```python
import torch

def _softmax(x, axis=-1):
    return torch.softmax(x, dim=axis)
def _gelu(x):
    return torch.nn.functional.gelu(x, approximate="tanh")
def _silu(x):
    return torch.nn.functional.silu(x)
def _sigmoid(x):
    return torch.sigmoid(x)
def _layernorm(x, axis=-1, eps=1e-5):
    m = x.mean(dim=axis, keepdim=True)
    v = x.var(dim=axis, keepdim=True, unbiased=False)
    return (x - m) / torch.sqrt(v + eps)
def _scatter_add(tgt, idx, src, axis=0):
    return tgt.clone().index_add_(axis, idx, src)
def _segment_sum(src, seg, n):
    out = torch.zeros((n,) + src.shape[1:], dtype=src.dtype)
    return out.index_add_(0, seg, src)
def _pad(x, pw):
    flat = tuple(v for pair in reversed(pw) for v in pair)
    return torch.nn.functional.pad(x, flat)

kernel_name = 'standalone__dcn_v2_cross__recsys'

def setup_inputs():

    _w = (lambda a: (lambda t: t.to(torch.bfloat16) if t.is_floating_point() else t)(torch.as_tensor(a)))
    B, F, D, L = 16384, 26, 32, 3
    Din = min(F * D, 1024)
    return {
        "x0": _w((lambda *s: torch.randn(*s, dtype=torch.bfloat16) * 0.05)(B, Din)),
        "ws": _w((lambda *s: torch.randn(*s, dtype=torch.bfloat16) * 0.05)(L, Din, Din)),
        "bs": _w((lambda *s: torch.randn(*s, dtype=torch.bfloat16) * 0.05)(L, Din)),
    }

def reference(x0, ws, bs):
    x = x0
    for l in range(ws.shape[0]):
        x = x0 * (x @ ws[l] + bs[l]) + x
    return x
```

```asm
; @launch grid=(256,1,1) block=(256,1,1) lds=142336
.amdgcn_target "amdgcn-amd-amdhsa--gfx950"
.text
.globl standalone__dcn_v2_cross__recsys_kernel
.p2align 8
.type standalone__dcn_v2_cross__recsys_kernel,@function
standalone__dcn_v2_cross__recsys_kernel:
s_cmp_ge_u32 s2, 256
s_cbranch_scc1 Lend
s_getpc_b64 s[32:33]
v_lshlrev_b32 v2, 4, v0
global_load_dwordx4 v[20:23], v2, s[32:33]
s_load_dwordx4 s[4:7], s[0:1], 0
s_load_dwordx4 s[8:11], s[0:1], 16
s_load_dwordx4 s[12:15], s[0:1], 32
v_lshrrev_b32 v40, 6, v0
v_and_b32 v41, 63, v0
v_readfirstlane_b32 s3, v40
v_lshlrev_b32 v1, 4, v41
s_getpc_b64 s[32:33]
Lpc2:
s_add_u32 s70, s32, Ltable-Lpc2
s_addc_u32 s71, s33, 0
s_add_u32 s32, s32, Lpa0-Lpc2
s_addc_u32 s33, s33, 0
s_lshl_b32 s56, s2, 2
s_add_u32 s56, s56, s3
s_min_u32 s67, s56, 597
s_mov_b32 s16, 33038210
s_mul_hi_u32 s17, s67, s16
s_mul_i32 s16, s17, 130
s_sub_u32 s23, s67, s16
s_mov_b32 s16, 858993460
s_mul_hi_u32 s35, s23, s16
s_mul_i32 s16, s35, 5
s_sub_u32 s16, s23, s16
s_mul_i32 s16, s16, 384
s_add_u32 s16, s16, 256
s_min_u32 s16, s16, 1536
s_lshl_b32 s23, s23, 4
s_cmp_ge_u32 s67, 390
s_cselect_b32 s69, 1, 0
s_cbranch_scc0 Ljd_b0
s_sub_u32 s18, s67, 390
s_cmp_ge_u32 s18, 104
s_cselect_b32 s17, 2, 1
s_cselect_b32 s19, 104, 0
s_sub_u32 s18, s18, s19
s_lshr_b32 s35, s18, 2
s_and_b32 s16, s18, 3
s_mul_i32 s16, s16, 384
s_add_u32 s16, s16, 3328
s_lshl_b32 s23, s18, 2
s_add_u32 s23, s23, 2080
Ljd_b0:
s_load_dwordx4 s[60:63], s[70:71], s23
s_mul_i32 s66, s17, 346112
s_mul_i32 s17, s17, 1384448
s_mul_i32 s35, s35, 53248
s_add_u32 s17, s17, s35
s_add_u32 s64, s17, s16
s_lshr_b32 s16, s2, 3
s_lshl_b32 s16, s16, 2
s_add_u32 s16, s16, s3
s_and_b32 s17, s2, 7
s_mul_i32 s17, s17, 7
s_add_u32 s16, s16, s17
s_mul_i32 s16, s16, 1
s_add_u32 s17, s16, 0
s_mul_hi_u32 s18, s17, 67108864
s_mul_i32 s18, s18, 64
s_sub_u32 s17, s17, s18
s_lshl_b32 s17, s17, 10
s_min_u32 s17, s17, Lcode_end-Lpa0
v_add_u32 v42, s17, v1
global_load_dwordx4 v[20:23], v42, s[32:33]
s_lshr_b32 s16, s2, 3
s_lshl_b32 s16, s16, 2
s_add_u32 s16, s16, s3
s_mul_hi_u32 s18, s16, 268435456
s_mul_i32 s18, s18, 16
s_sub_u32 s17, s16, s18
s_lshl_b32 s17, s17, 10
s_add_u32 s17, s17, Lpbl-Lpa0
s_min_u32 s17, s17, Lcode_end-Lpa0
v_add_u32 v38, s17, v1
v_and_b32 v42, 15, v41
v_lshrrev_b32 v43, 4, v41
v_lshlrev_b32 v40, 2, v0
v_lshrrev_b32 v24, 3, v41
v_and_b32 v25, 7, v41
v_xor_b32 v32, v25, v24
v_mul_u32_u24 v33, 1664, v24
v_lshl_add_u32 v9, v32, 4, v33
v_add_u32 v10, 13312, v9
v_mul_u32_u24 v32, 13312, v43
v_lshl_add_u32 v32, v42, 4, v32
v_add_u32 v33, 6656, v32
s_mov_b32 s84, 0x05040100
s_mov_b32 s85, 0x07060302
s_mul_i32 s27, s3, 24576
s_mul_i32 s16, s2, 106496
s_mul_i32 s17, s3, 384
s_add_u32 s22, s16, s17
s_lshr_b32 s18, s3, 1
s_and_b32 s19, s3, 1
s_mul_i32 s23, s3, 1038336
s_lshr_b32 s16, s2, 3
s_and_b32 s16, s16, 3
s_mov_b32 s24, 17
s_cmp_eq_u32 s16, 1
s_cselect_b32 s24, 34, s24
s_cmp_eq_u32 s16, 2
s_cselect_b32 s24, 68, s24
s_cmp_eq_u32 s16, 3
s_cselect_b32 s24, 136, s24
s_mov_b32 s17, 256
s_cmp_lt_u32 s56, 390
s_cselect_b32 s16, 512, s17
s_cmp_lt_u32 s56, 598
s_cselect_b32 s16, s16, 0
s_or_b32 s24, s24, s16
s_mov_b32 s17, 2048
s_cmp_lt_u32 s2, 160
s_cselect_b32 s16, 3072, s17
s_cmp_eq_u32 s3, 0
s_cselect_b32 s16, s16, 0
s_or_b32 s24, s24, s16
s_waitcnt lgkmcnt(0)
s_mov_b32 s28, s8
s_mov_b32 s29, s9
s_mov_b32 s30, 4992
s_mov_b32 s31, 0x20000
s_add_u32 s36, s4, s22
s_addc_u32 s37, s5, 0
s_add_u32 s38, s36, 26624
s_addc_u32 s39, s37, 0
s_add_u32 s40, s36, 53248
s_addc_u32 s41, s37, 0
s_add_u32 s42, s36, 79872
s_addc_u32 s43, s37, 0
s_add_u32 s20, s14, s23
s_addc_u32 s21, s15, 0
s_add_u32 s64, s6, s64
s_addc_u32 s65, s7, 0
s_mul_i32 s17, s3, 384
s_add_u32 s17, s17, 3328
s_add_u32 s58, s6, s17
s_addc_u32 s59, s7, 0
s_add_u32 s16, s3, 0
s_and_b32 s16, s16, 3
s_mul_i32 s16, s16, 319488
s_add_u32 s72, s58, s16
s_addc_u32 s73, s59, 0
s_add_u32 s16, s3, 1
s_and_b32 s16, s16, 3
s_mul_i32 s16, s16, 319488
s_add_u32 s74, s58, s16
s_addc_u32 s75, s59, 0
s_add_u32 s16, s3, 2
s_and_b32 s16, s16, 3
s_mul_i32 s16, s16, 319488
s_add_u32 s76, s58, s16
s_addc_u32 s77, s59, 0
s_add_u32 s16, s3, 3
s_and_b32 s16, s16, 3
s_mul_i32 s16, s16, 319488
s_add_u32 s78, s58, s16
s_addc_u32 s79, s59, 0
s_add_u32 s80, s58, 1277952
s_addc_u32 s81, s59, 0
buffer_load_dword v16, v40, s[28:31], 0 offen offset:0
buffer_load_dword v17, v40, s[28:31], 0 offen offset:1024
buffer_load_dword v18, v40, s[28:31], 0 offen offset:2048
buffer_load_dword v19, v40, s[28:31], 0 offen offset:3072
v_add_u32 v34, 4096, v40
buffer_load_dword v20, v34, s[28:31], 0 offen
s_add_u32 m0, s27, 0
s_nop 0
global_load_lds_dwordx4 v9, s[36:37] offset:0
s_add_u32 m0, s27, 1024
s_nop 0
global_load_lds_dwordx4 v10, s[36:37] offset:0
s_add_u32 m0, s27, 2048
s_nop 0
global_load_lds_dwordx4 v9, s[38:39] offset:0
s_add_u32 m0, s27, 3072
s_nop 0
global_load_lds_dwordx4 v10, s[38:39] offset:0
s_add_u32 m0, s27, 4096
s_nop 0
global_load_lds_dwordx4 v9, s[40:41] offset:0
s_add_u32 m0, s27, 5120
s_nop 0
global_load_lds_dwordx4 v10, s[40:41] offset:0
s_add_u32 m0, s27, 6144
s_nop 0
global_load_lds_dwordx4 v9, s[42:43] offset:0
s_add_u32 m0, s27, 7168
s_nop 0
global_load_lds_dwordx4 v10, s[42:43] offset:0
s_add_u32 s82, s72, 0
s_addc_u32 s83, s73, 0
global_load_dwordx4 a[168:171], v32, s[82:83] offset:-3328
global_load_dwordx4 a[172:175], v32, s[82:83] offset:-1664
global_load_dwordx4 a[176:179], v32, s[82:83] offset:0
global_load_dwordx4 a[180:183], v32, s[82:83] offset:1664
global_load_dwordx4 a[184:187], v33, s[82:83] offset:-3328
global_load_dwordx4 a[188:191], v33, s[82:83] offset:-1664
global_load_dwordx4 a[192:195], v33, s[82:83] offset:0
global_load_dwordx4 a[196:199], v33, s[82:83] offset:1664
s_mov_b32 s25, 0xffff0000
v_and_b32 v24, 7, v42
v_lshrrev_b32 v25, 3, v42
v_xor_b32 v30, v43, v24
v_lshlrev_b32 v30, 4, v30
v_lshl_add_u32 v30, v24, 7, v30
v_lshl_add_u32 v30, v25, 10, v30
v_xor_b32 v31, 64, v30
s_add_u32 s16, s3, 0
s_and_b32 s16, s16, 3
s_mul_i32 s16, s16, 24576
v_add_u32 v3, s16, v30
v_add_u32 v44, s16, v31
s_add_u32 s16, s3, 1
s_and_b32 s16, s16, 3
s_mul_i32 s16, s16, 24576
v_add_u32 v4, s16, v30
v_add_u32 v45, s16, v31
s_add_u32 s16, s3, 2
s_and_b32 s16, s16, 3
s_mul_i32 s16, s16, 24576
v_add_u32 v5, s16, v30
v_add_u32 v46, s16, v31
s_add_u32 s16, s3, 3
s_and_b32 s16, s16, 3
s_mul_i32 s16, s16, 24576
v_add_u32 v6, s16, v30
v_add_u32 v47, s16, v31
v_add_u32 v7, 98304, v30
v_add_u32 v15, 98304, v31
s_lshl_b32 s16, s18, 6
v_xor_b32 v8, s16, v7
s_lshl_b32 s17, s19, 3
v_add_u32 v8, s17, v8
s_mul_i32 s16, s3, 22528
s_sub_u32 s86, 117760, s16
v_and_b32 v26, 1, v43
v_lshlrev_b32 v26, 2, v26
v_xor_b32 v26, v26, v24
v_lshlrev_b32 v26, 4, v26
v_lshl_add_u32 v26, v24, 7, v26
v_lshl_add_u32 v26, v25, 10, v26
v_lshrrev_b32 v27, 1, v43
v_lshl_add_u32 v26, v27, 13, v26
v_add_u32 v26, s27, v26
v_lshlrev_b32 v24, 5, v43
s_mul_i32 s16, s3, 768
s_add_u32 s16, s16, 103168
v_add_u32 v13, s16, v24
v_lshlrev_b32 v25, 7, v43
s_add_u32 s16, s16, 3328
v_add_u32 v0, s16, v25
s_lshl_b32 s16, s18, 7
s_lshl_b32 s17, s19, 4
s_add_u32 s16, s16, s17
s_add_u32 s16, s16, 106240
v_add_u32 v14, s16, v24
v_add_u32 v2, 243712, v1
s_mov_b32 s26, 0
s_mov_b32 s68, 0
v_and_b32 v11, 15, v41
v_lshlrev_b32 v11, 4, v11
s_mul_i32 s16, s2, 106496
s_mul_i32 s17, s3, 26624
s_add_u32 s16, s16, s17
s_add_u32 s16, s16, 1536
s_add_u32 s44, s4, s16
s_addc_u32 s45, s5, 0
s_add_u32 s46, s10, s16
s_addc_u32 s47, s11, 0
s_lshl_b32 s16, s3, 11
s_add_u32 s34, s16, 98304
s_add_u32 s48, s10, s22
s_addc_u32 s49, s11, 0
s_add_u32 s50, s48, 26624
s_addc_u32 s51, s49, 0
s_add_u32 s52, s48, 53248
s_addc_u32 s53, s49, 0
s_add_u32 s54, s48, 79872
s_addc_u32 s55, s49, 0
v_lshlrev_b32 v27, 1, v40
v_add_u32 v27, 106496, v27
v_mov_b32 v40, v26
v_xor_b32 v41, 16, v26
v_xor_b32 v42, 32, v26
v_xor_b32 v43, 48, v26
v_lshrrev_b32 v28, 4, v1
v_lshrrev_b32 v29, 3, v28
v_mul_u32_u24 v29, 1664, v29
v_bfe_u32 v30, v28, 4, 1
v_lshlrev_b32 v30, 2, v30
v_and_b32 v36, 7, v28
v_xor_b32 v30, v30, v36
v_lshl_add_u32 v36, v30, 4, v29
v_lshrrev_b32 v29, 4, v28
v_bfe_u32 v30, v28, 2, 2
v_lshl_add_u32 v29, v29, 3, v30
v_lshlrev_b32 v29, 7, v29
v_and_b32 v30, 3, v28
v_lshl_add_u32 v29, v30, 4, v29
v_bfe_u32 v30, v28, 3, 1
v_lshl_add_u32 v34, v30, 6, v29
s_lshl_b32 s16, s3, 12
s_add_u32 s16, s16, 117760
v_add_u32 v34, s16, v34
v_xor_b32 v35, 64, v34
s_add_u32 s82, s74, 0
s_addc_u32 s83, s75, 0
global_load_dwordx4 v[192:195], v32, s[82:83] offset:-3328
global_load_dwordx4 v[196:199], v32, s[82:83] offset:-1664
global_load_dwordx4 v[200:203], v32, s[82:83] offset:0
global_load_dwordx4 v[204:207], v32, s[82:83] offset:1664
global_load_dwordx4 v[208:211], v33, s[82:83] offset:-3328
global_load_dwordx4 v[212:215], v33, s[82:83] offset:-1664
global_load_dwordx4 v[216:219], v33, s[82:83] offset:0
global_load_dwordx4 v[220:223], v33, s[82:83] offset:1664
s_bitcmp1_b32 s24, 8
s_cbranch_scc0 Ljla
global_load_dwordx4 a[0:3], v32, s[64:65] offset:-3328
global_load_dwordx4 a[4:7], v32, s[64:65] offset:-1664
global_load_dwordx4 a[8:11], v32, s[64:65] offset:0
global_load_dwordx4 a[12:15], v32, s[64:65] offset:1664
global_load_dwordx4 a[16:19], v33, s[64:65] offset:-3328
global_load_dwordx4 a[20:23], v33, s[64:65] offset:-1664
global_load_dwordx4 a[24:27], v33, s[64:65] offset:0
global_load_dwordx4 a[28:31], v33, s[64:65] offset:1664
Ljla:
s_bitcmp1_b32 s24, 9
s_cbranch_scc0 Ljlb
s_lshl_b32 s16, s3, 12
s_add_u32 s16, s16, 117760
s_add_u32 m0, s16, 0
s_nop 0
global_load_lds_dwordx4 v36, s[64:65]
s_add_u32 s64, s64, 13312
s_addc_u32 s65, s65, 0
s_add_u32 m0, s16, 1024
s_nop 0
global_load_lds_dwordx4 v36, s[64:65]
s_add_u32 s64, s64, 13312
s_addc_u32 s65, s65, 0
s_add_u32 m0, s16, 2048
s_nop 0
global_load_lds_dwordx4 v36, s[64:65]
s_add_u32 s64, s64, 13312
s_addc_u32 s65, s65, 0
s_add_u32 m0, s16, 3072
s_nop 0
global_load_lds_dwordx4 v36, s[64:65]
Ljlb:
s_lshr_b32 s16, s2, 3
s_and_b32 s16, s16, 31
s_lshl_b32 s16, s16, 2
s_add_u32 s16, s16, s3
s_mul_i32 s16, s16, 10816
s_add_u32 s16, s16, 4096
s_add_u32 s56, s6, s16
s_addc_u32 s57, s7, 0
global_load_dwordx4 a[96:99], v1, s[56:57] offset:-4096
global_load_dwordx4 a[96:99], v1, s[56:57] offset:-3072
global_load_dwordx4 a[96:99], v1, s[56:57] offset:-2048
global_load_dwordx4 a[96:99], v1, s[56:57] offset:-1024
global_load_dwordx4 a[96:99], v1, s[56:57] offset:0
global_load_dwordx4 a[96:99], v1, s[56:57] offset:1024
global_load_dwordx4 a[96:99], v1, s[56:57] offset:2048
global_load_dwordx4 a[96:99], v1, s[56:57] offset:3072
s_add_u32 s56, s56, 8192
s_addc_u32 s57, s57, 0
global_load_dwordx4 a[96:99], v1, s[56:57] offset:-4096
global_load_dwordx4 a[96:99], v1, s[56:57] offset:-3072
global_load_dwordx4 a[96:99], v1, s[56:57] offset:-2048
s_waitcnt vmcnt(35)
v_lshlrev_b32 v24, 16, v16
v_and_b32 v25, s25, v16
ds_write_b64 v27, v[24:25] offset:0
v_lshlrev_b32 v28, 16, v17
v_and_b32 v29, s25, v17
ds_write_b64 v27, v[28:29] offset:2048
v_lshlrev_b32 v24, 16, v18
v_and_b32 v25, s25, v18
ds_write_b64 v27, v[24:25] offset:4096
v_lshlrev_b32 v28, 16, v19
v_and_b32 v29, s25, v19
ds_write_b64 v27, v[28:29] offset:6144
v_lshlrev_b32 v24, 16, v20
v_and_b32 v25, s25, v20
ds_write_b64 v27, v[24:25] offset:8192
s_waitcnt vmcnt(27) lgkmcnt(0)
s_barrier
ds_read_b128 a[208:211], v3 offset:0
ds_read_b128 a[212:215], v3 offset:2048
ds_read_b128 a[216:219], v3 offset:4096
ds_read_b128 a[220:223], v3 offset:6144
ds_read2_b32 v[60:61], v0 offset0:0 offset1:8
ds_read2_b32 v[62:63], v0 offset0:16 offset1:24
ds_read2_b32 v[76:77], v0 offset0:1 offset1:9
ds_read2_b32 v[78:79], v0 offset0:17 offset1:25
ds_read2_b32 v[92:93], v0 offset0:2 offset1:10
ds_read2_b32 v[94:95], v0 offset0:18 offset1:26
ds_read2_b32 v[108:109], v0 offset0:3 offset1:11
ds_read2_b32 v[110:111], v0 offset0:19 offset1:27
ds_read2_b32 v[124:125], v0 offset0:4 offset1:12
ds_read2_b32 v[126:127], v0 offset0:20 offset1:28
ds_read2_b32 v[140:141], v0 offset0:5 offset1:13
ds_read2_b32 v[142:143], v0 offset0:21 offset1:29
ds_read2_b32 v[156:157], v0 offset0:6 offset1:14
ds_read2_b32 v[158:159], v0 offset0:22 offset1:30
ds_read2_b32 v[172:173], v0 offset0:7 offset1:15
ds_read2_b32 v[174:175], v0 offset0:23 offset1:31
s_waitcnt vmcnt(19)
v_accvgpr_read_b32 v16, a168
v_accvgpr_read_b32 v17, a172
v_accvgpr_read_b32 v18, a176
v_accvgpr_read_b32 v19, a180
v_accvgpr_read_b32 v20, a184
v_accvgpr_read_b32 v21, a188
v_accvgpr_read_b32 v22, a192
v_accvgpr_read_b32 v23, a196
v_accvgpr_read_b32 v24, a169
v_accvgpr_read_b32 v25, a173
v_accvgpr_read_b32 v26, a177
v_accvgpr_read_b32 v27, a181
v_accvgpr_read_b32 v28, a185
v_accvgpr_read_b32 v29, a189
v_accvgpr_read_b32 v30, a193
v_accvgpr_read_b32 v31, a197
v_perm_b32 v184, v17, v16, s84
v_perm_b32 v185, v19, v18, s84
v_perm_b32 v186, v21, v20, s84
v_perm_b32 v187, v23, v22, s84
v_perm_b32 v188, v17, v16, s85
v_perm_b32 v189, v19, v18, s85
v_perm_b32 v190, v21, v20, s85
v_perm_b32 v191, v23, v22, s85
s_nop 1
.p2align 6
Lpa0:
s_waitcnt lgkmcnt(14)
v_mfma_f32_16x16x32_bf16 v[48:51], v[184:187], a[208:211], v[60:63]
ds_read_b128 a[224:227], v4 offset:0
v_perm_b32 v176, v25, v24, s84
v_accvgpr_read_b32 v16, a170
v_add_u32 v13, 3328, v13
v_mfma_f32_16x16x32_bf16 v[52:55], v[184:187], a[212:215], v[60:63]
s_add_u32 s82, s76, 0
s_addc_u32 s83, s77, 0
ds_read_b128 a[228:231], v4 offset:2048
global_load_dwordx4 v[224:227], v32, s[82:83] offset:-3328
v_perm_b32 v177, v27, v26, s84
v_accvgpr_read_b32 v17, a174
v_mfma_f32_16x16x32_bf16 v[56:59], v[184:187], a[216:219], v[60:63]
ds_read_b128 a[232:235], v4 offset:4096
v_perm_b32 v178, v29, v28, s84
v_accvgpr_read_b32 v18, a178
v_add_u32 v14, 3328, v14
v_mfma_f32_16x16x32_bf16 v[60:63], v[184:187], a[220:223], v[60:63]
s_waitcnt lgkmcnt(15)
global_load_dwordx4 v[228:231], v32, s[82:83] offset:-1664
v_perm_b32 v179, v31, v30, s84
v_accvgpr_read_b32 v19, a182
v_add_u32 v0, 3328, v0
v_mfma_f32_16x16x32_bf16 v[64:67], v[188:191], a[208:211], v[76:79]
ds_read_b128 a[236:239], v4 offset:6144
v_perm_b32 v180, v25, v24, s85
v_accvgpr_read_b32 v20, a186
v_mfma_f32_16x16x32_bf16 v[68:71], v[188:191], a[212:215], v[76:79]
global_load_dwordx4 v[232:235], v32, s[82:83] offset:0
v_perm_b32 v181, v27, v26, s85
v_accvgpr_read_b32 v21, a190
v_mfma_f32_16x16x32_bf16 v[72:75], v[188:191], a[216:219], v[76:79]
v_perm_b32 v182, v29, v28, s85
v_accvgpr_read_b32 v22, a194
v_mfma_f32_16x16x32_bf16 v[76:79], v[188:191], a[220:223], v[76:79]
s_waitcnt lgkmcnt(14)
global_load_dwordx4 v[236:239], v32, s[82:83] offset:1664
v_perm_b32 v183, v31, v30, s85
v_accvgpr_read_b32 v23, a198
v_mfma_f32_16x16x32_bf16 v[80:83], v[176:179], a[208:211], v[92:95]
v_perm_b32 v184, v17, v16, s84
v_accvgpr_read_b32 v24, a171
v_mfma_f32_16x16x32_bf16 v[84:87], v[176:179], a[212:215], v[92:95]
global_load_dwordx4 v[240:243], v33, s[82:83] offset:-3328
v_perm_b32 v185, v19, v18, s84
v_accvgpr_read_b32 v25, a175
v_mfma_f32_16x16x32_bf16 v[88:91], v[176:179], a[216:219], v[92:95]
s_bitcmp1_b32 s24, 0
s_cbranch_scc0 Lsite0
s_add_u32 m0, s27, 8064
s_nop 0
global_load_lds_dwordx4 v9, s[36:37] offset:128
s_add_u32 m0, s27, 9088
s_nop 0
global_load_lds_dwordx4 v10, s[36:37] offset:128
s_add_u32 m0, s27, 10112
s_nop 0
global_load_lds_dwordx4 v9, s[38:39] offset:128
s_add_u32 m0, s27, 11136
s_nop 0
global_load_lds_dwordx4 v10, s[38:39] offset:128
s_add_u32 m0, s27, 12160
s_nop 0
global_load_lds_dwordx4 v9, s[40:41] offset:128
s_add_u32 m0, s27, 13184
s_nop 0
global_load_lds_dwordx4 v10, s[40:41] offset:128
s_add_u32 m0, s27, 14208
s_nop 0
global_load_lds_dwordx4 v9, s[42:43] offset:128
s_add_u32 m0, s27, 15232
s_nop 0
global_load_lds_dwordx4 v10, s[42:43] offset:128
Lsite0:
v_perm_b32 v186, v21, v20, s84
v_accvgpr_read_b32 v26, a179
v_mfma_f32_16x16x32_bf16 v[92:95], v[176:179], a[220:223], v[92:95]
s_waitcnt lgkmcnt(12)
global_load_dwordx4 v[244:247], v33, s[82:83] offset:-1664
v_perm_b32 v187, v23, v22, s84
v_accvgpr_read_b32 v27, a183
v_mfma_f32_16x16x32_bf16 v[96:99], v[180:183], a[208:211], v[108:111]
v_perm_b32 v188, v17, v16, s85
v_accvgpr_read_b32 v28, a187
v_mfma_f32_16x16x32_bf16 v[100:103], v[180:183], a[212:215], v[108:111]
global_load_dwordx4 v[248:251], v33, s[82:83] offset:0
v_perm_b32 v189, v19, v18, s85
v_accvgpr_read_b32 v29, a191
v_mfma_f32_16x16x32_bf16 v[104:107], v[180:183], a[216:219], v[108:111]
v_perm_b32 v190, v21, v20, s85
v_accvgpr_read_b32 v30, a195
v_mfma_f32_16x16x32_bf16 v[108:111], v[180:183], a[220:223], v[108:111]
s_waitcnt lgkmcnt(10)
global_load_dwordx4 v[252:255], v33, s[82:83] offset:1664
v_perm_b32 v191, v23, v22, s85
v_accvgpr_read_b32 v31, a199
v_mfma_f32_16x16x32_bf16 v[112:115], v[184:187], a[208:211], v[124:127]
v_perm_b32 v176, v25, v24, s84
v_mfma_f32_16x16x32_bf16 v[116:119], v[184:187], a[212:215], v[124:127]
s_add_u32 s82, s74, 53248
s_addc_u32 s83, s75, 0
global_load_dwordx4 a[168:171], v32, s[82:83] offset:-3328
v_perm_b32 v177, v27, v26, s84
v_mfma_f32_16x16x32_bf16 v[120:123], v[184:187], a[216:219], v[124:127]
v_perm_b32 v178, v29, v28, s84
v_mfma_f32_16x16x32_bf16 v[124:127], v[184:187], a[220:223], v[124:127]
s_waitcnt lgkmcnt(8)
global_load_dwordx4 a[172:175], v32, s[82:83] offset:-1664
v_perm_b32 v179, v31, v30, s84
v_mfma_f32_16x16x32_bf16 v[128:131], v[188:191], a[208:211], v[140:143]
v_perm_b32 v180, v25, v24, s85
v_mfma_f32_16x16x32_bf16 v[132:135], v[188:191], a[212:215], v[140:143]
global_load_dwordx4 a[176:179], v32, s[82:83] offset:0
v_perm_b32 v181, v27, v26, s85
v_mfma_f32_16x16x32_bf16 v[136:139], v[188:191], a[216:219], v[140:143]
v_perm_b32 v182, v29, v28, s85
v_mfma_f32_16x16x32_bf16 v[140:143], v[188:191], a[220:223], v[140:143]
s_waitcnt lgkmcnt(6)
global_load_dwordx4 a[180:183], v32, s[82:83] offset:1664
v_perm_b32 v183, v31, v30, s85
v_mfma_f32_16x16x32_bf16 v[144:147], v[176:179], a[208:211], v[156:159]
s_waitcnt vmcnt(23)
v_perm_b32 v184, v196, v192, s84
v_mfma_f32_16x16x32_bf16 v[148:151], v[176:179], a[212:215], v[156:159]
global_load_dwordx4 a[184:187], v33, s[82:83] offset:-3328
v_perm_b32 v185, v204, v200, s84
v_mfma_f32_16x16x32_bf16 v[152:155], v[176:179], a[216:219], v[156:159]
v_perm_b32 v186, v212, v208, s84
v_mfma_f32_16x16x32_bf16 v[156:159], v[176:179], a[220:223], v[156:159]
s_waitcnt lgkmcnt(4)
global_load_dwordx4 a[188:191], v33, s[82:83] offset:-1664
v_perm_b32 v187, v220, v216, s84
v_mfma_f32_16x16x32_bf16 v[160:163], v[180:183], a[208:211], v[172:175]
v_perm_b32 v188, v196, v192, s85
v_mfma_f32_16x16x32_bf16 v[164:167], v[180:183], a[212:215], v[172:175]
global_load_dwordx4 a[192:195], v33, s[82:83] offset:0
v_perm_b32 v189, v204, v200, s85
v_mfma_f32_16x16x32_bf16 v[168:171], v[180:183], a[216:219], v[172:175]
v_perm_b32 v190, v212, v208, s85
v_mfma_f32_16x16x32_bf16 v[172:175], v[180:183], a[220:223], v[172:175]
s_waitcnt lgkmcnt(3)
global_load_dwordx4 a[196:199], v33, s[82:83] offset:1664
v_perm_b32 v191, v220, v216, s85
v_mfma_f32_16x16x32_bf16 v[48:51], v[184:187], a[224:227], v[48:51]
s_waitcnt lgkmcnt(2)
ds_read_b128 a[208:211], v5 offset:0
v_perm_b32 v176, v197, v193, s84
v_mfma_f32_16x16x32_bf16 v[52:55], v[184:187], a[228:231], v[52:55]
s_waitcnt lgkmcnt(2)
s_add_u32 s82, s78, 0
s_addc_u32 s83, s79, 0
ds_read_b128 a[212:215], v5 offset:2048
global_load_dwordx4 a[104:107], v32, s[82:83] offset:-3328
v_perm_b32 v177, v205, v201, s84
v_mfma_f32_16x16x32_bf16 v[56:59], v[184:187], a[232:235], v[56:59]
s_waitcnt lgkmcnt(2)
ds_read_b128 a[216:219], v5 offset:4096
v_perm_b32 v178, v213, v209, s84
v_mfma_f32_16x16x32_bf16 v[60:63], v[184:187], a[236:239], v[60:63]
global_load_dwordx4 a[108:111], v32, s[82:83] offset:-1664
v_perm_b32 v179, v221, v217, s84
v_mfma_f32_16x16x32_bf16 v[76:79], v[188:191], a[236:239], v[76:79]
ds_read_b128 a[220:223], v5 offset:6144
v_perm_b32 v180, v197, v193, s85
v_mfma_f32_16x16x32_bf16 v[72:75], v[188:191], a[232:235], v[72:75]
global_load_dwordx4 a[112:115], v32, s[82:83] offset:0
v_perm_b32 v181, v205, v201, s85
v_mfma_f32_16x16x32_bf16 v[68:71], v[188:191], a[228:231], v[68:71]
v_perm_b32 v182, v213, v209, s85
v_mfma_f32_16x16x32_bf16 v[64:67], v[188:191], a[224:227], v[64:67]
global_load_dwordx4 a[116:119], v32, s[82:83] offset:1664
v_perm_b32 v183, v221, v217, s85
v_mfma_f32_16x16x32_bf16 v[80:83], v[176:179], a[224:227], v[80:83]
v_perm_b32 v184, v198, v194, s84
v_mfma_f32_16x16x32_bf16 v[84:87], v[176:179], a[228:231], v[84:87]
global_load_dwordx4 a[120:123], v33, s[82:83] offset:-3328
v_perm_b32 v185, v206, v202, s84
v_mfma_f32_16x16x32_bf16 v[88:91], v[176:179], a[232:235], v[88:91]
s_bitcmp1_b32 s24, 1
s_cbranch_scc0 Lsite1
s_add_u32 m0, s27, 8064
s_nop 0
global_load_lds_dwordx4 v9, s[36:37] offset:128
s_add_u32 m0, s27, 9088
s_nop 0
global_load_lds_dwordx4 v10, s[36:37] offset:128
s_add_u32 m0, s27, 10112
s_nop 0
global_load_lds_dwordx4 v9, s[38:39] offset:128
s_add_u32 m0, s27, 11136
s_nop 0
global_load_lds_dwordx4 v10, s[38:39] offset:128
s_add_u32 m0, s27, 12160
s_nop 0
global_load_lds_dwordx4 v9, s[40:41] offset:128
s_add_u32 m0, s27, 13184
s_nop 0
global_load_lds_dwordx4 v10, s[40:41] offset:128
s_add_u32 m0, s27, 14208
s_nop 0
global_load_lds_dwordx4 v9, s[42:43] offset:128
s_add_u32 m0, s27, 15232
s_nop 0
global_load_lds_dwordx4 v10, s[42:43] offset:128
Lsite1:
v_perm_b32 v186, v214, v210, s84
v_mfma_f32_16x16x32_bf16 v[92:95], v[176:179], a[236:239], v[92:95]
global_load_dwordx4 a[124:127], v33, s[82:83] offset:-1664
v_perm_b32 v187, v222, v218, s84
v_mfma_f32_16x16x32_bf16 v[108:111], v[180:183], a[236:239], v[108:111]
v_perm_b32 v188, v198, v194, s85
v_mfma_f32_16x16x32_bf16 v[104:107], v[180:183], a[232:235], v[104:107]
global_load_dwordx4 a[128:131], v33, s[82:83] offset:0
v_perm_b32 v189, v206, v202, s85
v_mfma_f32_16x16x32_bf16 v[100:103], v[180:183], a[228:231], v[100:103]
v_perm_b32 v190, v214, v210, s85
v_mfma_f32_16x16x32_bf16 v[96:99], v[180:183], a[224:227], v[96:99]
global_load_dwordx4 a[132:135], v33, s[82:83] offset:1664
v_perm_b32 v191, v222, v218, s85
v_mfma_f32_16x16x32_bf16 v[112:115], v[184:187], a[224:227], v[112:115]
v_perm_b32 v176, v199, v195, s84
v_mfma_f32_16x16x32_bf16 v[116:119], v[184:187], a[228:231], v[116:119]
v_perm_b32 v177, v207, v203, s84
v_mfma_f32_16x16x32_bf16 v[120:123], v[184:187], a[232:235], v[120:123]
v_perm_b32 v178, v215, v211, s84
v_mfma_f32_16x16x32_bf16 v[124:127], v[184:187], a[236:239], v[124:127]
v_perm_b32 v179, v223, v219, s84
v_mfma_f32_16x16x32_bf16 v[140:143], v[188:191], a[236:239], v[140:143]
v_perm_b32 v180, v199, v195, s85
v_mfma_f32_16x16x32_bf16 v[136:139], v[188:191], a[232:235], v[136:139]
v_perm_b32 v181, v207, v203, s85
v_mfma_f32_16x16x32_bf16 v[132:135], v[188:191], a[228:231], v[132:135]
v_perm_b32 v182, v215, v211, s85
v_mfma_f32_16x16x32_bf16 v[128:131], v[188:191], a[224:227], v[128:131]
v_perm_b32 v183, v223, v219, s85
v_mfma_f32_16x16x32_bf16 v[144:147], v[176:179], a[224:227], v[144:147]
s_waitcnt vmcnt(16)
s_add_u32 s82, s76, 53248
s_addc_u32 s83, s77, 0
global_load_dwordx4 v[192:195], v32, s[82:83] offset:-3328
v_perm_b32 v184, v228, v224, s84
v_mfma_f32_16x16x32_bf16 v[148:151], v[176:179], a[228:231], v[148:151]
global_load_dwordx4 v[196:199], v32, s[82:83] offset:-1664
v_perm_b32 v185, v236, v232, s84
v_mfma_f32_16x16x32_bf16 v[152:155], v[176:179], a[232:235], v[152:155]
global_load_dwordx4 v[200:203], v32, s[82:83] offset:0
v_perm_b32 v186, v244, v240, s84
v_mfma_f32_16x16x32_bf16 v[156:159], v[176:179], a[236:239], v[156:159]
global_load_dwordx4 v[204:207], v32, s[82:83] offset:1664
v_perm_b32 v187, v252, v248, s84
v_mfma_f32_16x16x32_bf16 v[172:175], v[180:183], a[236:239], v[172:175]
global_load_dwordx4 v[208:211], v33, s[82:83] offset:-3328
v_perm_b32 v188, v228, v224, s85
v_mfma_f32_16x16x32_bf16 v[168:171], v[180:183], a[232:235], v[168:171]
global_load_dwordx4 v[212:215], v33, s[82:83] offset:-1664
v_perm_b32 v189, v236, v232, s85
v_mfma_f32_16x16x32_bf16 v[164:167], v[180:183], a[228:231], v[164:167]
global_load_dwordx4 v[216:219], v33, s[82:83] offset:0
v_perm_b32 v190, v244, v240, s85
v_mfma_f32_16x16x32_bf16 v[160:163], v[180:183], a[224:227], v[160:163]
s_waitcnt lgkmcnt(3)
global_load_dwordx4 v[220:223], v33, s[82:83] offset:1664
v_perm_b32 v191, v252, v248, s85
v_mfma_f32_16x16x32_bf16 v[48:51], v[184:187], a[208:211], v[48:51]
s_waitcnt lgkmcnt(2)
ds_read_b128 a[224:227], v6 offset:0
v_perm_b32 v176, v229, v225, s84
v_mfma_f32_16x16x32_bf16 v[52:55], v[184:187], a[212:215], v[52:55]
s_waitcnt lgkmcnt(2)
s_add_u32 s82, s72, 53248
s_addc_u32 s83, s73, 0
ds_read_b128 a[228:231], v6 offset:2048
global_load_dwordx4 a[136:139], v32, s[82:83] offset:-3328
v_perm_b32 v177, v237, v233, s84
v_mfma_f32_16x16x32_bf16 v[56:59], v[184:187], a[216:219], v[56:59]
s_waitcnt lgkmcnt(2)
ds_read_b128 a[232:235], v6 offset:4096
v_perm_b32 v178, v245, v241, s84
v_mfma_f32_16x16x32_bf16 v[60:63], v[184:187], a[220:223], v[60:63]
global_load_dwordx4 a[140:143], v32, s[82:83] offset:-1664
v_perm_b32 v179, v253, v249, s84
v_mfma_f32_16x16x32_bf16 v[76:79], v[188:191], a[220:223], v[76:79]
ds_read_b128 a[236:239], v6 offset:6144
v_perm_b32 v180, v229, v225, s85
v_mfma_f32_16x16x32_bf16 v[72:75], v[188:191], a[216:219], v[72:75]
global_load_dwordx4 a[144:147], v32, s[82:83] offset:0
v_perm_b32 v181, v237, v233, s85
v_mfma_f32_16x16x32_bf16 v[68:71], v[188:191], a[212:215], v[68:71]
v_perm_b32 v182, v245, v241, s85
v_mfma_f32_16x16x32_bf16 v[64:67], v[188:191], a[208:211], v[64:67]
global_load_dwordx4 a[148:151], v32, s[82:83] offset:1664
v_perm_b32 v183, v253, v249, s85
v_mfma_f32_16x16x32_bf16 v[80:83], v[176:179], a[208:211], v[80:83]
v_perm_b32 v184, v230, v226, s84
v_mfma_f32_16x16x32_bf16 v[84:87], v[176:179], a[212:215], v[84:87]
global_load_dwordx4 a[152:155], v33, s[82:83] offset:-3328
v_perm_b32 v185, v238, v234, s84
v_mfma_f32_16x16x32_bf16 v[88:91], v[176:179], a[216:219], v[88:91]
v_perm_b32 v186, v246, v242, s84
v_mfma_f32_16x16x32_bf16 v[92:95], v[176:179], a[220:223], v[92:95]
global_load_dwordx4 a[156:159], v33, s[82:83] offset:-1664
v_perm_b32 v187, v254, v250, s84
v_mfma_f32_16x16x32_bf16 v[108:111], v[180:183], a[220:223], v[108:111]
v_perm_b32 v188, v230, v226, s85
v_mfma_f32_16x16x32_bf16 v[104:107], v[180:183], a[216:219], v[104:107]
global_load_dwordx4 a[160:163], v33, s[82:83] offset:0
v_perm_b32 v189, v238, v234, s85
v_mfma_f32_16x16x32_bf16 v[100:103], v[180:183], a[212:215], v[100:103]
s_bitcmp1_b32 s24, 8
s_cbranch_scc0 Ljpa
s_add_u32 s16, s60, s66
s_add_u32 s16, s16, 4096
v_add_u32 v36, s16, v1
v_accvgpr_read_b32 v16, a0
v_accvgpr_read_b32 v17, a4
v_accvgpr_read_b32 v18, a8
v_accvgpr_read_b32 v19, a12
v_accvgpr_read_b32 v20, a16
v_accvgpr_read_b32 v21, a20
v_accvgpr_read_b32 v22, a24
v_accvgpr_read_b32 v23, a28
v_perm_b32 v24, v17, v16, s84
v_perm_b32 v25, v19, v18, s84
v_perm_b32 v26, v21, v20, s84
v_perm_b32 v27, v23, v22, s84
v_perm_b32 v28, v17, v16, s85
v_perm_b32 v29, v19, v18, s85
v_perm_b32 v30, v21, v20, s85
v_perm_b32 v31, v23, v22, s85
global_store_dwordx4 v36, v[24:27], s[14:15] offset:-4096 sc0 sc1
global_store_dwordx4 v36, v[28:31], s[14:15] offset:-3072 sc0 sc1
s_nop 1
v_accvgpr_read_b32 v16, a1
v_accvgpr_read_b32 v17, a5
v_accvgpr_read_b32 v18, a9
v_accvgpr_read_b32 v19, a13
v_accvgpr_read_b32 v20, a17
v_accvgpr_read_b32 v21, a21
v_accvgpr_read_b32 v22, a25
v_accvgpr_read_b32 v23, a29
v_perm_b32 v24, v17, v16, s84
v_perm_b32 v25, v19, v18, s84
v_perm_b32 v26, v21, v20, s84
v_perm_b32 v27, v23, v22, s84
v_perm_b32 v28, v17, v16, s85
v_perm_b32 v29, v19, v18, s85
v_perm_b32 v30, v21, v20, s85
v_perm_b32 v31, v23, v22, s85
global_store_dwordx4 v36, v[24:27], s[14:15] offset:-2048 sc0 sc1
global_store_dwordx4 v36, v[28:31], s[14:15] offset:-1024 sc0 sc1
s_nop 1
v_accvgpr_read_b32 v16, a2
v_accvgpr_read_b32 v17, a6
v_accvgpr_read_b32 v18, a10
v_accvgpr_read_b32 v19, a14
v_accvgpr_read_b32 v20, a18
v_accvgpr_read_b32 v21, a22
v_accvgpr_read_b32 v22, a26
v_accvgpr_read_b32 v23, a30
v_perm_b32 v24, v17, v16, s84
v_perm_b32 v25, v19, v18, s84
v_perm_b32 v26, v21, v20, s84
v_perm_b32 v27, v23, v22, s84
v_perm_b32 v28, v17, v16, s85
v_perm_b32 v29, v19, v18, s85
v_perm_b32 v30, v21, v20, s85
v_perm_b32 v31, v23, v22, s85
global_store_dwordx4 v36, v[24:27], s[14:15] offset:0 sc0 sc1
global_store_dwordx4 v36, v[28:31], s[14:15] offset:1024 sc0 sc1
s_nop 1
v_accvgpr_read_b32 v16, a3
v_accvgpr_read_b32 v17, a7
v_accvgpr_read_b32 v18, a11
v_accvgpr_read_b32 v19, a15
v_accvgpr_read_b32 v20, a19
v_accvgpr_read_b32 v21, a23
v_accvgpr_read_b32 v22, a27
v_accvgpr_read_b32 v23, a31
v_perm_b32 v24, v17, v16, s84
v_perm_b32 v25, v19, v18, s84
v_perm_b32 v26, v21, v20, s84
v_perm_b32 v27, v23, v22, s84
v_perm_b32 v28, v17, v16, s85
v_perm_b32 v29, v19, v18, s85
v_perm_b32 v30, v21, v20, s85
v_perm_b32 v31, v23, v22, s85
global_store_dwordx4 v36, v[24:27], s[14:15] offset:2048 sc0 sc1
global_store_dwordx4 v36, v[28:31], s[14:15] offset:3072 sc0 sc1
s_nop 1
Ljpa:
s_bitcmp1_b32 s24, 9
s_cbranch_scc0 Ljpb
ds_read_b64_tr_b16 a[0:1], v34 offset:0
ds_read_b64_tr_b16 a[2:3], v34 offset:512
ds_read_b64_tr_b16 a[4:5], v34 offset:8
ds_read_b64_tr_b16 a[6:7], v34 offset:520
ds_read_b64_tr_b16 a[8:9], v35 offset:0
ds_read_b64_tr_b16 a[10:11], v35 offset:512
ds_read_b64_tr_b16 a[12:13], v35 offset:8
ds_read_b64_tr_b16 a[14:15], v35 offset:520
s_add_u32 s16, s60, s66
v_add_u32 v36, s16, v1
s_waitcnt lgkmcnt(6)
global_store_dwordx4 v36, a[0:3], s[14:15] sc0 sc1
s_add_u32 s16, s61, s66
v_add_u32 v37, s16, v1
s_waitcnt lgkmcnt(4)
global_store_dwordx4 v37, a[4:7], s[14:15] sc0 sc1
s_add_u32 s16, s62, s66
v_add_u32 v36, s16, v1
s_waitcnt lgkmcnt(2)
global_store_dwordx4 v36, a[8:11], s[14:15] sc0 sc1
s_add_u32 s16, s63, s66
v_add_u32 v37, s16, v1
s_waitcnt lgkmcnt(0)
global_store_dwordx4 v37, a[12:15], s[14:15] sc0 sc1
Ljpb:
v_perm_b32 v190, v246, v242, s85
v_mfma_f32_16x16x32_bf16 v[96:99], v[180:183], a[208:211], v[96:99]
global_load_dwordx4 a[164:167], v33, s[82:83] offset:1664
v_perm_b32 v191, v254, v250, s85
v_mfma_f32_16x16x32_bf16 v[112:115], v[184:187], a[208:211], v[112:115]
s_waitcnt vmcnt(16)
v_perm_b32 v176, v231, v227, s84
v_accvgpr_read_b32 v16, a104
v_mfma_f32_16x16x32_bf16 v[116:119], v[184:187], a[212:215], v[116:119]
v_perm_b32 v177, v239, v235, s84
v_accvgpr_read_b32 v17, a108
v_mfma_f32_16x16x32_bf16 v[120:123], v[184:187], a[216:219], v[120:123]
v_perm_b32 v178, v247, v243, s84
v_accvgpr_read_b32 v18, a112
v_mfma_f32_16x16x32_bf16 v[124:127], v[184:187], a[220:223], v[124:127]
v_perm_b32 v179, v255, v251, s84
v_accvgpr_read_b32 v19, a116
v_mfma_f32_16x16x32_bf16 v[140:143], v[188:191], a[220:223], v[140:143]
v_perm_b32 v180, v231, v227, s85
v_accvgpr_read_b32 v20, a120
v_mfma_f32_16x16x32_bf16 v[136:139], v[188:191], a[216:219], v[136:139]
v_perm_b32 v181, v239, v235, s85
v_accvgpr_read_b32 v21, a124
v_mfma_f32_16x16x32_bf16 v[132:135], v[188:191], a[212:215], v[132:135]
v_perm_b32 v182, v247, v243, s85
v_accvgpr_read_b32 v22, a128
v_mfma_f32_16x16x32_bf16 v[128:131], v[188:191], a[208:211], v[128:131]
v_perm_b32 v183, v255, v251, s85
v_accvgpr_read_b32 v23, a132
v_mfma_f32_16x16x32_bf16 v[144:147], v[176:179], a[208:211], v[144:147]
s_add_u32 s82, s78, 53248
s_addc_u32 s83, s79, 0
global_load_dwordx4 v[224:227], v32, s[82:83] offset:-3328
v_perm_b32 v184, v17, v16, s84
v_accvgpr_read_b32 v24, a105
v_mfma_f32_16x16x32_bf16 v[148:151], v[176:179], a[212:215], v[148:151]
global_load_dwordx4 v[228:231], v32, s[82:83] offset:-1664
v_perm_b32 v185, v19, v18, s84
v_accvgpr_read_b32 v25, a109
v_mfma_f32_16x16x32_bf16 v[152:155], v[176:179], a[216:219], v[152:155]
global_load_dwordx4 v[232:235], v32, s[82:83] offset:0
v_perm_b32 v186, v21, v20, s84
v_accvgpr_read_b32 v26, a113
v_mfma_f32_16x16x32_bf16 v[156:159], v[176:179], a[220:223], v[156:159]
global_load_dwordx4 v[236:239], v32, s[82:83] offset:1664
v_perm_b32 v187, v23, v22, s84
v_accvgpr_read_b32 v27, a117
v_mfma_f32_16x16x32_bf16 v[172:175], v[180:183], a[220:223], v[172:175]
global_load_dwordx4 v[240:243], v33, s[82:83] offset:-3328
v_perm_b32 v188, v17, v16, s85
v_accvgpr_read_b32 v28, a121
v_mfma_f32_16x16x32_bf16 v[168:171], v[180:183], a[216:219], v[168:171]
global_load_dwordx4 v[244:247], v33, s[82:83] offset:-1664
v_perm_b32 v189, v19, v18, s85
v_accvgpr_read_b32 v29, a125
v_mfma_f32_16x16x32_bf16 v[164:167], v[180:183], a[212:215], v[164:167]
global_load_dwordx4 v[248:251], v33, s[82:83] offset:0
v_perm_b32 v190, v21, v20, s85
v_accvgpr_read_b32 v30, a129
v_mfma_f32_16x16x32_bf16 v[160:163], v[180:183], a[208:211], v[160:163]
s_waitcnt lgkmcnt(3)
global_load_dwordx4 v[252:255], v33, s[82:83] offset:1664
v_perm_b32 v191, v23, v22, s85
v_accvgpr_read_b32 v31, a133
v_mfma_f32_16x16x32_bf16 v[48:51], v[184:187], a[224:227], v[48:51]
s_waitcnt lgkmcnt(2)
ds_read_b128 a[208:211], v44 offset:0
v_perm_b32 v176, v25, v24, s84
v_accvgpr_read_b32 v16, a106
v_mfma_f32_16x16x32_bf16 v[52:55], v[184:187], a[228:231], v[52:55]
s_waitcnt lgkmcnt(2)
ds_read_b128 a[212:215], v44 offset:2048
v_perm_b32 v177, v27, v26, s84
v_accvgpr_read_b32 v17, a110
v_mfma_f32_16x16x32_bf16 v[56:59], v[184:187], a[232:235], v[56:59]
s_waitcnt lgkmcnt(2)
ds_read_b128 a[216:219], v44 offset:4096
v_perm_b32 v178, v29, v28, s84
v_accvgpr_read_b32 v18, a114
v_mfma_f32_16x16x32_bf16 v[60:63], v[184:187], a[236:239], v[60:63]
v_perm_b32 v179, v31, v30, s84
v_accvgpr_read_b32 v19, a118
v_mfma_f32_16x16x32_bf16 v[76:79], v[188:191], a[236:239], v[76:79]
ds_read_b128 a[220:223], v44 offset:6144
v_perm_b32 v180, v25, v24, s85
v_accvgpr_read_b32 v20, a122
v_mfma_f32_16x16x32_bf16 v[72:75], v[188:191], a[232:235], v[72:75]
v_perm_b32 v181, v27, v26, s85
v_accvgpr_read_b32 v21, a126
v_mfma_f32_16x16x32_bf16 v[68:71], v[188:191], a[228:231], v[68:71]
v_perm_b32 v182, v29, v28, s85
v_accvgpr_read_b32 v22, a130
v_mfma_f32_16x16x32_bf16 v[64:67], v[188:191], a[224:227], v[64:67]
v_perm_b32 v183, v31, v30, s85
v_accvgpr_read_b32 v23, a134
v_mfma_f32_16x16x32_bf16 v[80:83], v[176:179], a[224:227], v[80:83]
v_perm_b32 v184, v17, v16, s84
v_accvgpr_read_b32 v24, a107
v_mfma_f32_16x16x32_bf16 v[84:87], v[176:179], a[228:231], v[84:87]
v_perm_b32 v185, v19, v18, s84
v_accvgpr_read_b32 v25, a111
v_mfma_f32_16x16x32_bf16 v[88:91], v[176:179], a[232:235], v[88:91]
s_bitcmp1_b32 s24, 2
s_cbranch_scc0 Lsite2
s_add_u32 m0, s27, 8064
s_nop 0
global_load_lds_dwordx4 v9, s[36:37] offset:128
s_add_u32 m0, s27, 9088
s_nop 0
global_load_lds_dwordx4 v10, s[36:37] offset:128
s_add_u32 m0, s27, 10112
s_nop 0
global_load_lds_dwordx4 v9, s[38:39] offset:128
s_add_u32 m0, s27, 11136
s_nop 0
global_load_lds_dwordx4 v10, s[38:39] offset:128
s_add_u32 m0, s27, 12160
s_nop 0
global_load_lds_dwordx4 v9, s[40:41] offset:128
s_add_u32 m0, s27, 13184
s_nop 0
global_load_lds_dwordx4 v10, s[40:41] offset:128
s_add_u32 m0, s27, 14208
s_nop 0
global_load_lds_dwordx4 v9, s[42:43] offset:128
s_add_u32 m0, s27, 15232
s_nop 0
global_load_lds_dwordx4 v10, s[42:43] offset:128
Lsite2:
v_perm_b32 v186, v21, v20, s84
v_accvgpr_read_b32 v26, a115
v_mfma_f32_16x16x32_bf16 v[92:95], v[176:179], a[236:239], v[92:95]
v_perm_b32 v187, v23, v22, s84
v_accvgpr_read_b32 v27, a119
v_mfma_f32_16x16x32_bf16 v[108:111], v[180:183], a[236:239], v[108:111]
v_perm_b32 v188, v17, v16, s85
v_accvgpr_read_b32 v28, a123
v_mfma_f32_16x16x32_bf16 v[104:107], v[180:183], a[232:235], v[104:107]
v_perm_b32 v189, v19, v18, s85
v_accvgpr_read_b32 v29, a127
v_mfma_f32_16x16x32_bf16 v[100:103], v[180:183], a[228:231], v[100:103]
v_perm_b32 v190, v21, v20, s85
v_accvgpr_read_b32 v30, a131
v_mfma_f32_16x16x32_bf16 v[96:99], v[180:183], a[224:227], v[96:99]
v_perm_b32 v191, v23, v22, s85
v_accvgpr_read_b32 v31, a135
v_mfma_f32_16x16x32_bf16 v[112:115], v[184:187], a[224:227], v[112:115]
s_waitcnt vmcnt(8)
v_perm_b32 v176, v25, v24, s84
v_accvgpr_read_b32 v16, a136
v_mfma_f32_16x16x32_bf16 v[116:119], v[184:187], a[228:231], v[116:119]
s_add_u32 s82, s72, 106496
s_addc_u32 s83, s73, 0
global_load_dwordx4 a[104:107], v32, s[82:83] offset:-3328
v_perm_b32 v177, v27, v26, s84
v_accvgpr_read_b32 v17, a140
v_mfma_f32_16x16x32_bf16 v[120:123], v[184:187], a[232:235], v[120:123]
v_perm_b32 v178, v29, v28, s84
v_accvgpr_read_b32 v18, a144
v_mfma_f32_16x16x32_bf16 v[124:127], v[184:187], a[236:239], v[124:127]
global_load_dwordx4 a[108:111], v32, s[82:83] offset:-1664
v_perm_b32 v179, v31, v30, s84
v_accvgpr_read_b32 v19, a148
v_mfma_f32_16x16x32_bf16 v[140:143], v[188:191], a[236:239], v[140:143]
v_perm_b32 v180, v25, v24, s85
v_accvgpr_read_b32 v20, a152
v_mfma_f32_16x16x32_bf16 v[136:139], v[188:191], a[232:235], v[136:139]
global_load_dwordx4 a[112:115], v32, s[82:83] offset:0
v_perm_b32 v181, v27, v26, s85
v_accvgpr_read_b32 v21, a156
v_mfma_f32_16x16x32_bf16 v[132:135], v[188:191], a[228:231], v[132:135]
v_perm_b32 v182, v29, v28, s85
v_accvgpr_read_b32 v22, a160
v_mfma_f32_16x16x32_bf16 v[128:131], v[188:191], a[224:227], v[128:131]
global_load_dwordx4 a[116:119], v32, s[82:83] offset:1664
v_perm_b32 v183, v31, v30, s85
v_accvgpr_read_b32 v23, a164
v_mfma_f32_16x16x32_bf16 v[144:147], v[176:179], a[224:227], v[144:147]
v_perm_b32 v184, v17, v16, s84
v_accvgpr_read_b32 v24, a137
v_mfma_f32_16x16x32_bf16 v[148:151], v[176:179], a[228:231], v[148:151]
global_load_dwordx4 a[120:123], v33, s[82:83] offset:-3328
v_perm_b32 v185, v19, v18, s84
v_accvgpr_read_b32 v25, a141
v_mfma_f32_16x16x32_bf16 v[152:155], v[176:179], a[232:235], v[152:155]
v_perm_b32 v186, v21, v20, s84
v_accvgpr_read_b32 v26, a145
v_mfma_f32_16x16x32_bf16 v[156:159], v[176:179], a[236:239], v[156:159]
global_load_dwordx4 a[124:127], v33, s[82:83] offset:-1664
v_perm_b32 v187, v23, v22, s84
v_accvgpr_read_b32 v27, a149
v_mfma_f32_16x16x32_bf16 v[172:175], v[180:183], a[236:239], v[172:175]
v_perm_b32 v188, v17, v16, s85
v_accvgpr_read_b32 v28, a153
v_mfma_f32_16x16x32_bf16 v[168:171], v[180:183], a[232:235], v[168:171]
global_load_dwordx4 a[128:131], v33, s[82:83] offset:0
v_perm_b32 v189, v19, v18, s85
v_accvgpr_read_b32 v29, a157
v_mfma_f32_16x16x32_bf16 v[164:167], v[180:183], a[228:231], v[164:167]
v_perm_b32 v190, v21, v20, s85
v_accvgpr_read_b32 v30, a161
v_mfma_f32_16x16x32_bf16 v[160:163], v[180:183], a[224:227], v[160:163]
s_waitcnt lgkmcnt(3)
global_load_dwordx4 a[132:135], v33, s[82:83] offset:1664
v_perm_b32 v191, v23, v22, s85
v_accvgpr_read_b32 v31, a165
v_mfma_f32_16x16x32_bf16 v[48:51], v[184:187], a[208:211], v[48:51]
s_waitcnt lgkmcnt(2)
ds_read_b128 a[224:227], v45 offset:0
v_perm_b32 v176, v25, v24, s84
v_accvgpr_read_b32 v16, a138
v_mfma_f32_16x16x32_bf16 v[52:55], v[184:187], a[212:215], v[52:55]
s_waitcnt lgkmcnt(2)
ds_read_b128 a[228:231], v45 offset:2048
v_perm_b32 v177, v27, v26, s84
v_accvgpr_read_b32 v17, a142
v_mfma_f32_16x16x32_bf16 v[56:59], v[184:187], a[216:219], v[56:59]
s_waitcnt lgkmcnt(2)
ds_read_b128 a[232:235], v45 offset:4096
v_perm_b32 v178, v29, v28, s84
v_accvgpr_read_b32 v18, a146
v_mfma_f32_16x16x32_bf16 v[60:63], v[184:187], a[220:223], v[60:63]
v_perm_b32 v179, v31, v30, s84
v_accvgpr_read_b32 v19, a150
v_mfma_f32_16x16x32_bf16 v[76:79], v[188:191], a[220:223], v[76:79]
ds_read_b128 a[236:239], v45 offset:6144
v_perm_b32 v180, v25, v24, s85
v_accvgpr_read_b32 v20, a154
v_mfma_f32_16x16x32_bf16 v[72:75], v[188:191], a[216:219], v[72:75]
v_perm_b32 v181, v27, v26, s85
v_accvgpr_read_b32 v21, a158
v_mfma_f32_16x16x32_bf16 v[68:71], v[188:191], a[212:215], v[68:71]
v_perm_b32 v182, v29, v28, s85
v_accvgpr_read_b32 v22, a162
v_mfma_f32_16x16x32_bf16 v[64:67], v[188:191], a[208:211], v[64:67]
v_perm_b32 v183, v31, v30, s85
v_accvgpr_read_b32 v23, a166
v_mfma_f32_16x16x32_bf16 v[80:83], v[176:179], a[208:211], v[80:83]
v_perm_b32 v184, v17, v16, s84
v_accvgpr_read_b32 v24, a139
v_mfma_f32_16x16x32_bf16 v[84:87], v[176:179], a[212:215], v[84:87]
v_perm_b32 v185, v19, v18, s84
v_accvgpr_read_b32 v25, a143
v_mfma_f32_16x16x32_bf16 v[88:91], v[176:179], a[216:219], v[88:91]
s_bitcmp1_b32 s24, 3
s_cbranch_scc0 Lsite3
s_add_u32 m0, s27, 8064
s_nop 0
global_load_lds_dwordx4 v9, s[36:37] offset:128
s_add_u32 m0, s27, 9088
s_nop 0
global_load_lds_dwordx4 v10, s[36:37] offset:128
s_add_u32 m0, s27, 10112
s_nop 0
global_load_lds_dwordx4 v9, s[38:39] offset:128
s_add_u32 m0, s27, 11136
s_nop 0
global_load_lds_dwordx4 v10, s[38:39] offset:128
s_add_u32 m0, s27, 12160
s_nop 0
global_load_lds_dwordx4 v9, s[40:41] offset:128
s_add_u32 m0, s27, 13184
s_nop 0
global_load_lds_dwordx4 v10, s[40:41] offset:128
s_add_u32 m0, s27, 14208
s_nop 0
global_load_lds_dwordx4 v9, s[42:43] offset:128
s_add_u32 m0, s27, 15232
s_nop 0
global_load_lds_dwordx4 v10, s[42:43] offset:128
Lsite3:
v_perm_b32 v186, v21, v20, s84
v_accvgpr_read_b32 v26, a147
v_mfma_f32_16x16x32_bf16 v[92:95], v[176:179], a[220:223], v[92:95]
v_perm_b32 v187, v23, v22, s84
v_accvgpr_read_b32 v27, a151
v_mfma_f32_16x16x32_bf16 v[108:111], v[180:183], a[220:223], v[108:111]
v_perm_b32 v188, v17, v16, s85
v_accvgpr_read_b32 v28, a155
v_mfma_f32_16x16x32_bf16 v[104:107], v[180:183], a[216:219], v[104:107]
v_perm_b32 v189, v19, v18, s85
v_accvgpr_read_b32 v29, a159
v_mfma_f32_16x16x32_bf16 v[100:103], v[180:183], a[212:215], v[100:103]
v_perm_b32 v190, v21, v20, s85
v_accvgpr_read_b32 v30, a163
v_mfma_f32_16x16x32_bf16 v[96:99], v[180:183], a[208:211], v[96:99]
v_perm_b32 v191, v23, v22, s85
v_accvgpr_read_b32 v31, a167
v_mfma_f32_16x16x32_bf16 v[112:115], v[184:187], a[208:211], v[112:115]
v_perm_b32 v176, v25, v24, s84
v_accvgpr_read_b32 v16, a168
v_mfma_f32_16x16x32_bf16 v[116:119], v[184:187], a[212:215], v[116:119]
s_add_u32 s82, s74, 106496
s_addc_u32 s83, s75, 0
global_load_dwordx4 a[136:139], v32, s[82:83] offset:-3328
v_perm_b32 v177, v27, v26, s84
v_accvgpr_read_b32 v17, a172
v_mfma_f32_16x16x32_bf16 v[120:123], v[184:187], a[216:219], v[120:123]
v_perm_b32 v178, v29, v28, s84
v_accvgpr_read_b32 v18, a176
v_mfma_f32_16x16x32_bf16 v[124:127], v[184:187], a[220:223], v[124:127]
global_load_dwordx4 a[140:143], v32, s[82:83] offset:-1664
v_perm_b32 v179, v31, v30, s84
v_accvgpr_read_b32 v19, a180
v_mfma_f32_16x16x32_bf16 v[140:143], v[188:191], a[220:223], v[140:143]
v_perm_b32 v180, v25, v24, s85
v_accvgpr_read_b32 v20, a184
v_mfma_f32_16x16x32_bf16 v[136:139], v[188:191], a[216:219], v[136:139]
global_load_dwordx4 a[144:147], v32, s[82:83] offset:0
v_perm_b32 v181, v27, v26, s85
v_accvgpr_read_b32 v21, a188
v_mfma_f32_16x16x32_bf16 v[132:135], v[188:191], a[212:215], v[132:135]
v_perm_b32 v182, v29, v28, s85
v_accvgpr_read_b32 v22, a192
v_mfma_f32_16x16x32_bf16 v[128:131], v[188:191], a[208:211], v[128:131]
global_load_dwordx4 a[148:151], v32, s[82:83] offset:1664
v_perm_b32 v183, v31, v30, s85
v_accvgpr_read_b32 v23, a196
v_mfma_f32_16x16x32_bf16 v[144:147], v[176:179], a[208:211], v[144:147]
v_perm_b32 v184, v17, v16, s84
v_accvgpr_read_b32 v24, a169
v_mfma_f32_16x16x32_bf16 v[148:151], v[176:179], a[212:215], v[148:151]
global_load_dwordx4 a[152:155], v33, s[82:83] offset:-3328
v_perm_b32 v185, v19, v18, s84
v_accvgpr_read_b32 v25, a173
v_mfma_f32_16x16x32_bf16 v[152:155], v[176:179], a[216:219], v[152:155]
v_perm_b32 v186, v21, v20, s84
v_accvgpr_read_b32 v26, a177
v_mfma_f32_16x16x32_bf16 v[156:159], v[176:179], a[220:223], v[156:159]
global_load_dwordx4 a[156:159], v33, s[82:83] offset:-1664
v_perm_b32 v187, v23, v22, s84
v_accvgpr_read_b32 v27, a181
v_mfma_f32_16x16x32_bf16 v[172:175], v[180:183], a[220:223], v[172:175]
v_perm_b32 v188, v17, v16, s85
v_accvgpr_read_b32 v28, a185
v_mfma_f32_16x16x32_bf16 v[168:171], v[180:183], a[216:219], v[168:171]
global_load_dwordx4 a[160:163], v33, s[82:83] offset:0
v_perm_b32 v189, v19, v18, s85
v_accvgpr_read_b32 v29, a189
v_mfma_f32_16x16x32_bf16 v[164:167], v[180:183], a[212:215], v[164:167]
v_perm_b32 v190, v21, v20, s85
v_accvgpr_read_b32 v30, a193
v_mfma_f32_16x16x32_bf16 v[160:163], v[180:183], a[208:211], v[160:163]
s_waitcnt lgkmcnt(3)
global_load_dwordx4 a[164:167], v33, s[82:83] offset:1664
v_perm_b32 v191, v23, v22, s85
v_accvgpr_read_b32 v31, a197
v_mfma_f32_16x16x32_bf16 v[48:51], v[184:187], a[224:227], v[48:51]
s_waitcnt lgkmcnt(2)
ds_read_b128 a[208:211], v46 offset:0
v_perm_b32 v176, v25, v24, s84
v_accvgpr_read_b32 v16, a170
v_mfma_f32_16x16x32_bf16 v[52:55], v[184:187], a[228:231], v[52:55]
s_waitcnt lgkmcnt(2)
ds_read_b128 a[212:215], v46 offset:2048
v_perm_b32 v177, v27, v26, s84
v_accvgpr_read_b32 v17, a174
v_mfma_f32_16x16x32_bf16 v[56:59], v[184:187], a[232:235], v[56:59]
s_waitcnt lgkmcnt(2)
ds_read_b128 a[216:219], v46 offset:4096
v_perm_b32 v178, v29, v28, s84
v_accvgpr_read_b32 v18, a178
v_mfma_f32_16x16x32_bf16 v[60:63], v[184:187], a[236:239], v[60:63]
v_perm_b32 v179, v31, v30, s84
v_accvgpr_read_b32 v19, a182
v_mfma_f32_16x16x32_bf16 v[76:79], v[188:191], a[236:239], v[76:79]
ds_read_b128 a[220:223], v46 offset:6144
v_perm_b32 v180, v25, v24, s85
v_accvgpr_read_b32 v20, a186
v_mfma_f32_16x16x32_bf16 v[72:75], v[188:191], a[232:235], v[72:75]
v_perm_b32 v181, v27, v26, s85
v_accvgpr_read_b32 v21, a190
v_mfma_f32_16x16x32_bf16 v[68:71], v[188:191], a[228:231], v[68:71]
v_perm_b32 v182, v29, v28, s85
v_accvgpr_read_b32 v22, a194
v_mfma_f32_16x16x32_bf16 v[64:67], v[188:191], a[224:227], v[64:67]
v_perm_b32 v183, v31, v30, s85
v_accvgpr_read_b32 v23, a198
v_mfma_f32_16x16x32_bf16 v[80:83], v[176:179], a[224:227], v[80:83]
v_perm_b32 v184, v17, v16, s84
v_accvgpr_read_b32 v24, a171
v_mfma_f32_16x16x32_bf16 v[84:87], v[176:179], a[228:231], v[84:87]
v_perm_b32 v185, v19, v18, s84
v_accvgpr_read_b32 v25, a175
v_mfma_f32_16x16x32_bf16 v[88:91], v[176:179], a[232:235], v[88:91]
v_perm_b32 v186, v21, v20, s84
v_accvgpr_read_b32 v26, a179
v_mfma_f32_16x16x32_bf16 v[92:95], v[176:179], a[236:239], v[92:95]
v_perm_b32 v187, v23, v22, s84
v_accvgpr_read_b32 v27, a183
v_mfma_f32_16x16x32_bf16 v[108:111], v[180:183], a[236:239], v[108:111]
v_perm_b32 v188, v17, v16, s85
v_accvgpr_read_b32 v28, a187
v_mfma_f32_16x16x32_bf16 v[104:107], v[180:183], a[232:235], v[104:107]
v_perm_b32 v189, v19, v18, s85
v_accvgpr_read_b32 v29, a191
v_mfma_f32_16x16x32_bf16 v[100:103], v[180:183], a[228:231], v[100:103]
v_perm_b32 v190, v21, v20, s85
v_accvgpr_read_b32 v30, a195
v_mfma_f32_16x16x32_bf16 v[96:99], v[180:183], a[224:227], v[96:99]
v_perm_b32 v191, v23, v22, s85
v_accvgpr_read_b32 v31, a199
v_mfma_f32_16x16x32_bf16 v[112:115], v[184:187], a[224:227], v[112:115]
v_perm_b32 v176, v25, v24, s84
v_mfma_f32_16x16x32_bf16 v[116:119], v[184:187], a[228:231], v[116:119]
s_add_u32 s82, s76, 106496
s_addc_u32 s83, s77, 0
global_load_dwordx4 a[168:171], v32, s[82:83] offset:-3328
v_perm_b32 v177, v27, v26, s84
v_mfma_f32_16x16x32_bf16 v[120:123], v[184:187], a[232:235], v[120:123]
v_perm_b32 v178, v29, v28, s84
v_mfma_f32_16x16x32_bf16 v[124:127], v[184:187], a[236:239], v[124:127]
global_load_dwordx4 a[172:175], v32, s[82:83] offset:-1664
v_perm_b32 v179, v31, v30, s84
v_mfma_f32_16x16x32_bf16 v[140:143], v[188:191], a[236:239], v[140:143]
v_perm_b32 v180, v25, v24, s85
v_mfma_f32_16x16x32_bf16 v[136:139], v[188:191], a[232:235], v[136:139]
global_load_dwordx4 a[176:179], v32, s[82:83] offset:0
v_perm_b32 v181, v27, v26, s85
v_mfma_f32_16x16x32_bf16 v[132:135], v[188:191], a[228:231], v[132:135]
v_perm_b32 v182, v29, v28, s85
v_mfma_f32_16x16x32_bf16 v[128:131], v[188:191], a[224:227], v[128:131]
global_load_dwordx4 a[180:183], v32, s[82:83] offset:1664
v_perm_b32 v183, v31, v30, s85
v_mfma_f32_16x16x32_bf16 v[144:147], v[176:179], a[224:227], v[144:147]
v_perm_b32 v184, v196, v192, s84
v_mfma_f32_16x16x32_bf16 v[148:151], v[176:179], a[228:231], v[148:151]
global_load_dwordx4 a[184:187], v33, s[82:83] offset:-3328
v_perm_b32 v185, v204, v200, s84
v_mfma_f32_16x16x32_bf16 v[152:155], v[176:179], a[232:235], v[152:155]
v_perm_b32 v186, v212, v208, s84
v_mfma_f32_16x16x32_bf16 v[156:159], v[176:179], a[236:239], v[156:159]
global_load_dwordx4 a[188:191], v33, s[82:83] offset:-1664
v_perm_b32 v187, v220, v216, s84
v_mfma_f32_16x16x32_bf16 v[172:175], v[180:183], a[236:239], v[172:175]
v_perm_b32 v188, v196, v192, s85
v_mfma_f32_16x16x32_bf16 v[168:171], v[180:183], a[232:235], v[168:171]
global_load_dwordx4 a[192:195], v33, s[82:83] offset:0
v_perm_b32 v189, v204, v200, s85
v_mfma_f32_16x16x32_bf16 v[164:167], v[180:183], a[228:231], v[164:167]
v_perm_b32 v190, v212, v208, s85
v_mfma_f32_16x16x32_bf16 v[160:163], v[180:183], a[224:227], v[160:163]
s_waitcnt lgkmcnt(3)
global_load_dwordx4 a[196:199], v33, s[82:83] offset:1664
v_perm_b32 v191, v220, v216, s85
v_mfma_f32_16x16x32_bf16 v[48:51], v[184:187], a[208:211], v[48:51]
s_waitcnt lgkmcnt(2)
ds_read_b128 a[224:227], v47 offset:0
v_perm_b32 v176, v197, v193, s84
v_mfma_f32_16x16x32_bf16 v[52:55], v[184:187], a[212:215], v[52:55]
s_waitcnt lgkmcnt(2)
ds_read_b128 a[228:231], v47 offset:2048
v_perm_b32 v177, v205, v201, s84
v_mfma_f32_16x16x32_bf16 v[56:59], v[184:187], a[216:219], v[56:59]
s_waitcnt lgkmcnt(2)
ds_read_b128 a[232:235], v47 offset:4096
v_perm_b32 v178, v213, v209, s84
v_mfma_f32_16x16x32_bf16 v[60:63], v[184:187], a[220:223], v[60:63]
v_perm_b32 v179, v221, v217, s84
v_mfma_f32_16x16x32_bf16 v[76:79], v[188:191], a[220:223], v[76:79]
ds_read_b128 a[236:239], v47 offset:6144
v_perm_b32 v180, v197, v193, s85
v_mfma_f32_16x16x32_bf16 v[72:75], v[188:191], a[216:219], v[72:75]
v_perm_b32 v181, v205, v201, s85
v_mfma_f32_16x16x32_bf16 v[68:71], v[188:191], a[212:215], v[68:71]
v_perm_b32 v182, v213, v209, s85
v_mfma_f32_16x16x32_bf16 v[64:67], v[188:191], a[208:211], v[64:67]
v_perm_b32 v183, v221, v217, s85
v_mfma_f32_16x16x32_bf16 v[80:83], v[176:179], a[208:211], v[80:83]
v_perm_b32 v184, v198, v194, s84
v_mfma_f32_16x16x32_bf16 v[84:87], v[176:179], a[212:215], v[84:87]
v_perm_b32 v185, v206, v202, s84
v_mfma_f32_16x16x32_bf16 v[88:91], v[176:179], a[216:219], v[88:91]
v_perm_b32 v186, v214, v210, s84
v_mfma_f32_16x16x32_bf16 v[92:95], v[176:179], a[220:223], v[92:95]
v_perm_b32 v187, v222, v218, s84
v_mfma_f32_16x16x32_bf16 v[108:111], v[180:183], a[220:223], v[108:111]
v_perm_b32 v188, v198, v194, s85
v_mfma_f32_16x16x32_bf16 v[104:107], v[180:183], a[216:219], v[104:107]
v_perm_b32 v189, v206, v202, s85
v_mfma_f32_16x16x32_bf16 v[100:103], v[180:183], a[212:215], v[100:103]
v_perm_b32 v190, v214, v210, s85
v_mfma_f32_16x16x32_bf16 v[96:99], v[180:183], a[208:211], v[96:99]
v_perm_b32 v191, v222, v218, s85
v_mfma_f32_16x16x32_bf16 v[112:115], v[184:187], a[208:211], v[112:115]
v_perm_b32 v176, v199, v195, s84
v_mfma_f32_16x16x32_bf16 v[116:119], v[184:187], a[212:215], v[116:119]
v_perm_b32 v177, v207, v203, s84
v_mfma_f32_16x16x32_bf16 v[120:123], v[184:187], a[216:219], v[120:123]
v_perm_b32 v178, v215, v211, s84
v_mfma_f32_16x16x32_bf16 v[124:127], v[184:187], a[220:223], v[124:127]
v_perm_b32 v179, v223, v219, s84
v_mfma_f32_16x16x32_bf16 v[140:143], v[188:191], a[220:223], v[140:143]
v_perm_b32 v180, v199, v195, s85
v_mfma_f32_16x16x32_bf16 v[136:139], v[188:191], a[216:219], v[136:139]
v_perm_b32 v181, v207, v203, s85
v_mfma_f32_16x16x32_bf16 v[132:135], v[188:191], a[212:215], v[132:135]
v_perm_b32 v182, v215, v211, s85
v_mfma_f32_16x16x32_bf16 v[128:131], v[188:191], a[208:211], v[128:131]
v_perm_b32 v183, v223, v219, s85
v_mfma_f32_16x16x32_bf16 v[144:147], v[176:179], a[208:211], v[144:147]
s_waitcnt vmcnt(24)
s_add_u32 s82, s78, 106496
s_addc_u32 s83, s79, 0
global_load_dwordx4 v[192:195], v32, s[82:83] offset:-3328
v_perm_b32 v184, v228, v224, s84
v_mfma_f32_16x16x32_bf16 v[148:151], v[176:179], a[212:215], v[148:151]
global_load_dwordx4 v[196:199], v32, s[82:83] offset:-1664
v_perm_b32 v185, v236, v232, s84
v_mfma_f32_16x16x32_bf16 v[152:155], v[176:179], a[216:219], v[152:155]
global_load_dwordx4 v[200:203], v32, s[82:83] offset:0
v_perm_b32 v186, v244, v240, s84
v_mfma_f32_16x16x32_bf16 v[156:159], v[176:179], a[220:223], v[156:159]
global_load_dwordx4 v[204:207], v32, s[82:83] offset:1664
v_perm_b32 v187, v252, v248, s84
v_mfma_f32_16x16x32_bf16 v[172:175], v[180:183], a[220:223], v[172:175]
global_load_dwordx4 v[208:211], v33, s[82:83] offset:-3328
v_perm_b32 v188, v228, v224, s85
v_mfma_f32_16x16x32_bf16 v[168:171], v[180:183], a[216:219], v[168:171]
global_load_dwordx4 v[212:215], v33, s[82:83] offset:-1664
v_perm_b32 v189, v236, v232, s85
v_mfma_f32_16x16x32_bf16 v[164:167], v[180:183], a[212:215], v[164:167]
global_load_dwordx4 v[216:219], v33, s[82:83] offset:0
v_perm_b32 v190, v244, v240, s85
v_mfma_f32_16x16x32_bf16 v[160:163], v[180:183], a[208:211], v[160:163]
s_waitcnt vmcnt(23) lgkmcnt(3)
global_load_dwordx4 v[220:223], v33, s[82:83] offset:1664
v_perm_b32 v191, v252, v248, s85
v_mfma_f32_16x16x32_bf16 v[48:51], v[184:187], a[224:227], v[48:51]
s_waitcnt lgkmcnt(2)
ds_read_b128 a[208:211], v3 offset:8192
v_perm_b32 v176, v229, v225, s84
v_mfma_f32_16x16x32_bf16 v[52:55], v[184:187], a[228:231], v[52:55]
s_waitcnt lgkmcnt(2)
ds_read_b128 a[212:215], v3 offset:10240
v_perm_b32 v177, v237, v233, s84
v_mfma_f32_16x16x32_bf16 v[56:59], v[184:187], a[232:235], v[56:59]
s_waitcnt lgkmcnt(2)
ds_read_b128 a[216:219], v3 offset:12288
v_perm_b32 v178, v245, v241, s84
v_mfma_f32_16x16x32_bf16 v[60:63], v[184:187], a[236:239], v[60:63]
v_perm_b32 v179, v253, v249, s84
v_mfma_f32_16x16x32_bf16 v[76:79], v[188:191], a[236:239], v[76:79]
ds_read_b128 a[220:223], v3 offset:14336
v_perm_b32 v180, v229, v225, s85
v_mfma_f32_16x16x32_bf16 v[72:75], v[188:191], a[232:235], v[72:75]
v_perm_b32 v181, v237, v233, s85
v_mfma_f32_16x16x32_bf16 v[68:71], v[188:191], a[228:231], v[68:71]
v_perm_b32 v182, v245, v241, s85
v_mfma_f32_16x16x32_bf16 v[64:67], v[188:191], a[224:227], v[64:67]
v_perm_b32 v183, v253, v249, s85
v_mfma_f32_16x16x32_bf16 v[80:83], v[176:179], a[224:227], v[80:83]
v_perm_b32 v184, v230, v226, s84
v_mfma_f32_16x16x32_bf16 v[84:87], v[176:179], a[228:231], v[84:87]
v_perm_b32 v185, v238, v234, s84
v_mfma_f32_16x16x32_bf16 v[88:91], v[176:179], a[232:235], v[88:91]
s_bitcmp1_b32 s24, 4
s_cbranch_scc0 Lsite4
s_add_u32 m0, s27, 16128
s_nop 0
global_load_lds_dwordx4 v9, s[36:37] offset:256
s_add_u32 m0, s27, 17152
s_nop 0
global_load_lds_dwordx4 v10, s[36:37] offset:256
s_add_u32 m0, s27, 18176
s_nop 0
global_load_lds_dwordx4 v9, s[38:39] offset:256
s_add_u32 m0, s27, 19200
s_nop 0
global_load_lds_dwordx4 v10, s[38:39] offset:256
s_add_u32 m0, s27, 20224
s_nop 0
global_load_lds_dwordx4 v9, s[40:41] offset:256
s_add_u32 m0, s27, 21248
s_nop 0
global_load_lds_dwordx4 v10, s[40:41] offset:256
s_add_u32 m0, s27, 22272
s_nop 0
global_load_lds_dwordx4 v9, s[42:43] offset:256
s_add_u32 m0, s27, 23296
s_nop 0
global_load_lds_dwordx4 v10, s[42:43] offset:256
s_add_u32 m0, s34, 0
s_nop 0
global_load_lds_dwordx4 v9, s[44:45]
s_add_u32 m0, s34, 1024
s_nop 0
global_load_lds_dwordx4 v10, s[44:45]
Lsite4:
v_perm_b32 v186, v246, v242, s84
v_mfma_f32_16x16x32_bf16 v[92:95], v[176:179], a[236:239], v[92:95]
v_perm_b32 v187, v254, v250, s84
v_mfma_f32_16x16x32_bf16 v[108:111], v[180:183], a[236:239], v[108:111]
v_perm_b32 v188, v230, v226, s85
v_mfma_f32_16x16x32_bf16 v[104:107], v[180:183], a[232:235], v[104:107]
v_perm_b32 v189, v238, v234, s85
v_mfma_f32_16x16x32_bf16 v[100:103], v[180:183], a[228:231], v[100:103]
v_perm_b32 v190, v246, v242, s85
v_mfma_f32_16x16x32_bf16 v[96:99], v[180:183], a[224:227], v[96:99]
v_perm_b32 v191, v254, v250, s85
v_mfma_f32_16x16x32_bf16 v[112:115], v[184:187], a[224:227], v[112:115]
s_waitcnt vmcnt(24)
v_perm_b32 v176, v231, v227, s84
v_accvgpr_read_b32 v16, a104
v_mfma_f32_16x16x32_bf16 v[116:119], v[184:187], a[228:231], v[116:119]
v_perm_b32 v177, v239, v235, s84
v_accvgpr_read_b32 v17, a108
v_mfma_f32_16x16x32_bf16 v[120:123], v[184:187], a[232:235], v[120:123]
v_perm_b32 v178, v247, v243, s84
v_accvgpr_read_b32 v18, a112
v_mfma_f32_16x16x32_bf16 v[124:127], v[184:187], a[236:239], v[124:127]
v_perm_b32 v179, v255, v251, s84
v_accvgpr_read_b32 v19, a116
v_mfma_f32_16x16x32_bf16 v[140:143], v[188:191], a[236:239], v[140:143]
v_perm_b32 v180, v231, v227, s85
v_accvgpr_read_b32 v20, a120
v_mfma_f32_16x16x32_bf16 v[136:139], v[188:191], a[232:235], v[136:139]
v_perm_b32 v181, v239, v235, s85
v_accvgpr_read_b32 v21, a124
v_mfma_f32_16x16x32_bf16 v[132:135], v[188:191], a[228:231], v[132:135]
v_perm_b32 v182, v247, v243, s85
v_accvgpr_read_b32 v22, a128
v_mfma_f32_16x16x32_bf16 v[128:131], v[188:191], a[224:227], v[128:131]
v_perm_b32 v183, v255, v251, s85
v_accvgpr_read_b32 v23, a132
v_mfma_f32_16x16x32_bf16 v[144:147], v[176:179], a[224:227], v[144:147]
s_add_u32 s82, s72, 159744
s_addc_u32 s83, s73, 0
global_load_dwordx4 v[224:227], v32, s[82:83] offset:-3328
v_perm_b32 v184, v17, v16, s84
v_accvgpr_read_b32 v24, a105
v_mfma_f32_16x16x32_bf16 v[148:151], v[176:179], a[228:231], v[148:151]
global_load_dwordx4 v[228:231], v32, s[82:83] offset:-1664
v_perm_b32 v185, v19, v18, s84
v_accvgpr_read_b32 v25, a109
v_mfma_f32_16x16x32_bf16 v[152:155], v[176:179], a[232:235], v[152:155]
global_load_dwordx4 v[232:235], v32, s[82:83] offset:0
v_perm_b32 v186, v21, v20, s84
v_accvgpr_read_b32 v26, a113
v_mfma_f32_16x16x32_bf16 v[156:159], v[176:179], a[236:239], v[156:159]
global_load_dwordx4 v[236:239], v32, s[82:83] offset:1664
v_perm_b32 v187, v23, v22, s84
v_accvgpr_read_b32 v27, a117
v_mfma_f32_16x16x32_bf16 v[172:175], v[180:183], a[236:239], v[172:175]
global_load_dwordx4 v[240:243], v33, s[82:83] offset:-3328
v_perm_b32 v188, v17, v16, s85
v_accvgpr_read_b32 v28, a121
v_mfma_f32_16x16x32_bf16 v[168:171], v[180:183], a[232:235], v[168:171]
global_load_dwordx4 v[244:247], v33, s[82:83] offset:-1664
v_perm_b32 v189, v19, v18, s85
v_accvgpr_read_b32 v29, a125
v_mfma_f32_16x16x32_bf16 v[164:167], v[180:183], a[228:231], v[164:167]
global_load_dwordx4 v[248:251], v33, s[82:83] offset:0
v_perm_b32 v190, v21, v20, s85
v_accvgpr_read_b32 v30, a129
v_mfma_f32_16x16x32_bf16 v[160:163], v[180:183], a[224:227], v[160:163]
s_waitcnt lgkmcnt(3)
s_barrier
global_load_dwordx4 v[252:255], v33, s[82:83] offset:1664
v_perm_b32 v191, v23, v22, s85
v_accvgpr_read_b32 v31, a133
v_mfma_f32_16x16x32_bf16 v[48:51], v[184:187], a[208:211], v[48:51]
s_waitcnt lgkmcnt(2)
ds_read_b128 a[224:227], v4 offset:8192
v_perm_b32 v176, v25, v24, s84
v_accvgpr_read_b32 v16, a106
v_mfma_f32_16x16x32_bf16 v[52:55], v[184:187], a[212:215], v[52:55]
s_waitcnt lgkmcnt(2)
ds_read_b128 a[228:231], v4 offset:10240
v_perm_b32 v177, v27, v26, s84
v_accvgpr_read_b32 v17, a110
v_mfma_f32_16x16x32_bf16 v[56:59], v[184:187], a[216:219], v[56:59]
s_waitcnt lgkmcnt(2)
ds_read_b128 a[232:235], v4 offset:12288
v_perm_b32 v178, v29, v28, s84
v_accvgpr_read_b32 v18, a114
v_mfma_f32_16x16x32_bf16 v[60:63], v[184:187], a[220:223], v[60:63]
v_perm_b32 v179, v31, v30, s84
v_accvgpr_read_b32 v19, a118
v_mfma_f32_16x16x32_bf16 v[76:79], v[188:191], a[220:223], v[76:79]
ds_read_b128 a[236:239], v4 offset:14336
v_perm_b32 v180, v25, v24, s85
v_accvgpr_read_b32 v20, a122
v_mfma_f32_16x16x32_bf16 v[72:75], v[188:191], a[216:219], v[72:75]
v_perm_b32 v181, v27, v26, s85
v_accvgpr_read_b32 v21, a126
v_mfma_f32_16x16x32_bf16 v[68:71], v[188:191], a[212:215], v[68:71]
v_perm_b32 v182, v29, v28, s85
v_accvgpr_read_b32 v22, a130
v_mfma_f32_16x16x32_bf16 v[64:67], v[188:191], a[208:211], v[64:67]
v_perm_b32 v183, v31, v30, s85
v_accvgpr_read_b32 v23, a134
v_mfma_f32_16x16x32_bf16 v[80:83], v[176:179], a[208:211], v[80:83]
ds_read_b128 a[0:3], v40 offset:0
v_perm_b32 v184, v17, v16, s84
v_accvgpr_read_b32 v24, a107
v_mfma_f32_16x16x32_bf16 v[84:87], v[176:179], a[212:215], v[84:87]
v_perm_b32 v185, v19, v18, s84
v_accvgpr_read_b32 v25, a111
v_mfma_f32_16x16x32_bf16 v[88:91], v[176:179], a[216:219], v[88:91]
v_perm_b32 v186, v21, v20, s84
v_accvgpr_read_b32 v26, a115
v_mfma_f32_16x16x32_bf16 v[92:95], v[176:179], a[220:223], v[92:95]
v_perm_b32 v187, v23, v22, s84
v_accvgpr_read_b32 v27, a119
v_mfma_f32_16x16x32_bf16 v[108:111], v[180:183], a[220:223], v[108:111]
ds_read_b128 a[4:7], v40 offset:2048
v_perm_b32 v188, v17, v16, s85
v_accvgpr_read_b32 v28, a123
v_mfma_f32_16x16x32_bf16 v[104:107], v[180:183], a[216:219], v[104:107]
v_perm_b32 v189, v19, v18, s85
v_accvgpr_read_b32 v29, a127
v_mfma_f32_16x16x32_bf16 v[100:103], v[180:183], a[212:215], v[100:103]
v_perm_b32 v190, v21, v20, s85
v_accvgpr_read_b32 v30, a131
v_mfma_f32_16x16x32_bf16 v[96:99], v[180:183], a[208:211], v[96:99]
v_perm_b32 v191, v23, v22, s85
v_accvgpr_read_b32 v31, a135
v_mfma_f32_16x16x32_bf16 v[112:115], v[184:187], a[208:211], v[112:115]
s_waitcnt vmcnt(24)
ds_read_b128 a[8:11], v40 offset:4096
v_perm_b32 v176, v25, v24, s84
v_accvgpr_read_b32 v16, a136
v_mfma_f32_16x16x32_bf16 v[116:119], v[184:187], a[212:215], v[116:119]
s_add_u32 s82, s74, 159744
s_addc_u32 s83, s75, 0
global_load_dwordx4 a[104:107], v32, s[82:83] offset:-3328
v_perm_b32 v177, v27, v26, s84
v_accvgpr_read_b32 v17, a140
v_mfma_f32_16x16x32_bf16 v[120:123], v[184:187], a[216:219], v[120:123]
v_perm_b32 v178, v29, v28, s84
v_accvgpr_read_b32 v18, a144
v_mfma_f32_16x16x32_bf16 v[124:127], v[184:187], a[220:223], v[124:127]
global_load_dwordx4 a[108:111], v32, s[82:83] offset:-1664
v_perm_b32 v179, v31, v30, s84
v_accvgpr_read_b32 v19, a148
v_mfma_f32_16x16x32_bf16 v[140:143], v[188:191], a[220:223], v[140:143]
ds_read_b128 a[12:15], v40 offset:6144
v_perm_b32 v180, v25, v24, s85
v_accvgpr_read_b32 v20, a152
v_mfma_f32_16x16x32_bf16 v[136:139], v[188:191], a[216:219], v[136:139]
global_load_dwordx4 a[112:115], v32, s[82:83] offset:0
v_perm_b32 v181, v27, v26, s85
v_accvgpr_read_b32 v21, a156
v_mfma_f32_16x16x32_bf16 v[132:135], v[188:191], a[212:215], v[132:135]
v_perm_b32 v182, v29, v28, s85
v_accvgpr_read_b32 v22, a160
v_mfma_f32_16x16x32_bf16 v[128:131], v[188:191], a[208:211], v[128:131]
global_load_dwordx4 a[116:119], v32, s[82:83] offset:1664
v_perm_b32 v183, v31, v30, s85
v_accvgpr_read_b32 v23, a164
v_mfma_f32_16x16x32_bf16 v[144:147], v[176:179], a[208:211], v[144:147]
v_perm_b32 v184, v17, v16, s84
v_accvgpr_read_b32 v24, a137
v_mfma_f32_16x16x32_bf16 v[148:151], v[176:179], a[212:215], v[148:151]
global_load_dwordx4 a[120:123], v33, s[82:83] offset:-3328
v_perm_b32 v185, v19, v18, s84
v_accvgpr_read_b32 v25, a141
v_mfma_f32_16x16x32_bf16 v[152:155], v[176:179], a[216:219], v[152:155]
v_perm_b32 v186, v21, v20, s84
v_accvgpr_read_b32 v26, a145
v_mfma_f32_16x16x32_bf16 v[156:159], v[176:179], a[220:223], v[156:159]
global_load_dwordx4 a[124:127], v33, s[82:83] offset:-1664
v_perm_b32 v187, v23, v22, s84
v_accvgpr_read_b32 v27, a149
v_mfma_f32_16x16x32_bf16 v[172:175], v[180:183], a[220:223], v[172:175]
v_perm_b32 v188, v17, v16, s85
v_accvgpr_read_b32 v28, a153
v_mfma_f32_16x16x32_bf16 v[168:171], v[180:183], a[216:219], v[168:171]
global_load_dwordx4 a[128:131], v33, s[82:83] offset:0
v_perm_b32 v189, v19, v18, s85
v_accvgpr_read_b32 v29, a157
v_mfma_f32_16x16x32_bf16 v[164:167], v[180:183], a[212:215], v[164:167]
v_perm_b32 v190, v21, v20, s85
v_accvgpr_read_b32 v30, a161
v_mfma_f32_16x16x32_bf16 v[160:163], v[180:183], a[208:211], v[160:163]
s_waitcnt lgkmcnt(7)
s_barrier
s_bitcmp1_b32 s24, 10
s_cbranch_scc0 Lsig
s_and_b32 s16, s2, 15
s_lshl_b32 s16, s16, 4
v_mov_b32 v34, s16
v_mov_b32 v35, 1
s_mov_b64 exec, 1
global_atomic_add v34, v35, s[12:13] sc1
s_mov_b64 exec, -1
s_nop 3
Lsig:
global_load_dwordx4 a[132:135], v33, s[82:83] offset:1664
v_perm_b32 v191, v23, v22, s85
v_accvgpr_read_b32 v31, a165
v_mfma_f32_16x16x32_bf16 v[48:51], v[184:187], a[224:227], v[48:51]
s_waitcnt lgkmcnt(6)
ds_read_b128 a[208:211], v5 offset:8192
v_perm_b32 v176, v25, v24, s84
v_accvgpr_read_b32 v16, a138
v_mfma_f32_16x16x32_bf16 v[52:55], v[184:187], a[228:231], v[52:55]
s_waitcnt lgkmcnt(6)
ds_read_b128 a[212:215], v5 offset:10240
v_perm_b32 v177, v27, v26, s84
v_accvgpr_read_b32 v17, a142
v_mfma_f32_16x16x32_bf16 v[56:59], v[184:187], a[232:235], v[56:59]
s_waitcnt lgkmcnt(6)
ds_read_b128 a[216:219], v5 offset:12288
v_perm_b32 v178, v29, v28, s84
v_accvgpr_read_b32 v18, a146
v_mfma_f32_16x16x32_bf16 v[60:63], v[184:187], a[236:239], v[60:63]
v_perm_b32 v179, v31, v30, s84
v_accvgpr_read_b32 v19, a150
v_mfma_f32_16x16x32_bf16 v[76:79], v[188:191], a[236:239], v[76:79]
ds_read_b128 a[220:223], v5 offset:14336
v_perm_b32 v180, v25, v24, s85
v_accvgpr_read_b32 v20, a154
v_mfma_f32_16x16x32_bf16 v[72:75], v[188:191], a[232:235], v[72:75]
v_perm_b32 v181, v27, v26, s85
v_accvgpr_read_b32 v21, a158
v_mfma_f32_16x16x32_bf16 v[68:71], v[188:191], a[228:231], v[68:71]
v_perm_b32 v182, v29, v28, s85
v_accvgpr_read_b32 v22, a162
v_mfma_f32_16x16x32_bf16 v[64:67], v[188:191], a[224:227], v[64:67]
v_perm_b32 v183, v31, v30, s85
v_accvgpr_read_b32 v23, a166
v_mfma_f32_16x16x32_bf16 v[80:83], v[176:179], a[224:227], v[80:83]
ds_read_b128 a[16:19], v41 offset:0
v_perm_b32 v184, v17, v16, s84
v_accvgpr_read_b32 v24, a139
v_mfma_f32_16x16x32_bf16 v[84:87], v[176:179], a[228:231], v[84:87]
v_perm_b32 v185, v19, v18, s84
v_accvgpr_read_b32 v25, a143
v_mfma_f32_16x16x32_bf16 v[88:91], v[176:179], a[232:235], v[88:91]
s_bitcmp1_b32 s24, 5
s_cbranch_scc0 Lsite5
s_add_u32 m0, s27, 16128
s_nop 0
global_load_lds_dwordx4 v9, s[36:37] offset:256
s_add_u32 m0, s27, 17152
s_nop 0
global_load_lds_dwordx4 v10, s[36:37] offset:256
s_add_u32 m0, s27, 18176
s_nop 0
global_load_lds_dwordx4 v9, s[38:39] offset:256
s_add_u32 m0, s27, 19200
s_nop 0
global_load_lds_dwordx4 v10, s[38:39] offset:256
s_add_u32 m0, s27, 20224
s_nop 0
global_load_lds_dwordx4 v9, s[40:41] offset:256
s_add_u32 m0, s27, 21248
s_nop 0
global_load_lds_dwordx4 v10, s[40:41] offset:256
s_add_u32 m0, s27, 22272
s_nop 0
global_load_lds_dwordx4 v9, s[42:43] offset:256
s_add_u32 m0, s27, 23296
s_nop 0
global_load_lds_dwordx4 v10, s[42:43] offset:256
s_add_u32 m0, s34, 0
s_nop 0
global_load_lds_dwordx4 v9, s[44:45]
s_add_u32 m0, s34, 1024
s_nop 0
global_load_lds_dwordx4 v10, s[44:45]
Lsite5:
v_perm_b32 v186, v21, v20, s84
v_accvgpr_read_b32 v26, a147
v_mfma_f32_16x16x32_bf16 v[92:95], v[176:179], a[236:239], v[92:95]
v_perm_b32 v187, v23, v22, s84
v_accvgpr_read_b32 v27, a151
v_mfma_f32_16x16x32_bf16 v[108:111], v[180:183], a[236:239], v[108:111]
ds_read_b128 a[20:23], v41 offset:2048
v_perm_b32 v188, v17, v16, s85
v_accvgpr_read_b32 v28, a155
v_mfma_f32_16x16x32_bf16 v[104:107], v[180:183], a[232:235], v[104:107]
v_perm_b32 v189, v19, v18, s85
v_accvgpr_read_b32 v29, a159
v_mfma_f32_16x16x32_bf16 v[100:103], v[180:183], a[228:231], v[100:103]
v_perm_b32 v190, v21, v20, s85
v_accvgpr_read_b32 v30, a163
v_mfma_f32_16x16x32_bf16 v[96:99], v[180:183], a[224:227], v[96:99]
v_perm_b32 v191, v23, v22, s85
v_accvgpr_read_b32 v31, a167
v_mfma_f32_16x16x32_bf16 v[112:115], v[184:187], a[224:227], v[112:115]
s_waitcnt vmcnt(24)
ds_read_b128 a[24:27], v41 offset:4096
v_perm_b32 v176, v25, v24, s84
v_accvgpr_read_b32 v16, a168
v_mfma_f32_16x16x32_bf16 v[116:119], v[184:187], a[228:231], v[116:119]
s_add_u32 s82, s76, 159744
s_addc_u32 s83, s77, 0
global_load_dwordx4 a[136:139], v32, s[82:83] offset:-3328
v_perm_b32 v177, v27, v26, s84
v_accvgpr_read_b32 v17, a172
v_mfma_f32_16x16x32_bf16 v[120:123], v[184:187], a[232:235], v[120:123]
v_perm_b32 v178, v29, v28, s84
v_accvgpr_read_b32 v18, a176
v_mfma_f32_16x16x32_bf16 v[124:127], v[184:187], a[236:239], v[124:127]
global_load_dwordx4 a[140:143], v32, s[82:83] offset:-1664
v_perm_b32 v179, v31, v30, s84
v_accvgpr_read_b32 v19, a180
v_mfma_f32_16x16x32_bf16 v[140:143], v[188:191], a[236:239], v[140:143]
ds_read_b128 a[28:31], v41 offset:6144
v_perm_b32 v180, v25, v24, s85
v_accvgpr_read_b32 v20, a184
v_mfma_f32_16x16x32_bf16 v[136:139], v[188:191], a[232:235], v[136:139]
global_load_dwordx4 a[144:147], v32, s[82:83] offset:0
v_perm_b32 v181, v27, v26, s85
v_accvgpr_read_b32 v21, a188
v_mfma_f32_16x16x32_bf16 v[132:135], v[188:191], a[228:231], v[132:135]
v_perm_b32 v182, v29, v28, s85
v_accvgpr_read_b32 v22, a192
v_mfma_f32_16x16x32_bf16 v[128:131], v[188:191], a[224:227], v[128:131]
global_load_dwordx4 a[148:151], v32, s[82:83] offset:1664
v_perm_b32 v183, v31, v30, s85
v_accvgpr_read_b32 v23, a196
v_mfma_f32_16x16x32_bf16 v[144:147], v[176:179], a[224:227], v[144:147]
v_perm_b32 v184, v17, v16, s84
v_accvgpr_read_b32 v24, a169
v_mfma_f32_16x16x32_bf16 v[148:151], v[176:179], a[228:231], v[148:151]
global_load_dwordx4 a[152:155], v33, s[82:83] offset:-3328
v_perm_b32 v185, v19, v18, s84
v_accvgpr_read_b32 v25, a173
v_mfma_f32_16x16x32_bf16 v[152:155], v[176:179], a[232:235], v[152:155]
v_perm_b32 v186, v21, v20, s84
v_accvgpr_read_b32 v26, a177
v_mfma_f32_16x16x32_bf16 v[156:159], v[176:179], a[236:239], v[156:159]
global_load_dwordx4 a[156:159], v33, s[82:83] offset:-1664
v_perm_b32 v187, v23, v22, s84
v_accvgpr_read_b32 v27, a181
v_mfma_f32_16x16x32_bf16 v[172:175], v[180:183], a[236:239], v[172:175]
v_perm_b32 v188, v17, v16, s85
v_accvgpr_read_b32 v28, a185
v_mfma_f32_16x16x32_bf16 v[168:171], v[180:183], a[232:235], v[168:171]
global_load_dwordx4 a[160:163], v33, s[82:83] offset:0
v_perm_b32 v189, v19, v18, s85
v_accvgpr_read_b32 v29, a189
v_mfma_f32_16x16x32_bf16 v[164:167], v[180:183], a[228:231], v[164:167]
v_perm_b32 v190, v21, v20, s85
v_accvgpr_read_b32 v30, a193
v_mfma_f32_16x16x32_bf16 v[160:163], v[180:183], a[224:227], v[160:163]
s_waitcnt lgkmcnt(7)
global_load_dwordx4 a[164:167], v33, s[82:83] offset:1664
v_perm_b32 v191, v23, v22, s85
v_accvgpr_read_b32 v31, a197
v_mfma_f32_16x16x32_bf16 v[48:51], v[184:187], a[208:211], v[48:51]
s_waitcnt lgkmcnt(6)
ds_read_b128 a[224:227], v6 offset:8192
v_perm_b32 v176, v25, v24, s84
v_accvgpr_read_b32 v16, a170
v_mfma_f32_16x16x32_bf16 v[52:55], v[184:187], a[212:215], v[52:55]
s_waitcnt lgkmcnt(6)
ds_read_b128 a[228:231], v6 offset:10240
v_perm_b32 v177, v27, v26, s84
v_accvgpr_read_b32 v17, a174
v_mfma_f32_16x16x32_bf16 v[56:59], v[184:187], a[216:219], v[56:59]
s_waitcnt lgkmcnt(6)
ds_read_b128 a[232:235], v6 offset:12288
v_perm_b32 v178, v29, v28, s84
v_accvgpr_read_b32 v18, a178
v_mfma_f32_16x16x32_bf16 v[60:63], v[184:187], a[220:223], v[60:63]
v_perm_b32 v179, v31, v30, s84
v_accvgpr_read_b32 v19, a182
v_mfma_f32_16x16x32_bf16 v[76:79], v[188:191], a[220:223], v[76:79]
ds_read_b128 a[236:239], v6 offset:14336
v_perm_b32 v180, v25, v24, s85
v_accvgpr_read_b32 v20, a186
v_mfma_f32_16x16x32_bf16 v[72:75], v[188:191], a[216:219], v[72:75]
v_perm_b32 v181, v27, v26, s85
v_accvgpr_read_b32 v21, a190
v_mfma_f32_16x16x32_bf16 v[68:71], v[188:191], a[212:215], v[68:71]
v_perm_b32 v182, v29, v28, s85
v_accvgpr_read_b32 v22, a194
v_mfma_f32_16x16x32_bf16 v[64:67], v[188:191], a[208:211], v[64:67]
v_perm_b32 v183, v31, v30, s85
v_accvgpr_read_b32 v23, a198
v_mfma_f32_16x16x32_bf16 v[80:83], v[176:179], a[208:211], v[80:83]
ds_read_b128 a[32:35], v42 offset:0
v_perm_b32 v184, v17, v16, s84
v_accvgpr_read_b32 v24, a171
v_mfma_f32_16x16x32_bf16 v[84:87], v[176:179], a[212:215], v[84:87]
v_perm_b32 v185, v19, v18, s84
v_accvgpr_read_b32 v25, a175
v_mfma_f32_16x16x32_bf16 v[88:91], v[176:179], a[216:219], v[88:91]
v_perm_b32 v186, v21, v20, s84
v_accvgpr_read_b32 v26, a179
v_mfma_f32_16x16x32_bf16 v[92:95], v[176:179], a[220:223], v[92:95]
v_perm_b32 v187, v23, v22, s84
v_accvgpr_read_b32 v27, a183
v_mfma_f32_16x16x32_bf16 v[108:111], v[180:183], a[220:223], v[108:111]
ds_read_b128 a[36:39], v42 offset:2048
v_perm_b32 v188, v17, v16, s85
v_accvgpr_read_b32 v28, a187
v_mfma_f32_16x16x32_bf16 v[104:107], v[180:183], a[216:219], v[104:107]
v_perm_b32 v189, v19, v18, s85
v_accvgpr_read_b32 v29, a191
v_mfma_f32_16x16x32_bf16 v[100:103], v[180:183], a[212:215], v[100:103]
v_perm_b32 v190, v21, v20, s85
v_accvgpr_read_b32 v30, a195
v_mfma_f32_16x16x32_bf16 v[96:99], v[180:183], a[208:211], v[96:99]
v_perm_b32 v191, v23, v22, s85
v_accvgpr_read_b32 v31, a199
v_mfma_f32_16x16x32_bf16 v[112:115], v[184:187], a[208:211], v[112:115]
ds_read_b128 a[40:43], v42 offset:4096
v_perm_b32 v176, v25, v24, s84
v_mfma_f32_16x16x32_bf16 v[116:119], v[184:187], a[212:215], v[116:119]
s_add_u32 s82, s78, 159744
s_addc_u32 s83, s79, 0
global_load_dwordx4 a[168:171], v32, s[82:83] offset:-3328
v_perm_b32 v177, v27, v26, s84
v_mfma_f32_16x16x32_bf16 v[120:123], v[184:187], a[216:219], v[120:123]
v_perm_b32 v178, v29, v28, s84
v_mfma_f32_16x16x32_bf16 v[124:127], v[184:187], a[220:223], v[124:127]
global_load_dwordx4 a[172:175], v32, s[82:83] offset:-1664
v_perm_b32 v179, v31, v30, s84
v_mfma_f32_16x16x32_bf16 v[140:143], v[188:191], a[220:223], v[140:143]
ds_read_b128 a[44:47], v42 offset:6144
v_perm_b32 v180, v25, v24, s85
v_mfma_f32_16x16x32_bf16 v[136:139], v[188:191], a[216:219], v[136:139]
global_load_dwordx4 a[176:179], v32, s[82:83] offset:0
v_perm_b32 v181, v27, v26, s85
v_mfma_f32_16x16x32_bf16 v[132:135], v[188:191], a[212:215], v[132:135]
v_perm_b32 v182, v29, v28, s85
v_mfma_f32_16x16x32_bf16 v[128:131], v[188:191], a[208:211], v[128:131]
global_load_dwordx4 a[180:183], v32, s[82:83] offset:1664
v_perm_b32 v183, v31, v30, s85
v_mfma_f32_16x16x32_bf16 v[144:147], v[176:179], a[208:211], v[144:147]
s_waitcnt vmcnt(28)
v_perm_b32 v184, v196, v192, s84
v_mfma_f32_16x16x32_bf16 v[148:151], v[176:179], a[212:215], v[148:151]
global_load_dwordx4 a[184:187], v33, s[82:83] offset:-3328
v_perm_b32 v185, v204, v200, s84
v_mfma_f32_16x16x32_bf16 v[152:155], v[176:179], a[216:219], v[152:155]
v_perm_b32 v186, v212, v208, s84
v_mfma_f32_16x16x32_bf16 v[156:159], v[176:179], a[220:223], v[156:159]
global_load_dwordx4 a[188:191], v33, s[82:83] offset:-1664
v_perm_b32 v187, v220, v216, s84
v_mfma_f32_16x16x32_bf16 v[172:175], v[180:183], a[220:223], v[172:175]
v_perm_b32 v188, v196, v192, s85
v_mfma_f32_16x16x32_bf16 v[168:171], v[180:183], a[216:219], v[168:171]
global_load_dwordx4 a[192:195], v33, s[82:83] offset:0
v_perm_b32 v189, v204, v200, s85
v_mfma_f32_16x16x32_bf16 v[164:167], v[180:183], a[212:215], v[164:167]
v_perm_b32 v190, v212, v208, s85
v_mfma_f32_16x16x32_bf16 v[160:163], v[180:183], a[208:211], v[160:163]
s_waitcnt lgkmcnt(7)
global_load_dwordx4 a[196:199], v33, s[82:83] offset:1664
v_perm_b32 v191, v220, v216, s85
v_mfma_f32_16x16x32_bf16 v[48:51], v[184:187], a[224:227], v[48:51]
s_waitcnt lgkmcnt(6)
ds_read_b128 a[208:211], v44 offset:8192
v_perm_b32 v176, v197, v193, s84
v_mfma_f32_16x16x32_bf16 v[52:55], v[184:187], a[228:231], v[52:55]
s_waitcnt lgkmcnt(6)
ds_read_b128 a[212:215], v44 offset:10240
v_perm_b32 v177, v205, v201, s84
v_mfma_f32_16x16x32_bf16 v[56:59], v[184:187], a[232:235], v[56:59]
s_waitcnt lgkmcnt(6)
ds_read_b128 a[216:219], v44 offset:12288
v_perm_b32 v178, v213, v209, s84
v_mfma_f32_16x16x32_bf16 v[60:63], v[184:187], a[236:239], v[60:63]
v_perm_b32 v179, v221, v217, s84
v_mfma_f32_16x16x32_bf16 v[76:79], v[188:191], a[236:239], v[76:79]
ds_read_b128 a[220:223], v44 offset:14336
v_perm_b32 v180, v197, v193, s85
v_mfma_f32_16x16x32_bf16 v[72:75], v[188:191], a[232:235], v[72:75]
v_perm_b32 v181, v205, v201, s85
v_mfma_f32_16x16x32_bf16 v[68:71], v[188:191], a[228:231], v[68:71]
v_perm_b32 v182, v213, v209, s85
v_mfma_f32_16x16x32_bf16 v[64:67], v[188:191], a[224:227], v[64:67]
v_perm_b32 v183, v221, v217, s85
v_mfma_f32_16x16x32_bf16 v[80:83], v[176:179], a[224:227], v[80:83]
v_perm_b32 v184, v198, v194, s84
v_mfma_f32_16x16x32_bf16 v[84:87], v[176:179], a[228:231], v[84:87]
v_perm_b32 v185, v206, v202, s84
v_mfma_f32_16x16x32_bf16 v[88:91], v[176:179], a[232:235], v[88:91]
s_bitcmp1_b32 s24, 6
s_cbranch_scc0 Lsite6
s_add_u32 m0, s27, 16128
s_nop 0
global_load_lds_dwordx4 v9, s[36:37] offset:256
s_add_u32 m0, s27, 17152
s_nop 0
global_load_lds_dwordx4 v10, s[36:37] offset:256
s_add_u32 m0, s27, 18176
s_nop 0
global_load_lds_dwordx4 v9, s[38:39] offset:256
s_add_u32 m0, s27, 19200
s_nop 0
global_load_lds_dwordx4 v10, s[38:39] offset:256
s_add_u32 m0, s27, 20224
s_nop 0
global_load_lds_dwordx4 v9, s[40:41] offset:256
s_add_u32 m0, s27, 21248
s_nop 0
global_load_lds_dwordx4 v10, s[40:41] offset:256
s_add_u32 m0, s27, 22272
s_nop 0
global_load_lds_dwordx4 v9, s[42:43] offset:256
s_add_u32 m0, s27, 23296
s_nop 0
global_load_lds_dwordx4 v10, s[42:43] offset:256
s_add_u32 m0, s34, 0
s_nop 0
global_load_lds_dwordx4 v9, s[44:45]
s_add_u32 m0, s34, 1024
s_nop 0
global_load_lds_dwordx4 v10, s[44:45]
Lsite6:
v_perm_b32 v186, v214, v210, s84
v_mfma_f32_16x16x32_bf16 v[92:95], v[176:179], a[236:239], v[92:95]
v_perm_b32 v187, v222, v218, s84
v_mfma_f32_16x16x32_bf16 v[108:111], v[180:183], a[236:239], v[108:111]
v_perm_b32 v188, v198, v194, s85
v_mfma_f32_16x16x32_bf16 v[104:107], v[180:183], a[232:235], v[104:107]
v_perm_b32 v189, v206, v202, s85
v_mfma_f32_16x16x32_bf16 v[100:103], v[180:183], a[228:231], v[100:103]
v_perm_b32 v190, v214, v210, s85
v_mfma_f32_16x16x32_bf16 v[96:99], v[180:183], a[224:227], v[96:99]
v_perm_b32 v191, v222, v218, s85
v_mfma_f32_16x16x32_bf16 v[112:115], v[184:187], a[224:227], v[112:115]
v_perm_b32 v176, v199, v195, s84
v_mfma_f32_16x16x32_bf16 v[116:119], v[184:187], a[228:231], v[116:119]
v_perm_b32 v177, v207, v203, s84
v_mfma_f32_16x16x32_bf16 v[120:123], v[184:187], a[232:235], v[120:123]
v_perm_b32 v178, v215, v211, s84
v_mfma_f32_16x16x32_bf16 v[124:127], v[184:187], a[236:239], v[124:127]
v_perm_b32 v179, v223, v219, s84
v_mfma_f32_16x16x32_bf16 v[140:143], v[188:191], a[236:239], v[140:143]
v_perm_b32 v180, v199, v195, s85
v_mfma_f32_16x16x32_bf16 v[136:139], v[188:191], a[232:235], v[136:139]
v_perm_b32 v181, v207, v203, s85
v_mfma_f32_16x16x32_bf16 v[132:135], v[188:191], a[228:231], v[132:135]
v_perm_b32 v182, v215, v211, s85
v_mfma_f32_16x16x32_bf16 v[128:131], v[188:191], a[224:227], v[128:131]
v_perm_b32 v183, v223, v219, s85
v_mfma_f32_16x16x32_bf16 v[144:147], v[176:179], a[224:227], v[144:147]
s_waitcnt vmcnt(24)
s_add_u32 s82, s72, 212992
s_addc_u32 s83, s73, 0
global_load_dwordx4 v[192:195], v32, s[82:83] offset:-3328
v_perm_b32 v184, v228, v224, s84
v_mfma_f32_16x16x32_bf16 v[148:151], v[176:179], a[228:231], v[148:151]
global_load_dwordx4 v[196:199], v32, s[82:83] offset:-1664
v_perm_b32 v185, v236, v232, s84
v_mfma_f32_16x16x32_bf16 v[152:155], v[176:179], a[232:235], v[152:155]
global_load_dwordx4 v[200:203], v32, s[82:83] offset:0
v_perm_b32 v186, v244, v240, s84
v_mfma_f32_16x16x32_bf16 v[156:159], v[176:179], a[236:239], v[156:159]
global_load_dwordx4 v[204:207], v32, s[82:83] offset:1664
v_perm_b32 v187, v252, v248, s84
v_mfma_f32_16x16x32_bf16 v[172:175], v[180:183], a[236:239], v[172:175]
global_load_dwordx4 v[208:211], v33, s[82:83] offset:-3328
v_perm_b32 v188, v228, v224, s85
v_mfma_f32_16x16x32_bf16 v[168:171], v[180:183], a[232:235], v[168:171]
global_load_dwordx4 v[212:215], v33, s[82:83] offset:-1664
v_perm_b32 v189, v236, v232, s85
v_mfma_f32_16x16x32_bf16 v[164:167], v[180:183], a[228:231], v[164:167]
global_load_dwordx4 v[216:219], v33, s[82:83] offset:0
v_perm_b32 v190, v244, v240, s85
v_mfma_f32_16x16x32_bf16 v[160:163], v[180:183], a[224:227], v[160:163]
s_waitcnt lgkmcnt(3)
global_load_dwordx4 v[220:223], v33, s[82:83] offset:1664
v_perm_b32 v191, v252, v248, s85
v_mfma_f32_16x16x32_bf16 v[48:51], v[184:187], a[208:211], v[48:51]
s_waitcnt lgkmcnt(2)
ds_read_b128 a[224:227], v45 offset:8192
v_perm_b32 v176, v229, v225, s84
v_mfma_f32_16x16x32_bf16 v[52:55], v[184:187], a[212:215], v[52:55]
s_waitcnt lgkmcnt(2)
ds_read_b128 a[228:231], v45 offset:10240
v_perm_b32 v177, v237, v233, s84
v_mfma_f32_16x16x32_bf16 v[56:59], v[184:187], a[216:219], v[56:59]
s_waitcnt lgkmcnt(2)
ds_read_b128 a[232:235], v45 offset:12288
v_perm_b32 v178, v245, v241, s84
v_mfma_f32_16x16x32_bf16 v[60:63], v[184:187], a[220:223], v[60:63]
v_perm_b32 v179, v253, v249, s84
v_mfma_f32_16x16x32_bf16 v[76:79], v[188:191], a[220:223], v[76:79]
ds_read_b128 a[236:239], v45 offset:14336
v_perm_b32 v180, v229, v225, s85
v_mfma_f32_16x16x32_bf16 v[72:75], v[188:191], a[216:219], v[72:75]
v_perm_b32 v181, v237, v233, s85
v_mfma_f32_16x16x32_bf16 v[68:71], v[188:191], a[212:215], v[68:71]
v_perm_b32 v182, v245, v241, s85
v_mfma_f32_16x16x32_bf16 v[64:67], v[188:191], a[208:211], v[64:67]
v_perm_b32 v183, v253, v249, s85
v_mfma_f32_16x16x32_bf16 v[80:83], v[176:179], a[208:211], v[80:83]
ds_read_b128 a[48:51], v43 offset:0
v_perm_b32 v184, v230, v226, s84
v_mfma_f32_16x16x32_bf16 v[84:87], v[176:179], a[212:215], v[84:87]
v_perm_b32 v185, v238, v234, s84
v_mfma_f32_16x16x32_bf16 v[88:91], v[176:179], a[216:219], v[88:91]
v_perm_b32 v186, v246, v242, s84
v_mfma_f32_16x16x32_bf16 v[92:95], v[176:179], a[220:223], v[92:95]
v_perm_b32 v187, v254, v250, s84
v_mfma_f32_16x16x32_bf16 v[108:111], v[180:183], a[220:223], v[108:111]
ds_read_b128 a[52:55], v43 offset:2048
v_perm_b32 v188, v230, v226, s85
v_mfma_f32_16x16x32_bf16 v[104:107], v[180:183], a[216:219], v[104:107]
v_perm_b32 v189, v238, v234, s85
v_mfma_f32_16x16x32_bf16 v[100:103], v[180:183], a[212:215], v[100:103]
v_perm_b32 v190, v246, v242, s85
v_mfma_f32_16x16x32_bf16 v[96:99], v[180:183], a[208:211], v[96:99]
v_perm_b32 v191, v254, v250, s85
v_mfma_f32_16x16x32_bf16 v[112:115], v[184:187], a[208:211], v[112:115]
s_waitcnt vmcnt(24)
ds_read_b128 a[56:59], v43 offset:4096
v_perm_b32 v176, v231, v227, s84
v_accvgpr_read_b32 v16, a104
v_mfma_f32_16x16x32_bf16 v[116:119], v[184:187], a[212:215], v[116:119]
v_perm_b32 v177, v239, v235, s84
v_accvgpr_read_b32 v17, a108
v_mfma_f32_16x16x32_bf16 v[120:123], v[184:187], a[216:219], v[120:123]
v_perm_b32 v178, v247, v243, s84
v_accvgpr_read_b32 v18, a112
v_mfma_f32_16x16x32_bf16 v[124:127], v[184:187], a[220:223], v[124:127]
v_perm_b32 v179, v255, v251, s84
v_accvgpr_read_b32 v19, a116
v_mfma_f32_16x16x32_bf16 v[140:143], v[188:191], a[220:223], v[140:143]
ds_read_b128 a[60:63], v43 offset:6144
v_perm_b32 v180, v231, v227, s85
v_accvgpr_read_b32 v20, a120
v_mfma_f32_16x16x32_bf16 v[136:139], v[188:191], a[216:219], v[136:139]
v_perm_b32 v181, v239, v235, s85
v_accvgpr_read_b32 v21, a124
v_mfma_f32_16x16x32_bf16 v[132:135], v[188:191], a[212:215], v[132:135]
v_perm_b32 v182, v247, v243, s85
v_accvgpr_read_b32 v22, a128
v_mfma_f32_16x16x32_bf16 v[128:131], v[188:191], a[208:211], v[128:131]
v_perm_b32 v183, v255, v251, s85
v_accvgpr_read_b32 v23, a132
v_mfma_f32_16x16x32_bf16 v[144:147], v[176:179], a[208:211], v[144:147]
s_add_u32 s82, s72, 266240
s_addc_u32 s83, s73, 0
global_load_dwordx4 v[224:227], v32, s[82:83] offset:-3328
v_perm_b32 v184, v17, v16, s84
v_accvgpr_read_b32 v24, a105
v_mfma_f32_16x16x32_bf16 v[148:151], v[176:179], a[212:215], v[148:151]
global_load_dwordx4 v[228:231], v32, s[82:83] offset:-1664
v_perm_b32 v185, v19, v18, s84
v_accvgpr_read_b32 v25, a109
v_mfma_f32_16x16x32_bf16 v[152:155], v[176:179], a[216:219], v[152:155]
global_load_dwordx4 v[232:235], v32, s[82:83] offset:0
v_perm_b32 v186, v21, v20, s84
v_accvgpr_read_b32 v26, a113
v_mfma_f32_16x16x32_bf16 v[156:159], v[176:179], a[220:223], v[156:159]
global_load_dwordx4 v[236:239], v32, s[82:83] offset:1664
v_perm_b32 v187, v23, v22, s84
v_accvgpr_read_b32 v27, a117
v_mfma_f32_16x16x32_bf16 v[172:175], v[180:183], a[220:223], v[172:175]
global_load_dwordx4 v[240:243], v33, s[82:83] offset:-3328
v_perm_b32 v188, v17, v16, s85
v_accvgpr_read_b32 v28, a121
v_mfma_f32_16x16x32_bf16 v[168:171], v[180:183], a[216:219], v[168:171]
global_load_dwordx4 v[244:247], v33, s[82:83] offset:-1664
v_perm_b32 v189, v19, v18, s85
v_accvgpr_read_b32 v29, a125
v_mfma_f32_16x16x32_bf16 v[164:167], v[180:183], a[212:215], v[164:167]
global_load_dwordx4 v[248:251], v33, s[82:83] offset:0
v_perm_b32 v190, v21, v20, s85
v_accvgpr_read_b32 v30, a129
v_mfma_f32_16x16x32_bf16 v[160:163], v[180:183], a[208:211], v[160:163]
s_waitcnt lgkmcnt(7)
global_load_dwordx4 v[252:255], v33, s[82:83] offset:1664
v_perm_b32 v191, v23, v22, s85
v_accvgpr_read_b32 v31, a133
v_mfma_f32_16x16x32_bf16 v[48:51], v[184:187], a[224:227], v[48:51]
s_waitcnt lgkmcnt(6)
ds_read_b128 a[208:211], v46 offset:8192
v_perm_b32 v176, v25, v24, s84
v_accvgpr_read_b32 v16, a106
v_mfma_f32_16x16x32_bf16 v[52:55], v[184:187], a[228:231], v[52:55]
s_waitcnt lgkmcnt(6)
ds_read_b128 a[212:215], v46 offset:10240
v_perm_b32 v177, v27, v26, s84
v_accvgpr_read_b32 v17, a110
v_mfma_f32_16x16x32_bf16 v[56:59], v[184:187], a[232:235], v[56:59]
s_waitcnt lgkmcnt(6)
ds_read_b128 a[216:219], v46 offset:12288
v_perm_b32 v178, v29, v28, s84
v_accvgpr_read_b32 v18, a114
v_mfma_f32_16x16x32_bf16 v[60:63], v[184:187], a[236:239], v[60:63]
v_perm_b32 v179, v31, v30, s84
v_accvgpr_read_b32 v19, a118
v_mfma_f32_16x16x32_bf16 v[76:79], v[188:191], a[236:239], v[76:79]
ds_read_b128 a[220:223], v46 offset:14336
v_perm_b32 v180, v25, v24, s85
v_accvgpr_read_b32 v20, a122
v_mfma_f32_16x16x32_bf16 v[72:75], v[188:191], a[232:235], v[72:75]
v_perm_b32 v181, v27, v26, s85
v_accvgpr_read_b32 v21, a126
v_mfma_f32_16x16x32_bf16 v[68:71], v[188:191], a[228:231], v[68:71]
v_perm_b32 v182, v29, v28, s85
v_accvgpr_read_b32 v22, a130
v_mfma_f32_16x16x32_bf16 v[64:67], v[188:191], a[224:227], v[64:67]
v_perm_b32 v183, v31, v30, s85
v_accvgpr_read_b32 v23, a134
v_mfma_f32_16x16x32_bf16 v[80:83], v[176:179], a[224:227], v[80:83]
v_perm_b32 v184, v17, v16, s84
v_accvgpr_read_b32 v24, a107
v_mfma_f32_16x16x32_bf16 v[84:87], v[176:179], a[228:231], v[84:87]
v_perm_b32 v185, v19, v18, s84
v_accvgpr_read_b32 v25, a111
v_mfma_f32_16x16x32_bf16 v[88:91], v[176:179], a[232:235], v[88:91]
s_bitcmp1_b32 s24, 7
s_cbranch_scc0 Lsite7
s_add_u32 m0, s27, 16128
s_nop 0
global_load_lds_dwordx4 v9, s[36:37] offset:256
s_add_u32 m0, s27, 17152
s_nop 0
global_load_lds_dwordx4 v10, s[36:37] offset:256
s_add_u32 m0, s27, 18176
s_nop 0
global_load_lds_dwordx4 v9, s[38:39] offset:256
s_add_u32 m0, s27, 19200
s_nop 0
global_load_lds_dwordx4 v10, s[38:39] offset:256
s_add_u32 m0, s27, 20224
s_nop 0
global_load_lds_dwordx4 v9, s[40:41] offset:256
s_add_u32 m0, s27, 21248
s_nop 0
global_load_lds_dwordx4 v10, s[40:41] offset:256
s_add_u32 m0, s27, 22272
s_nop 0
global_load_lds_dwordx4 v9, s[42:43] offset:256
s_add_u32 m0, s27, 23296
s_nop 0
global_load_lds_dwordx4 v10, s[42:43] offset:256
s_add_u32 m0, s34, 0
s_nop 0
global_load_lds_dwordx4 v9, s[44:45]
s_add_u32 m0, s34, 1024
s_nop 0
global_load_lds_dwordx4 v10, s[44:45]
Lsite7:
v_perm_b32 v186, v21, v20, s84
v_accvgpr_read_b32 v26, a115
v_mfma_f32_16x16x32_bf16 v[92:95], v[176:179], a[236:239], v[92:95]
v_perm_b32 v187, v23, v22, s84
v_accvgpr_read_b32 v27, a119
v_mfma_f32_16x16x32_bf16 v[108:111], v[180:183], a[236:239], v[108:111]
v_perm_b32 v188, v17, v16, s85
v_accvgpr_read_b32 v28, a123
v_mfma_f32_16x16x32_bf16 v[104:107], v[180:183], a[232:235], v[104:107]
v_perm_b32 v189, v19, v18, s85
v_accvgpr_read_b32 v29, a127
v_mfma_f32_16x16x32_bf16 v[100:103], v[180:183], a[228:231], v[100:103]
v_perm_b32 v190, v21, v20, s85
v_accvgpr_read_b32 v30, a131
v_mfma_f32_16x16x32_bf16 v[96:99], v[180:183], a[224:227], v[96:99]
v_perm_b32 v191, v23, v22, s85
v_accvgpr_read_b32 v31, a135
v_mfma_f32_16x16x32_bf16 v[112:115], v[184:187], a[224:227], v[112:115]
s_waitcnt vmcnt(24)
v_perm_b32 v176, v25, v24, s84
v_accvgpr_read_b32 v16, a136
v_mfma_f32_16x16x32_bf16 v[116:119], v[184:187], a[228:231], v[116:119]
s_add_u32 s82, s80, 0
s_addc_u32 s83, s81, 0
global_load_dwordx4 a[104:107], v32, s[82:83] offset:-3328
v_perm_b32 v177, v27, v26, s84
v_accvgpr_read_b32 v17, a140
v_mfma_f32_16x16x32_bf16 v[120:123], v[184:187], a[232:235], v[120:123]
v_perm_b32 v178, v29, v28, s84
v_accvgpr_read_b32 v18, a144
v_mfma_f32_16x16x32_bf16 v[124:127], v[184:187], a[236:239], v[124:127]
global_load_dwordx4 a[108:111], v32, s[82:83] offset:-1664
v_perm_b32 v179, v31, v30, s84
v_accvgpr_read_b32 v19, a148
v_mfma_f32_16x16x32_bf16 v[140:143], v[188:191], a[236:239], v[140:143]
v_perm_b32 v180, v25, v24, s85
v_accvgpr_read_b32 v20, a152
v_mfma_f32_16x16x32_bf16 v[136:139], v[188:191], a[232:235], v[136:139]
global_load_dwordx4 a[112:115], v32, s[82:83] offset:0
v_perm_b32 v181, v27, v26, s85
v_accvgpr_read_b32 v21, a156
v_mfma_f32_16x16x32_bf16 v[132:135], v[188:191], a[228:231], v[132:135]
v_perm_b32 v182, v29, v28, s85
v_accvgpr_read_b32 v22, a160
v_mfma_f32_16x16x32_bf16 v[128:131], v[188:191], a[224:227], v[128:131]
global_load_dwordx4 a[116:119], v32, s[82:83] offset:1664
v_perm_b32 v183, v31, v30, s85
v_accvgpr_read_b32 v23, a164
v_mfma_f32_16x16x32_bf16 v[144:147], v[176:179], a[224:227], v[144:147]
v_perm_b32 v184, v17, v16, s84
v_accvgpr_read_b32 v24, a137
v_mfma_f32_16x16x32_bf16 v[148:151], v[176:179], a[228:231], v[148:151]
global_load_dwordx4 a[120:123], v33, s[82:83] offset:-3328
v_perm_b32 v185, v19, v18, s84
v_accvgpr_read_b32 v25, a141
v_mfma_f32_16x16x32_bf16 v[152:155], v[176:179], a[232:235], v[152:155]
v_perm_b32 v186, v21, v20, s84
v_accvgpr_read_b32 v26, a145
v_mfma_f32_16x16x32_bf16 v[156:159], v[176:179], a[236:239], v[156:159]
global_load_dwordx4 a[124:127], v33, s[82:83] offset:-1664
v_perm_b32 v187, v23, v22, s84
v_accvgpr_read_b32 v27, a149
v_mfma_f32_16x16x32_bf16 v[172:175], v[180:183], a[236:239], v[172:175]
v_perm_b32 v188, v17, v16, s85
v_accvgpr_read_b32 v28, a153
v_mfma_f32_16x16x32_bf16 v[168:171], v[180:183], a[232:235], v[168:171]
global_load_dwordx4 a[128:131], v33, s[82:83] offset:0
v_perm_b32 v189, v19, v18, s85
v_accvgpr_read_b32 v29, a157
v_mfma_f32_16x16x32_bf16 v[164:167], v[180:183], a[228:231], v[164:167]
v_perm_b32 v190, v21, v20, s85
v_accvgpr_read_b32 v30, a161
v_mfma_f32_16x16x32_bf16 v[160:163], v[180:183], a[224:227], v[160:163]
s_waitcnt lgkmcnt(3)
global_load_dwordx4 a[132:135], v33, s[82:83] offset:1664
v_perm_b32 v191, v23, v22, s85
v_accvgpr_read_b32 v31, a165
v_mfma_f32_16x16x32_bf16 v[48:51], v[184:187], a[208:211], v[48:51]
s_waitcnt lgkmcnt(2)
ds_read_b128 a[224:227], v47 offset:8192
v_perm_b32 v176, v25, v24, s84
v_accvgpr_read_b32 v16, a138
v_mfma_f32_16x16x32_bf16 v[52:55], v[184:187], a[212:215], v[52:55]
s_waitcnt lgkmcnt(2)
ds_read_b128 a[228:231], v47 offset:10240
v_perm_b32 v177, v27, v26, s84
v_accvgpr_read_b32 v17, a142
v_mfma_f32_16x16x32_bf16 v[56:59], v[184:187], a[216:219], v[56:59]
s_waitcnt lgkmcnt(2)
ds_read_b128 a[232:235], v47 offset:12288
v_perm_b32 v178, v29, v28, s84
v_accvgpr_read_b32 v18, a146
v_mfma_f32_16x16x32_bf16 v[60:63], v[184:187], a[220:223], v[60:63]
v_perm_b32 v179, v31, v30, s84
v_accvgpr_read_b32 v19, a150
v_mfma_f32_16x16x32_bf16 v[76:79], v[188:191], a[220:223], v[76:79]
ds_read_b128 a[236:239], v47 offset:14336
v_perm_b32 v180, v25, v24, s85
v_accvgpr_read_b32 v20, a154
v_mfma_f32_16x16x32_bf16 v[72:75], v[188:191], a[216:219], v[72:75]
v_perm_b32 v181, v27, v26, s85
v_accvgpr_read_b32 v21, a158
v_mfma_f32_16x16x32_bf16 v[68:71], v[188:191], a[212:215], v[68:71]
v_perm_b32 v182, v29, v28, s85
v_accvgpr_read_b32 v22, a162
v_mfma_f32_16x16x32_bf16 v[64:67], v[188:191], a[208:211], v[64:67]
v_perm_b32 v183, v31, v30, s85
v_accvgpr_read_b32 v23, a166
v_mfma_f32_16x16x32_bf16 v[80:83], v[176:179], a[208:211], v[80:83]
v_perm_b32 v184, v17, v16, s84
v_accvgpr_read_b32 v24, a139
v_mfma_f32_16x16x32_bf16 v[84:87], v[176:179], a[212:215], v[84:87]
v_perm_b32 v185, v19, v18, s84
v_accvgpr_read_b32 v25, a143
v_mfma_f32_16x16x32_bf16 v[88:91], v[176:179], a[216:219], v[88:91]
v_perm_b32 v186, v21, v20, s84
v_accvgpr_read_b32 v26, a147
v_mfma_f32_16x16x32_bf16 v[92:95], v[176:179], a[220:223], v[92:95]
v_perm_b32 v187, v23, v22, s84
v_accvgpr_read_b32 v27, a151
v_mfma_f32_16x16x32_bf16 v[108:111], v[180:183], a[220:223], v[108:111]
v_perm_b32 v188, v17, v16, s85
v_accvgpr_read_b32 v28, a155
v_mfma_f32_16x16x32_bf16 v[104:107], v[180:183], a[216:219], v[104:107]
v_perm_b32 v189, v19, v18, s85
v_accvgpr_read_b32 v29, a159
v_mfma_f32_16x16x32_bf16 v[100:103], v[180:183], a[212:215], v[100:103]
v_perm_b32 v190, v21, v20, s85
v_accvgpr_read_b32 v30, a163
v_mfma_f32_16x16x32_bf16 v[96:99], v[180:183], a[208:211], v[96:99]
v_perm_b32 v191, v23, v22, s85
v_accvgpr_read_b32 v31, a167
v_mfma_f32_16x16x32_bf16 v[112:115], v[184:187], a[208:211], v[112:115]
s_waitcnt vmcnt(24)
v_perm_b32 v176, v25, v24, s84
v_accvgpr_read_b32 v16, a168
v_mfma_f32_16x16x32_bf16 v[116:119], v[184:187], a[212:215], v[116:119]
s_add_u32 s82, s80, 53248
s_addc_u32 s83, s81, 0
global_load_dwordx4 a[136:139], v32, s[82:83] offset:-3328
v_perm_b32 v177, v27, v26, s84
v_accvgpr_read_b32 v17, a172
v_mfma_f32_16x16x32_bf16 v[120:123], v[184:187], a[216:219], v[120:123]
v_perm_b32 v178, v29, v28, s84
v_accvgpr_read_b32 v18, a176
v_mfma_f32_16x16x32_bf16 v[124:127], v[184:187], a[220:223], v[124:127]
global_load_dwordx4 a[140:143], v32, s[82:83] offset:-1664
v_perm_b32 v179, v31, v30, s84
v_accvgpr_read_b32 v19, a180
v_mfma_f32_16x16x32_bf16 v[140:143], v[188:191], a[220:223], v[140:143]
v_perm_b32 v180, v25, v24, s85
v_accvgpr_read_b32 v20, a184
v_mfma_f32_16x16x32_bf16 v[136:139], v[188:191], a[216:219], v[136:139]
global_load_dwordx4 a[144:147], v32, s[82:83] offset:0
v_perm_b32 v181, v27, v26, s85
v_accvgpr_read_b32 v21, a188
v_mfma_f32_16x16x32_bf16 v[132:135], v[188:191], a[212:215], v[132:135]
v_perm_b32 v182, v29, v28, s85
v_accvgpr_read_b32 v22, a192
v_mfma_f32_16x16x32_bf16 v[128:131], v[188:191], a[208:211], v[128:131]
global_load_dwordx4 a[148:151], v32, s[82:83] offset:1664
v_perm_b32 v183, v31, v30, s85
v_accvgpr_read_b32 v23, a196
v_mfma_f32_16x16x32_bf16 v[144:147], v[176:179], a[208:211], v[144:147]
v_perm_b32 v184, v17, v16, s84
v_accvgpr_read_b32 v24, a169
v_mfma_f32_16x16x32_bf16 v[148:151], v[176:179], a[212:215], v[148:151]
global_load_dwordx4 a[152:155], v33, s[82:83] offset:-3328
v_perm_b32 v185, v19, v18, s84
v_accvgpr_read_b32 v25, a173
v_mfma_f32_16x16x32_bf16 v[152:155], v[176:179], a[216:219], v[152:155]
v_perm_b32 v186, v21, v20, s84
v_accvgpr_read_b32 v26, a177
v_mfma_f32_16x16x32_bf16 v[156:159], v[176:179], a[220:223], v[156:159]
global_load_dwordx4 a[156:159], v33, s[82:83] offset:-1664
v_perm_b32 v187, v23, v22, s84
v_accvgpr_read_b32 v27, a181
v_mfma_f32_16x16x32_bf16 v[172:175], v[180:183], a[220:223], v[172:175]
v_perm_b32 v188, v17, v16, s85
v_accvgpr_read_b32 v28, a185
v_mfma_f32_16x16x32_bf16 v[168:171], v[180:183], a[216:219], v[168:171]
global_load_dwordx4 a[160:163], v33, s[82:83] offset:0
v_perm_b32 v189, v19, v18, s85
v_accvgpr_read_b32 v29, a189
v_mfma_f32_16x16x32_bf16 v[164:167], v[180:183], a[212:215], v[164:167]
v_perm_b32 v190, v21, v20, s85
v_accvgpr_read_b32 v30, a193
v_mfma_f32_16x16x32_bf16 v[160:163], v[180:183], a[208:211], v[160:163]
s_waitcnt vmcnt(17) lgkmcnt(3)
global_load_dwordx4 a[164:167], v33, s[82:83] offset:1664
v_perm_b32 v191, v23, v22, s85
v_accvgpr_read_b32 v31, a197
v_mfma_f32_16x16x32_bf16 v[48:51], v[184:187], a[224:227], v[48:51]
s_waitcnt lgkmcnt(2)
ds_read_b128 a[208:211], v3 offset:16384
v_perm_b32 v176, v25, v24, s84
v_accvgpr_read_b32 v16, a170
v_mfma_f32_16x16x32_bf16 v[52:55], v[184:187], a[228:231], v[52:55]
s_waitcnt lgkmcnt(2)
ds_read_b128 a[212:215], v3 offset:18432
v_perm_b32 v177, v27, v26, s84
v_accvgpr_read_b32 v17, a174
v_mfma_f32_16x16x32_bf16 v[56:59], v[184:187], a[232:235], v[56:59]
s_waitcnt lgkmcnt(2)
ds_read_b128 a[216:219], v3 offset:20480
v_perm_b32 v178, v29, v28, s84
v_accvgpr_read_b32 v18, a178
v_mfma_f32_16x16x32_bf16 v[60:63], v[184:187], a[236:239], v[60:63]
v_perm_b32 v179, v31, v30, s84
v_accvgpr_read_b32 v19, a182
v_mfma_f32_16x16x32_bf16 v[76:79], v[188:191], a[236:239], v[76:79]
ds_read_b128 a[220:223], v3 offset:22528
v_perm_b32 v180, v25, v24, s85
v_accvgpr_read_b32 v20, a186
v_mfma_f32_16x16x32_bf16 v[72:75], v[188:191], a[232:235], v[72:75]
v_perm_b32 v181, v27, v26, s85
v_accvgpr_read_b32 v21, a190
v_mfma_f32_16x16x32_bf16 v[68:71], v[188:191], a[228:231], v[68:71]
v_perm_b32 v182, v29, v28, s85
v_accvgpr_read_b32 v22, a194
v_mfma_f32_16x16x32_bf16 v[64:67], v[188:191], a[224:227], v[64:67]
v_perm_b32 v183, v31, v30, s85
v_accvgpr_read_b32 v23, a198
v_mfma_f32_16x16x32_bf16 v[80:83], v[176:179], a[224:227], v[80:83]
v_perm_b32 v184, v17, v16, s84
v_accvgpr_read_b32 v24, a171
v_mfma_f32_16x16x32_bf16 v[84:87], v[176:179], a[228:231], v[84:87]
v_perm_b32 v185, v19, v18, s84
v_accvgpr_read_b32 v25, a175
v_mfma_f32_16x16x32_bf16 v[88:91], v[176:179], a[232:235], v[88:91]
v_perm_b32 v186, v21, v20, s84
v_accvgpr_read_b32 v26, a179
v_mfma_f32_16x16x32_bf16 v[92:95], v[176:179], a[236:239], v[92:95]
v_perm_b32 v187, v23, v22, s84
v_accvgpr_read_b32 v27, a183
v_mfma_f32_16x16x32_bf16 v[108:111], v[180:183], a[236:239], v[108:111]
v_perm_b32 v188, v17, v16, s85
v_accvgpr_read_b32 v28, a187
v_mfma_f32_16x16x32_bf16 v[104:107], v[180:183], a[232:235], v[104:107]
v_perm_b32 v189, v19, v18, s85
v_accvgpr_read_b32 v29, a191
v_mfma_f32_16x16x32_bf16 v[100:103], v[180:183], a[228:231], v[100:103]
v_perm_b32 v190, v21, v20, s85
v_accvgpr_read_b32 v30, a195
v_mfma_f32_16x16x32_bf16 v[96:99], v[180:183], a[224:227], v[96:99]
v_perm_b32 v191, v23, v22, s85
v_accvgpr_read_b32 v31, a199
v_mfma_f32_16x16x32_bf16 v[112:115], v[184:187], a[224:227], v[112:115]
v_perm_b32 v176, v25, v24, s84
v_mfma_f32_16x16x32_bf16 v[116:119], v[184:187], a[228:231], v[116:119]
s_add_u32 s82, s74, 212992
s_addc_u32 s83, s75, 0
global_load_dwordx4 a[168:171], v32, s[82:83] offset:-3328
v_perm_b32 v177, v27, v26, s84
v_mfma_f32_16x16x32_bf16 v[120:123], v[184:187], a[232:235], v[120:123]
v_perm_b32 v178, v29, v28, s84
v_mfma_f32_16x16x32_bf16 v[124:127], v[184:187], a[236:239], v[124:127]
global_load_dwordx4 a[172:175], v32, s[82:83] offset:-1664
v_perm_b32 v179, v31, v30, s84
v_mfma_f32_16x16x32_bf16 v[140:143], v[188:191], a[236:239], v[140:143]
v_perm_b32 v180, v25, v24, s85
v_mfma_f32_16x16x32_bf16 v[136:139], v[188:191], a[232:235], v[136:139]
global_load_dwordx4 a[176:179], v32, s[82:83] offset:0
v_perm_b32 v181, v27, v26, s85
v_mfma_f32_16x16x32_bf16 v[132:135], v[188:191], a[228:231], v[132:135]
v_perm_b32 v182, v29, v28, s85
v_mfma_f32_16x16x32_bf16 v[128:131], v[188:191], a[224:227], v[128:131]
global_load_dwordx4 a[180:183], v32, s[82:83] offset:1664
v_perm_b32 v183, v31, v30, s85
v_mfma_f32_16x16x32_bf16 v[144:147], v[176:179], a[224:227], v[144:147]
s_waitcnt vmcnt(28)
v_perm_b32 v184, v196, v192, s84
v_mfma_f32_16x16x32_bf16 v[148:151], v[176:179], a[228:231], v[148:151]
global_load_dwordx4 a[184:187], v33, s[82:83] offset:-3328
v_perm_b32 v185, v204, v200, s84
v_mfma_f32_16x16x32_bf16 v[152:155], v[176:179], a[232:235], v[152:155]
v_perm_b32 v186, v212, v208, s84
v_mfma_f32_16x16x32_bf16 v[156:159], v[176:179], a[236:239], v[156:159]
global_load_dwordx4 a[188:191], v33, s[82:83] offset:-1664
v_perm_b32 v187, v220, v216, s84
v_mfma_f32_16x16x32_bf16 v[172:175], v[180:183], a[236:239], v[172:175]
v_perm_b32 v188, v196, v192, s85
v_mfma_f32_16x16x32_bf16 v[168:171], v[180:183], a[232:235], v[168:171]
global_load_dwordx4 a[192:195], v33, s[82:83] offset:0
v_perm_b32 v189, v204, v200, s85
v_mfma_f32_16x16x32_bf16 v[164:167], v[180:183], a[228:231], v[164:167]
v_perm_b32 v190, v212, v208, s85
v_mfma_f32_16x16x32_bf16 v[160:163], v[180:183], a[224:227], v[160:163]
s_waitcnt lgkmcnt(3)
global_load_dwordx4 a[196:199], v33, s[82:83] offset:1664
v_perm_b32 v191, v220, v216, s85
v_mfma_f32_16x16x32_bf16 v[48:51], v[184:187], a[208:211], v[48:51]
s_waitcnt lgkmcnt(2)
ds_read_b128 a[224:227], v44 offset:16384
v_perm_b32 v176, v197, v193, s84
v_mfma_f32_16x16x32_bf16 v[52:55], v[184:187], a[212:215], v[52:55]
s_waitcnt lgkmcnt(2)
ds_read_b128 a[228:231], v44 offset:18432
v_perm_b32 v177, v205, v201, s84
v_mfma_f32_16x16x32_bf16 v[56:59], v[184:187], a[216:219], v[56:59]
s_waitcnt lgkmcnt(2)
ds_read_b128 a[232:235], v44 offset:20480
v_perm_b32 v178, v213, v209, s84
v_mfma_f32_16x16x32_bf16 v[60:63], v[184:187], a[220:223], v[60:63]
v_perm_b32 v179, v221, v217, s84
v_mfma_f32_16x16x32_bf16 v[76:79], v[188:191], a[220:223], v[76:79]
ds_read_b128 a[236:239], v44 offset:22528
v_perm_b32 v180, v197, v193, s85
v_mfma_f32_16x16x32_bf16 v[72:75], v[188:191], a[216:219], v[72:75]
v_perm_b32 v181, v205, v201, s85
v_mfma_f32_16x16x32_bf16 v[68:71], v[188:191], a[212:215], v[68:71]
v_perm_b32 v182, v213, v209, s85
v_mfma_f32_16x16x32_bf16 v[64:67], v[188:191], a[208:211], v[64:67]
v_perm_b32 v183, v221, v217, s85
v_mfma_f32_16x16x32_bf16 v[80:83], v[176:179], a[208:211], v[80:83]
ds_read_b128 a[64:67], v3 offset:16384
v_perm_b32 v184, v198, v194, s84
v_mfma_f32_16x16x32_bf16 v[84:87], v[176:179], a[212:215], v[84:87]
v_perm_b32 v185, v206, v202, s84
v_mfma_f32_16x16x32_bf16 v[88:91], v[176:179], a[216:219], v[88:91]
v_perm_b32 v186, v214, v210, s84
v_mfma_f32_16x16x32_bf16 v[92:95], v[176:179], a[220:223], v[92:95]
v_perm_b32 v187, v222, v218, s84
v_mfma_f32_16x16x32_bf16 v[108:111], v[180:183], a[220:223], v[108:111]
ds_read_b128 a[68:71], v3 offset:18432
v_perm_b32 v188, v198, v194, s85
v_mfma_f32_16x16x32_bf16 v[104:107], v[180:183], a[216:219], v[104:107]
v_perm_b32 v189, v206, v202, s85
v_mfma_f32_16x16x32_bf16 v[100:103], v[180:183], a[212:215], v[100:103]
v_perm_b32 v190, v214, v210, s85
v_mfma_f32_16x16x32_bf16 v[96:99], v[180:183], a[208:211], v[96:99]
v_perm_b32 v191, v222, v218, s85
v_mfma_f32_16x16x32_bf16 v[112:115], v[184:187], a[208:211], v[112:115]
ds_read_b128 a[72:75], v3 offset:20480
v_perm_b32 v176, v199, v195, s84
v_mfma_f32_16x16x32_bf16 v[116:119], v[184:187], a[212:215], v[116:119]
v_perm_b32 v177, v207, v203, s84
v_mfma_f32_16x16x32_bf16 v[120:123], v[184:187], a[216:219], v[120:123]
v_perm_b32 v178, v215, v211, s84
v_mfma_f32_16x16x32_bf16 v[124:127], v[184:187], a[220:223], v[124:127]
v_perm_b32 v179, v223, v219, s84
v_mfma_f32_16x16x32_bf16 v[140:143], v[188:191], a[220:223], v[140:143]
ds_read_b128 a[76:79], v3 offset:22528
v_perm_b32 v180, v199, v195, s85
v_mfma_f32_16x16x32_bf16 v[136:139], v[188:191], a[216:219], v[136:139]
v_perm_b32 v181, v207, v203, s85
v_mfma_f32_16x16x32_bf16 v[132:135], v[188:191], a[212:215], v[132:135]
v_perm_b32 v182, v215, v211, s85
v_mfma_f32_16x16x32_bf16 v[128:131], v[188:191], a[208:211], v[128:131]
v_perm_b32 v183, v223, v219, s85
v_mfma_f32_16x16x32_bf16 v[144:147], v[176:179], a[208:211], v[144:147]
s_waitcnt vmcnt(24)
s_add_u32 s82, s74, 266240
s_addc_u32 s83, s75, 0
global_load_dwordx4 v[192:195], v32, s[82:83] offset:-3328
v_perm_b32 v184, v228, v224, s84
v_mfma_f32_16x16x32_bf16 v[148:151], v[176:179], a[212:215], v[148:151]
global_load_dwordx4 v[196:199], v32, s[82:83] offset:-1664
v_perm_b32 v185, v236, v232, s84
v_mfma_f32_16x16x32_bf16 v[152:155], v[176:179], a[216:219], v[152:155]
global_load_dwordx4 v[200:203], v32, s[82:83] offset:0
v_perm_b32 v186, v244, v240, s84
v_mfma_f32_16x16x32_bf16 v[156:159], v[176:179], a[220:223], v[156:159]
global_load_dwordx4 v[204:207], v32, s[82:83] offset:1664
v_perm_b32 v187, v252, v248, s84
v_mfma_f32_16x16x32_bf16 v[172:175], v[180:183], a[220:223], v[172:175]
global_load_dwordx4 v[208:211], v33, s[82:83] offset:-3328
v_perm_b32 v188, v228, v224, s85
v_mfma_f32_16x16x32_bf16 v[168:171], v[180:183], a[216:219], v[168:171]
global_load_dwordx4 v[212:215], v33, s[82:83] offset:-1664
v_perm_b32 v189, v236, v232, s85
v_mfma_f32_16x16x32_bf16 v[164:167], v[180:183], a[212:215], v[164:167]
global_load_dwordx4 v[216:219], v33, s[82:83] offset:0
v_perm_b32 v190, v244, v240, s85
v_mfma_f32_16x16x32_bf16 v[160:163], v[180:183], a[208:211], v[160:163]
s_waitcnt vmcnt(31) lgkmcnt(7)
s_barrier
global_load_dwordx4 v[220:223], v33, s[82:83] offset:1664
v_perm_b32 v191, v252, v248, s85
v_mfma_f32_16x16x32_bf16 v[48:51], v[184:187], a[224:227], v[48:51]
s_waitcnt lgkmcnt(6)
ds_read_b128 a[208:211], v7 offset:0
v_perm_b32 v176, v229, v225, s84
v_mfma_f32_16x16x32_bf16 v[52:55], v[184:187], a[228:231], v[52:55]
s_waitcnt lgkmcnt(6)
ds_read_b128 a[212:215], v7 offset:2048
v_perm_b32 v177, v237, v233, s84
v_mfma_f32_16x16x32_bf16 v[56:59], v[184:187], a[232:235], v[56:59]
s_waitcnt lgkmcnt(6)
ds_read_b128 a[216:219], v7 offset:4096
v_perm_b32 v178, v245, v241, s84
v_mfma_f32_16x16x32_bf16 v[60:63], v[184:187], a[236:239], v[60:63]
v_perm_b32 v179, v253, v249, s84
v_mfma_f32_16x16x32_bf16 v[76:79], v[188:191], a[236:239], v[76:79]
ds_read_b128 a[220:223], v7 offset:6144
v_perm_b32 v180, v229, v225, s85
v_mfma_f32_16x16x32_bf16 v[72:75], v[188:191], a[232:235], v[72:75]
v_perm_b32 v181, v237, v233, s85
v_mfma_f32_16x16x32_bf16 v[68:71], v[188:191], a[228:231], v[68:71]
v_perm_b32 v182, v245, v241, s85
v_mfma_f32_16x16x32_bf16 v[64:67], v[188:191], a[224:227], v[64:67]
v_perm_b32 v183, v253, v249, s85
v_mfma_f32_16x16x32_bf16 v[80:83], v[176:179], a[224:227], v[80:83]
ds_read_b128 a[80:83], v44 offset:16384
v_perm_b32 v184, v230, v226, s84
v_mfma_f32_16x16x32_bf16 v[84:87], v[176:179], a[228:231], v[84:87]
v_perm_b32 v185, v238, v234, s84
v_mfma_f32_16x16x32_bf16 v[88:91], v[176:179], a[232:235], v[88:91]
v_perm_b32 v186, v246, v242, s84
v_mfma_f32_16x16x32_bf16 v[92:95], v[176:179], a[236:239], v[92:95]
v_perm_b32 v187, v254, v250, s84
v_mfma_f32_16x16x32_bf16 v[108:111], v[180:183], a[236:239], v[108:111]
ds_read_b128 a[84:87], v44 offset:18432
v_perm_b32 v188, v230, v226, s85
v_mfma_f32_16x16x32_bf16 v[104:107], v[180:183], a[232:235], v[104:107]
v_perm_b32 v189, v238, v234, s85
v_mfma_f32_16x16x32_bf16 v[100:103], v[180:183], a[228:231], v[100:103]
v_perm_b32 v190, v246, v242, s85
v_mfma_f32_16x16x32_bf16 v[96:99], v[180:183], a[224:227], v[96:99]
v_perm_b32 v191, v254, v250, s85
v_mfma_f32_16x16x32_bf16 v[112:115], v[184:187], a[224:227], v[112:115]
s_waitcnt vmcnt(24)
ds_read_b128 a[88:91], v44 offset:20480
v_perm_b32 v176, v231, v227, s84
v_accvgpr_read_b32 v16, a104
v_mfma_f32_16x16x32_bf16 v[116:119], v[184:187], a[228:231], v[116:119]
v_perm_b32 v177, v239, v235, s84
v_accvgpr_read_b32 v17, a108
v_mfma_f32_16x16x32_bf16 v[120:123], v[184:187], a[232:235], v[120:123]
v_perm_b32 v178, v247, v243, s84
v_accvgpr_read_b32 v18, a112
v_mfma_f32_16x16x32_bf16 v[124:127], v[184:187], a[236:239], v[124:127]
v_perm_b32 v179, v255, v251, s84
v_accvgpr_read_b32 v19, a116
v_mfma_f32_16x16x32_bf16 v[140:143], v[188:191], a[236:239], v[140:143]
ds_read_b128 a[92:95], v44 offset:22528
v_perm_b32 v180, v231, v227, s85
v_accvgpr_read_b32 v20, a120
v_mfma_f32_16x16x32_bf16 v[136:139], v[188:191], a[232:235], v[136:139]
v_perm_b32 v181, v239, v235, s85
v_accvgpr_read_b32 v21, a124
v_mfma_f32_16x16x32_bf16 v[132:135], v[188:191], a[228:231], v[132:135]
v_perm_b32 v182, v247, v243, s85
v_accvgpr_read_b32 v22, a128
v_mfma_f32_16x16x32_bf16 v[128:131], v[188:191], a[224:227], v[128:131]
v_perm_b32 v183, v255, v251, s85
v_accvgpr_read_b32 v23, a132
v_mfma_f32_16x16x32_bf16 v[144:147], v[176:179], a[224:227], v[144:147]
s_add_u32 s82, s76, 212992
s_addc_u32 s83, s77, 0
global_load_dwordx4 v[224:227], v32, s[82:83] offset:-3328
v_perm_b32 v184, v17, v16, s84
v_accvgpr_read_b32 v24, a105
v_mfma_f32_16x16x32_bf16 v[148:151], v[176:179], a[228:231], v[148:151]
global_load_dwordx4 v[228:231], v32, s[82:83] offset:-1664
v_perm_b32 v185, v19, v18, s84
v_accvgpr_read_b32 v25, a109
v_mfma_f32_16x16x32_bf16 v[152:155], v[176:179], a[232:235], v[152:155]
global_load_dwordx4 v[232:235], v32, s[82:83] offset:0
v_perm_b32 v186, v21, v20, s84
v_accvgpr_read_b32 v26, a113
v_mfma_f32_16x16x32_bf16 v[156:159], v[176:179], a[236:239], v[156:159]
global_load_dwordx4 v[236:239], v32, s[82:83] offset:1664
v_perm_b32 v187, v23, v22, s84
v_accvgpr_read_b32 v27, a117
v_mfma_f32_16x16x32_bf16 v[172:175], v[180:183], a[236:239], v[172:175]
global_load_dwordx4 v[240:243], v33, s[82:83] offset:-3328
v_perm_b32 v188, v17, v16, s85
v_accvgpr_read_b32 v28, a121
v_mfma_f32_16x16x32_bf16 v[168:171], v[180:183], a[232:235], v[168:171]
global_load_dwordx4 v[244:247], v33, s[82:83] offset:-1664
v_perm_b32 v189, v19, v18, s85
v_accvgpr_read_b32 v29, a125
v_mfma_f32_16x16x32_bf16 v[164:167], v[180:183], a[228:231], v[164:167]
global_load_dwordx4 v[248:251], v33, s[82:83] offset:0
v_perm_b32 v190, v21, v20, s85
v_accvgpr_read_b32 v30, a129
v_mfma_f32_16x16x32_bf16 v[160:163], v[180:183], a[224:227], v[160:163]
s_waitcnt lgkmcnt(7)
global_load_dwordx4 v[252:255], v33, s[82:83] offset:1664
v_perm_b32 v191, v23, v22, s85
v_accvgpr_read_b32 v31, a133
v_mfma_f32_16x16x32_bf16 v[48:51], v[184:187], a[208:211], v[48:51]
s_waitcnt lgkmcnt(6)
ds_read_b128 a[224:227], v15 offset:0
v_perm_b32 v176, v25, v24, s84
v_accvgpr_read_b32 v16, a106
v_mfma_f32_16x16x32_bf16 v[52:55], v[184:187], a[212:215], v[52:55]
s_waitcnt lgkmcnt(6)
ds_read_b128 a[228:231], v15 offset:2048
v_perm_b32 v177, v27, v26, s84
v_accvgpr_read_b32 v17, a110
v_mfma_f32_16x16x32_bf16 v[56:59], v[184:187], a[216:219], v[56:59]
s_waitcnt lgkmcnt(6)
ds_read_b128 a[232:235], v15 offset:4096
v_perm_b32 v178, v29, v28, s84
v_accvgpr_read_b32 v18, a114
v_mfma_f32_16x16x32_bf16 v[60:63], v[184:187], a[220:223], v[60:63]
v_perm_b32 v179, v31, v30, s84
v_accvgpr_read_b32 v19, a118
v_mfma_f32_16x16x32_bf16 v[76:79], v[188:191], a[220:223], v[76:79]
ds_read_b128 a[236:239], v15 offset:6144
v_perm_b32 v180, v25, v24, s85
v_accvgpr_read_b32 v20, a122
v_mfma_f32_16x16x32_bf16 v[72:75], v[188:191], a[216:219], v[72:75]
v_perm_b32 v181, v27, v26, s85
v_accvgpr_read_b32 v21, a126
v_mfma_f32_16x16x32_bf16 v[68:71], v[188:191], a[212:215], v[68:71]
s_bitcmp1_b32 s24, 11
s_cbranch_scc0 Lchk
global_load_dword v12, v11, s[12:13] sc1
Lchk:
v_perm_b32 v182, v29, v28, s85
v_accvgpr_read_b32 v22, a130
v_mfma_f32_16x16x32_bf16 v[64:67], v[188:191], a[208:211], v[64:67]
v_perm_b32 v183, v31, v30, s85
v_accvgpr_read_b32 v23, a134
v_mfma_f32_16x16x32_bf16 v[80:83], v[176:179], a[208:211], v[80:83]
ds_read_b64 a[96:97], v8 offset:0
v_perm_b32 v184, v17, v16, s84
v_accvgpr_read_b32 v24, a107
v_mfma_f32_16x16x32_bf16 v[84:87], v[176:179], a[212:215], v[84:87]
v_perm_b32 v185, v19, v18, s84
v_accvgpr_read_b32 v25, a111
v_mfma_f32_16x16x32_bf16 v[88:91], v[176:179], a[216:219], v[88:91]
v_perm_b32 v186, v21, v20, s84
v_accvgpr_read_b32 v26, a115
v_mfma_f32_16x16x32_bf16 v[92:95], v[176:179], a[220:223], v[92:95]
v_perm_b32 v187, v23, v22, s84
v_accvgpr_read_b32 v27, a119
v_mfma_f32_16x16x32_bf16 v[108:111], v[180:183], a[220:223], v[108:111]
ds_read_b64 a[98:99], v8 offset:2048
v_perm_b32 v188, v17, v16, s85
v_accvgpr_read_b32 v28, a123
v_mfma_f32_16x16x32_bf16 v[104:107], v[180:183], a[216:219], v[104:107]
v_perm_b32 v189, v19, v18, s85
v_accvgpr_read_b32 v29, a127
v_mfma_f32_16x16x32_bf16 v[100:103], v[180:183], a[212:215], v[100:103]
v_perm_b32 v190, v21, v20, s85
v_accvgpr_read_b32 v30, a131
v_mfma_f32_16x16x32_bf16 v[96:99], v[180:183], a[208:211], v[96:99]
v_perm_b32 v191, v23, v22, s85
v_accvgpr_read_b32 v31, a135
v_mfma_f32_16x16x32_bf16 v[112:115], v[184:187], a[208:211], v[112:115]
s_waitcnt vmcnt(24)
ds_read_b64 a[100:101], v8 offset:4096
v_perm_b32 v176, v25, v24, s84
v_accvgpr_read_b32 v16, a136
v_mfma_f32_16x16x32_bf16 v[116:119], v[184:187], a[212:215], v[116:119]
s_add_u32 s82, s76, 266240
s_addc_u32 s83, s77, 0
global_load_dwordx4 a[104:107], v32, s[82:83] offset:-3328
v_perm_b32 v177, v27, v26, s84
v_accvgpr_read_b32 v17, a140
v_mfma_f32_16x16x32_bf16 v[120:123], v[184:187], a[216:219], v[120:123]
v_perm_b32 v178, v29, v28, s84
v_accvgpr_read_b32 v18, a144
v_mfma_f32_16x16x32_bf16 v[124:127], v[184:187], a[220:223], v[124:127]
global_load_dwordx4 a[108:111], v32, s[82:83] offset:-1664
v_perm_b32 v179, v31, v30, s84
v_accvgpr_read_b32 v19, a148
v_mfma_f32_16x16x32_bf16 v[140:143], v[188:191], a[220:223], v[140:143]
ds_read_b64 a[102:103], v8 offset:6144
v_perm_b32 v180, v25, v24, s85
v_accvgpr_read_b32 v20, a152
v_mfma_f32_16x16x32_bf16 v[136:139], v[188:191], a[216:219], v[136:139]
global_load_dwordx4 a[112:115], v32, s[82:83] offset:0
v_perm_b32 v181, v27, v26, s85
v_accvgpr_read_b32 v21, a156
v_mfma_f32_16x16x32_bf16 v[132:135], v[188:191], a[212:215], v[132:135]
v_perm_b32 v182, v29, v28, s85
v_accvgpr_read_b32 v22, a160
v_mfma_f32_16x16x32_bf16 v[128:131], v[188:191], a[208:211], v[128:131]
global_load_dwordx4 a[116:119], v32, s[82:83] offset:1664
v_perm_b32 v183, v31, v30, s85
v_accvgpr_read_b32 v23, a164
v_mfma_f32_16x16x32_bf16 v[144:147], v[176:179], a[208:211], v[144:147]
v_perm_b32 v184, v17, v16, s84
v_accvgpr_read_b32 v24, a137
v_mfma_f32_16x16x32_bf16 v[148:151], v[176:179], a[212:215], v[148:151]
global_load_dwordx4 a[120:123], v33, s[82:83] offset:-3328
v_perm_b32 v185, v19, v18, s84
v_accvgpr_read_b32 v25, a141
v_mfma_f32_16x16x32_bf16 v[152:155], v[176:179], a[216:219], v[152:155]
v_perm_b32 v186, v21, v20, s84
v_accvgpr_read_b32 v26, a145
v_mfma_f32_16x16x32_bf16 v[156:159], v[176:179], a[220:223], v[156:159]
global_load_dwordx4 a[124:127], v33, s[82:83] offset:-1664
v_perm_b32 v187, v23, v22, s84
v_accvgpr_read_b32 v27, a149
v_mfma_f32_16x16x32_bf16 v[172:175], v[180:183], a[220:223], v[172:175]
v_perm_b32 v188, v17, v16, s85
v_accvgpr_read_b32 v28, a153
v_mfma_f32_16x16x32_bf16 v[168:171], v[180:183], a[216:219], v[168:171]
global_load_dwordx4 a[128:131], v33, s[82:83] offset:0
v_perm_b32 v189, v19, v18, s85
v_accvgpr_read_b32 v29, a157
v_mfma_f32_16x16x32_bf16 v[164:167], v[180:183], a[212:215], v[164:167]
v_perm_b32 v190, v21, v20, s85
v_accvgpr_read_b32 v30, a161
v_mfma_f32_16x16x32_bf16 v[160:163], v[180:183], a[208:211], v[160:163]
s_waitcnt lgkmcnt(7)
global_load_dwordx4 a[132:135], v33, s[82:83] offset:1664
v_perm_b32 v191, v23, v22, s85
v_accvgpr_read_b32 v31, a165
v_mfma_f32_16x16x32_bf16 v[48:51], v[184:187], a[224:227], v[48:51]
s_waitcnt lgkmcnt(6)
ds_read_b128 a[208:211], v4 offset:16384
v_perm_b32 v176, v25, v24, s84
v_accvgpr_read_b32 v16, a138
v_mfma_f32_16x16x32_bf16 v[52:55], v[184:187], a[228:231], v[52:55]
s_waitcnt lgkmcnt(6)
ds_read_b128 a[212:215], v4 offset:18432
v_perm_b32 v177, v27, v26, s84
v_accvgpr_read_b32 v17, a142
v_mfma_f32_16x16x32_bf16 v[56:59], v[184:187], a[232:235], v[56:59]
s_waitcnt lgkmcnt(6)
ds_read_b128 a[216:219], v4 offset:20480
v_perm_b32 v178, v29, v28, s84
v_accvgpr_read_b32 v18, a146
v_mfma_f32_16x16x32_bf16 v[60:63], v[184:187], a[236:239], v[60:63]
v_perm_b32 v179, v31, v30, s84
v_accvgpr_read_b32 v19, a150
v_mfma_f32_16x16x32_bf16 v[76:79], v[188:191], a[236:239], v[76:79]
ds_read_b128 a[220:223], v4 offset:22528
v_perm_b32 v180, v25, v24, s85
v_accvgpr_read_b32 v20, a154
v_mfma_f32_16x16x32_bf16 v[72:75], v[188:191], a[232:235], v[72:75]
v_perm_b32 v181, v27, v26, s85
v_accvgpr_read_b32 v21, a158
v_mfma_f32_16x16x32_bf16 v[68:71], v[188:191], a[228:231], v[68:71]
v_perm_b32 v182, v29, v28, s85
v_accvgpr_read_b32 v22, a162
v_mfma_f32_16x16x32_bf16 v[64:67], v[188:191], a[224:227], v[64:67]
v_perm_b32 v183, v31, v30, s85
v_accvgpr_read_b32 v23, a166
v_mfma_f32_16x16x32_bf16 v[80:83], v[176:179], a[224:227], v[80:83]
v_perm_b32 v184, v17, v16, s84
v_accvgpr_read_b32 v24, a139
v_mfma_f32_16x16x32_bf16 v[84:87], v[176:179], a[228:231], v[84:87]
v_perm_b32 v185, v19, v18, s84
v_accvgpr_read_b32 v25, a143
v_mfma_f32_16x16x32_bf16 v[88:91], v[176:179], a[232:235], v[88:91]
v_perm_b32 v186, v21, v20, s84
v_accvgpr_read_b32 v26, a147
v_mfma_f32_16x16x32_bf16 v[92:95], v[176:179], a[236:239], v[92:95]
v_perm_b32 v187, v23, v22, s84
v_accvgpr_read_b32 v27, a151
v_mfma_f32_16x16x32_bf16 v[108:111], v[180:183], a[236:239], v[108:111]
v_perm_b32 v188, v17, v16, s85
v_accvgpr_read_b32 v28, a155
v_mfma_f32_16x16x32_bf16 v[104:107], v[180:183], a[232:235], v[104:107]
v_perm_b32 v189, v19, v18, s85
v_accvgpr_read_b32 v29, a159
v_mfma_f32_16x16x32_bf16 v[100:103], v[180:183], a[228:231], v[100:103]
v_perm_b32 v190, v21, v20, s85
v_accvgpr_read_b32 v30, a163
v_mfma_f32_16x16x32_bf16 v[96:99], v[180:183], a[224:227], v[96:99]
v_perm_b32 v191, v23, v22, s85
v_accvgpr_read_b32 v31, a167
v_mfma_f32_16x16x32_bf16 v[112:115], v[184:187], a[224:227], v[112:115]
s_waitcnt vmcnt(24)
v_perm_b32 v176, v25, v24, s84
v_accvgpr_read_b32 v16, a168
v_mfma_f32_16x16x32_bf16 v[116:119], v[184:187], a[228:231], v[116:119]
s_add_u32 s82, s78, 212992
s_addc_u32 s83, s79, 0
global_load_dwordx4 a[136:139], v32, s[82:83] offset:-3328
v_perm_b32 v177, v27, v26, s84
v_accvgpr_read_b32 v17, a172
v_mfma_f32_16x16x32_bf16 v[120:123], v[184:187], a[232:235], v[120:123]
v_perm_b32 v178, v29, v28, s84
v_accvgpr_read_b32 v18, a176
v_mfma_f32_16x16x32_bf16 v[124:127], v[184:187], a[236:239], v[124:127]
global_load_dwordx4 a[140:143], v32, s[82:83] offset:-1664
v_perm_b32 v179, v31, v30, s84
v_accvgpr_read_b32 v19, a180
v_mfma_f32_16x16x32_bf16 v[140:143], v[188:191], a[236:239], v[140:143]
v_perm_b32 v180, v25, v24, s85
v_accvgpr_read_b32 v20, a184
v_mfma_f32_16x16x32_bf16 v[136:139], v[188:191], a[232:235], v[136:139]
global_load_dwordx4 a[144:147], v32, s[82:83] offset:0
v_perm_b32 v181, v27, v26, s85
v_accvgpr_read_b32 v21, a188
v_mfma_f32_16x16x32_bf16 v[132:135], v[188:191], a[228:231], v[132:135]
v_perm_b32 v182, v29, v28, s85
v_accvgpr_read_b32 v22, a192
v_mfma_f32_16x16x32_bf16 v[128:131], v[188:191], a[224:227], v[128:131]
global_load_dwordx4 a[148:151], v32, s[82:83] offset:1664
v_perm_b32 v183, v31, v30, s85
v_accvgpr_read_b32 v23, a196
v_mfma_f32_16x16x32_bf16 v[144:147], v[176:179], a[224:227], v[144:147]
v_perm_b32 v184, v17, v16, s84
v_accvgpr_read_b32 v24, a169
v_mfma_f32_16x16x32_bf16 v[148:151], v[176:179], a[228:231], v[148:151]
global_load_dwordx4 a[152:155], v33, s[82:83] offset:-3328
v_perm_b32 v185, v19, v18, s84
v_accvgpr_read_b32 v25, a173
v_mfma_f32_16x16x32_bf16 v[152:155], v[176:179], a[232:235], v[152:155]
v_perm_b32 v186, v21, v20, s84
v_accvgpr_read_b32 v26, a177
v_mfma_f32_16x16x32_bf16 v[156:159], v[176:179], a[236:239], v[156:159]
global_load_dwordx4 a[156:159], v33, s[82:83] offset:-1664
v_perm_b32 v187, v23, v22, s84
v_accvgpr_read_b32 v27, a181
v_mfma_f32_16x16x32_bf16 v[172:175], v[180:183], a[236:239], v[172:175]
v_perm_b32 v188, v17, v16, s85
v_accvgpr_read_b32 v28, a185
v_mfma_f32_16x16x32_bf16 v[168:171], v[180:183], a[232:235], v[168:171]
global_load_dwordx4 a[160:163], v33, s[82:83] offset:0
v_perm_b32 v189, v19, v18, s85
v_accvgpr_read_b32 v29, a189
v_mfma_f32_16x16x32_bf16 v[164:167], v[180:183], a[228:231], v[164:167]
v_perm_b32 v190, v21, v20, s85
v_accvgpr_read_b32 v30, a193
v_mfma_f32_16x16x32_bf16 v[160:163], v[180:183], a[224:227], v[160:163]
s_waitcnt lgkmcnt(3)
global_load_dwordx4 a[164:167], v33, s[82:83] offset:1664
v_perm_b32 v191, v23, v22, s85
v_accvgpr_read_b32 v31, a197
v_mfma_f32_16x16x32_bf16 v[48:51], v[184:187], a[208:211], v[48:51]
s_waitcnt lgkmcnt(2)
ds_read_b128 a[224:227], v45 offset:16384
v_perm_b32 v176, v25, v24, s84
v_accvgpr_read_b32 v16, a170
v_mfma_f32_16x16x32_bf16 v[52:55], v[184:187], a[212:215], v[52:55]
s_waitcnt lgkmcnt(2)
ds_read_b128 a[228:231], v45 offset:18432
v_perm_b32 v177, v27, v26, s84
v_accvgpr_read_b32 v17, a174
v_mfma_f32_16x16x32_bf16 v[56:59], v[184:187], a[216:219], v[56:59]
s_waitcnt lgkmcnt(2)
ds_read_b128 a[232:235], v45 offset:20480
v_perm_b32 v178, v29, v28, s84
v_accvgpr_read_b32 v18, a178
v_mfma_f32_16x16x32_bf16 v[60:63], v[184:187], a[220:223], v[60:63]
v_perm_b32 v179, v31, v30, s84
v_accvgpr_read_b32 v19, a182
v_mfma_f32_16x16x32_bf16 v[76:79], v[188:191], a[220:223], v[76:79]
ds_read_b128 a[236:239], v45 offset:22528
v_perm_b32 v180, v25, v24, s85
v_accvgpr_read_b32 v20, a186
v_mfma_f32_16x16x32_bf16 v[72:75], v[188:191], a[216:219], v[72:75]
v_perm_b32 v181, v27, v26, s85
v_accvgpr_read_b32 v21, a190
v_mfma_f32_16x16x32_bf16 v[68:71], v[188:191], a[212:215], v[68:71]
v_perm_b32 v182, v29, v28, s85
v_accvgpr_read_b32 v22, a194
v_mfma_f32_16x16x32_bf16 v[64:67], v[188:191], a[208:211], v[64:67]
v_perm_b32 v183, v31, v30, s85
v_accvgpr_read_b32 v23, a198
v_mfma_f32_16x16x32_bf16 v[80:83], v[176:179], a[208:211], v[80:83]
v_perm_b32 v184, v17, v16, s84
v_accvgpr_read_b32 v24, a171
v_mfma_f32_16x16x32_bf16 v[84:87], v[176:179], a[212:215], v[84:87]
v_perm_b32 v185, v19, v18, s84
v_accvgpr_read_b32 v25, a175
v_mfma_f32_16x16x32_bf16 v[88:91], v[176:179], a[216:219], v[88:91]
v_perm_b32 v186, v21, v20, s84
v_accvgpr_read_b32 v26, a179
v_mfma_f32_16x16x32_bf16 v[92:95], v[176:179], a[220:223], v[92:95]
v_perm_b32 v187, v23, v22, s84
v_accvgpr_read_b32 v27, a183
v_mfma_f32_16x16x32_bf16 v[108:111], v[180:183], a[220:223], v[108:111]
v_perm_b32 v188, v17, v16, s85
v_accvgpr_read_b32 v28, a187
v_mfma_f32_16x16x32_bf16 v[104:107], v[180:183], a[216:219], v[104:107]
v_perm_b32 v189, v19, v18, s85
v_accvgpr_read_b32 v29, a191
v_mfma_f32_16x16x32_bf16 v[100:103], v[180:183], a[212:215], v[100:103]
v_perm_b32 v190, v21, v20, s85
v_accvgpr_read_b32 v30, a195
v_mfma_f32_16x16x32_bf16 v[96:99], v[180:183], a[208:211], v[96:99]
v_perm_b32 v191, v23, v22, s85
v_accvgpr_read_b32 v31, a199
v_mfma_f32_16x16x32_bf16 v[112:115], v[184:187], a[208:211], v[112:115]
v_perm_b32 v176, v25, v24, s84
v_mfma_f32_16x16x32_bf16 v[116:119], v[184:187], a[212:215], v[116:119]
s_add_u32 s82, s78, 266240
s_addc_u32 s83, s79, 0
global_load_dwordx4 a[168:171], v32, s[82:83] offset:-3328
v_perm_b32 v177, v27, v26, s84
v_mfma_f32_16x16x32_bf16 v[120:123], v[184:187], a[216:219], v[120:123]
v_perm_b32 v178, v29, v28, s84
v_mfma_f32_16x16x32_bf16 v[124:127], v[184:187], a[220:223], v[124:127]
global_load_dwordx4 a[172:175], v32, s[82:83] offset:-1664
v_perm_b32 v179, v31, v30, s84
v_mfma_f32_16x16x32_bf16 v[140:143], v[188:191], a[220:223], v[140:143]
v_perm_b32 v180, v25, v24, s85
v_mfma_f32_16x16x32_bf16 v[136:139], v[188:191], a[216:219], v[136:139]
global_load_dwordx4 a[176:179], v32, s[82:83] offset:0
v_perm_b32 v181, v27, v26, s85
v_mfma_f32_16x16x32_bf16 v[132:135], v[188:191], a[212:215], v[132:135]
v_perm_b32 v182, v29, v28, s85
v_mfma_f32_16x16x32_bf16 v[128:131], v[188:191], a[208:211], v[128:131]
global_load_dwordx4 a[180:183], v32, s[82:83] offset:1664
v_perm_b32 v183, v31, v30, s85
v_mfma_f32_16x16x32_bf16 v[144:147], v[176:179], a[208:211], v[144:147]
s_waitcnt vmcnt(28)
v_perm_b32 v184, v196, v192, s84
v_mfma_f32_16x16x32_bf16 v[148:151], v[176:179], a[212:215], v[148:151]
global_load_dwordx4 a[184:187], v33, s[82:83] offset:-3328
v_perm_b32 v185, v204, v200, s84
v_mfma_f32_16x16x32_bf16 v[152:155], v[176:179], a[216:219], v[152:155]
v_perm_b32 v186, v212, v208, s84
v_mfma_f32_16x16x32_bf16 v[156:159], v[176:179], a[220:223], v[156:159]
global_load_dwordx4 a[188:191], v33, s[82:83] offset:-1664
v_perm_b32 v187, v220, v216, s84
v_mfma_f32_16x16x32_bf16 v[172:175], v[180:183], a[220:223], v[172:175]
v_perm_b32 v188, v196, v192, s85
v_mfma_f32_16x16x32_bf16 v[168:171], v[180:183], a[216:219], v[168:171]
global_load_dwordx4 a[192:195], v33, s[82:83] offset:0
v_perm_b32 v189, v204, v200, s85
v_mfma_f32_16x16x32_bf16 v[164:167], v[180:183], a[212:215], v[164:167]
v_perm_b32 v190, v212, v208, s85
v_mfma_f32_16x16x32_bf16 v[160:163], v[180:183], a[208:211], v[160:163]
s_waitcnt lgkmcnt(3)
global_load_dwordx4 a[196:199], v33, s[82:83] offset:1664
v_perm_b32 v191, v220, v216, s85
v_mfma_f32_16x16x32_bf16 v[48:51], v[184:187], a[224:227], v[48:51]
s_waitcnt lgkmcnt(2)
ds_read_b128 a[208:211], v5 offset:16384
v_perm_b32 v176, v197, v193, s84
v_mfma_f32_16x16x32_bf16 v[52:55], v[184:187], a[228:231], v[52:55]
s_waitcnt lgkmcnt(2)
ds_read_b128 a[212:215], v5 offset:18432
v_perm_b32 v177, v205, v201, s84
v_mfma_f32_16x16x32_bf16 v[56:59], v[184:187], a[232:235], v[56:59]
s_waitcnt lgkmcnt(2)
ds_read_b128 a[216:219], v5 offset:20480
v_perm_b32 v178, v213, v209, s84
v_mfma_f32_16x16x32_bf16 v[60:63], v[184:187], a[236:239], v[60:63]
v_perm_b32 v179, v221, v217, s84
v_mfma_f32_16x16x32_bf16 v[76:79], v[188:191], a[236:239], v[76:79]
ds_read_b128 a[220:223], v5 offset:22528
v_perm_b32 v180, v197, v193, s85
v_mfma_f32_16x16x32_bf16 v[72:75], v[188:191], a[232:235], v[72:75]
v_perm_b32 v181, v205, v201, s85
v_mfma_f32_16x16x32_bf16 v[68:71], v[188:191], a[228:231], v[68:71]
v_perm_b32 v182, v213, v209, s85
v_mfma_f32_16x16x32_bf16 v[64:67], v[188:191], a[224:227], v[64:67]
v_perm_b32 v183, v221, v217, s85
v_mfma_f32_16x16x32_bf16 v[80:83], v[176:179], a[224:227], v[80:83]
v_perm_b32 v184, v198, v194, s84
v_mfma_f32_16x16x32_bf16 v[84:87], v[176:179], a[228:231], v[84:87]
v_perm_b32 v185, v206, v202, s84
v_mfma_f32_16x16x32_bf16 v[88:91], v[176:179], a[232:235], v[88:91]
v_perm_b32 v186, v214, v210, s84
v_mfma_f32_16x16x32_bf16 v[92:95], v[176:179], a[236:239], v[92:95]
v_perm_b32 v187, v222, v218, s84
v_mfma_f32_16x16x32_bf16 v[108:111], v[180:183], a[236:239], v[108:111]
v_perm_b32 v188, v198, v194, s85
v_mfma_f32_16x16x32_bf16 v[104:107], v[180:183], a[232:235], v[104:107]
v_perm_b32 v189, v206, v202, s85
v_mfma_f32_16x16x32_bf16 v[100:103], v[180:183], a[228:231], v[100:103]
v_perm_b32 v190, v214, v210, s85
v_mfma_f32_16x16x32_bf16 v[96:99], v[180:183], a[224:227], v[96:99]
v_perm_b32 v191, v222, v218, s85
v_mfma_f32_16x16x32_bf16 v[112:115], v[184:187], a[224:227], v[112:115]
v_perm_b32 v176, v199, v195, s84
v_mfma_f32_16x16x32_bf16 v[116:119], v[184:187], a[228:231], v[116:119]
v_perm_b32 v177, v207, v203, s84
v_mfma_f32_16x16x32_bf16 v[120:123], v[184:187], a[232:235], v[120:123]
v_perm_b32 v178, v215, v211, s84
v_mfma_f32_16x16x32_bf16 v[124:127], v[184:187], a[236:239], v[124:127]
v_perm_b32 v179, v223, v219, s84
v_mfma_f32_16x16x32_bf16 v[140:143], v[188:191], a[236:239], v[140:143]
v_perm_b32 v180, v199, v195, s85
v_mfma_f32_16x16x32_bf16 v[136:139], v[188:191], a[232:235], v[136:139]
v_perm_b32 v181, v207, v203, s85
v_mfma_f32_16x16x32_bf16 v[132:135], v[188:191], a[228:231], v[132:135]
v_perm_b32 v182, v215, v211, s85
v_mfma_f32_16x16x32_bf16 v[128:131], v[188:191], a[224:227], v[128:131]
v_perm_b32 v183, v223, v219, s85
v_mfma_f32_16x16x32_bf16 v[144:147], v[176:179], a[224:227], v[144:147]
s_waitcnt vmcnt(24)
v_perm_b32 v184, v228, v224, s84
v_mfma_f32_16x16x32_bf16 v[148:151], v[176:179], a[228:231], v[148:151]
v_perm_b32 v185, v236, v232, s84
v_mfma_f32_16x16x32_bf16 v[152:155], v[176:179], a[232:235], v[152:155]
v_perm_b32 v186, v244, v240, s84
v_mfma_f32_16x16x32_bf16 v[156:159], v[176:179], a[236:239], v[156:159]
v_perm_b32 v187, v252, v248, s84
v_mfma_f32_16x16x32_bf16 v[172:175], v[180:183], a[236:239], v[172:175]
v_perm_b32 v188, v228, v224, s85
v_mfma_f32_16x16x32_bf16 v[168:171], v[180:183], a[232:235], v[168:171]
v_perm_b32 v189, v236, v232, s85
v_mfma_f32_16x16x32_bf16 v[164:167], v[180:183], a[228:231], v[164:167]
v_perm_b32 v190, v244, v240, s85
v_mfma_f32_16x16x32_bf16 v[160:163], v[180:183], a[224:227], v[160:163]
s_waitcnt lgkmcnt(3)
v_perm_b32 v191, v252, v248, s85
v_mfma_f32_16x16x32_bf16 v[48:51], v[184:187], a[208:211], v[48:51]
s_waitcnt lgkmcnt(2)
ds_read_b128 a[224:227], v46 offset:16384
v_perm_b32 v176, v229, v225, s84
v_mfma_f32_16x16x32_bf16 v[52:55], v[184:187], a[212:215], v[52:55]
s_waitcnt lgkmcnt(2)
ds_read_b128 a[228:231], v46 offset:18432
v_perm_b32 v177, v237, v233, s84
v_mfma_f32_16x16x32_bf16 v[56:59], v[184:187], a[216:219], v[56:59]
s_waitcnt lgkmcnt(2)
ds_read_b128 a[232:235], v46 offset:20480
v_perm_b32 v178, v245, v241, s84
v_mfma_f32_16x16x32_bf16 v[60:63], v[184:187], a[220:223], v[60:63]
v_perm_b32 v179, v253, v249, s84
v_mfma_f32_16x16x32_bf16 v[76:79], v[188:191], a[220:223], v[76:79]
ds_read_b128 a[236:239], v46 offset:22528
v_perm_b32 v180, v229, v225, s85
v_mfma_f32_16x16x32_bf16 v[72:75], v[188:191], a[216:219], v[72:75]
v_perm_b32 v181, v237, v233, s85
v_mfma_f32_16x16x32_bf16 v[68:71], v[188:191], a[212:215], v[68:71]
v_perm_b32 v182, v245, v241, s85
v_mfma_f32_16x16x32_bf16 v[64:67], v[188:191], a[208:211], v[64:67]
v_perm_b32 v183, v253, v249, s85
v_mfma_f32_16x16x32_bf16 v[80:83], v[176:179], a[208:211], v[80:83]
v_perm_b32 v184, v230, v226, s84
v_mfma_f32_16x16x32_bf16 v[84:87], v[176:179], a[212:215], v[84:87]
v_perm_b32 v185, v238, v234, s84
v_mfma_f32_16x16x32_bf16 v[88:91], v[176:179], a[216:219], v[88:91]
v_perm_b32 v186, v246, v242, s84
v_mfma_f32_16x16x32_bf16 v[92:95], v[176:179], a[220:223], v[92:95]
v_perm_b32 v187, v254, v250, s84
v_mfma_f32_16x16x32_bf16 v[108:111], v[180:183], a[220:223], v[108:111]
v_perm_b32 v188, v230, v226, s85
v_mfma_f32_16x16x32_bf16 v[104:107], v[180:183], a[216:219], v[104:107]
v_perm_b32 v189, v238, v234, s85
v_mfma_f32_16x16x32_bf16 v[100:103], v[180:183], a[212:215], v[100:103]
v_perm_b32 v190, v246, v242, s85
v_mfma_f32_16x16x32_bf16 v[96:99], v[180:183], a[208:211], v[96:99]
v_perm_b32 v191, v254, v250, s85
v_mfma_f32_16x16x32_bf16 v[112:115], v[184:187], a[208:211], v[112:115]
s_waitcnt vmcnt(16)
v_perm_b32 v176, v231, v227, s84
v_accvgpr_read_b32 v16, a104
v_mfma_f32_16x16x32_bf16 v[116:119], v[184:187], a[212:215], v[116:119]
v_perm_b32 v177, v239, v235, s84
v_accvgpr_read_b32 v17, a108
v_mfma_f32_16x16x32_bf16 v[120:123], v[184:187], a[216:219], v[120:123]
v_perm_b32 v178, v247, v243, s84
v_accvgpr_read_b32 v18, a112
v_mfma_f32_16x16x32_bf16 v[124:127], v[184:187], a[220:223], v[124:127]
v_perm_b32 v179, v255, v251, s84
v_accvgpr_read_b32 v19, a116
v_mfma_f32_16x16x32_bf16 v[140:143], v[188:191], a[220:223], v[140:143]
v_perm_b32 v180, v231, v227, s85
v_accvgpr_read_b32 v20, a120
v_mfma_f32_16x16x32_bf16 v[136:139], v[188:191], a[216:219], v[136:139]
v_perm_b32 v181, v239, v235, s85
v_accvgpr_read_b32 v21, a124
v_mfma_f32_16x16x32_bf16 v[132:135], v[188:191], a[212:215], v[132:135]
v_perm_b32 v182, v247, v243, s85
v_accvgpr_read_b32 v22, a128
v_mfma_f32_16x16x32_bf16 v[128:131], v[188:191], a[208:211], v[128:131]
v_perm_b32 v183, v255, v251, s85
v_accvgpr_read_b32 v23, a132
v_mfma_f32_16x16x32_bf16 v[144:147], v[176:179], a[208:211], v[144:147]
v_perm_b32 v184, v17, v16, s84
v_accvgpr_read_b32 v24, a105
v_mfma_f32_16x16x32_bf16 v[148:151], v[176:179], a[212:215], v[148:151]
v_perm_b32 v185, v19, v18, s84
v_accvgpr_read_b32 v25, a109
v_mfma_f32_16x16x32_bf16 v[152:155], v[176:179], a[216:219], v[152:155]
v_perm_b32 v186, v21, v20, s84
v_accvgpr_read_b32 v26, a113
v_mfma_f32_16x16x32_bf16 v[156:159], v[176:179], a[220:223], v[156:159]
v_perm_b32 v187, v23, v22, s84
v_accvgpr_read_b32 v27, a117
v_mfma_f32_16x16x32_bf16 v[172:175], v[180:183], a[220:223], v[172:175]
v_perm_b32 v188, v17, v16, s85
v_accvgpr_read_b32 v28, a121
v_mfma_f32_16x16x32_bf16 v[168:171], v[180:183], a[216:219], v[168:171]
v_perm_b32 v189, v19, v18, s85
v_accvgpr_read_b32 v29, a125
v_mfma_f32_16x16x32_bf16 v[164:167], v[180:183], a[212:215], v[164:167]
v_perm_b32 v190, v21, v20, s85
v_accvgpr_read_b32 v30, a129
v_mfma_f32_16x16x32_bf16 v[160:163], v[180:183], a[208:211], v[160:163]
s_waitcnt lgkmcnt(3)
v_perm_b32 v191, v23, v22, s85
v_accvgpr_read_b32 v31, a133
v_mfma_f32_16x16x32_bf16 v[48:51], v[184:187], a[224:227], v[48:51]
s_waitcnt lgkmcnt(2)
ds_read_b128 a[208:211], v6 offset:16384
v_perm_b32 v176, v25, v24, s84
v_accvgpr_read_b32 v16, a106
v_mfma_f32_16x16x32_bf16 v[52:55], v[184:187], a[228:231], v[52:55]
s_waitcnt lgkmcnt(2)
ds_read_b128 a[212:215], v6 offset:18432
v_perm_b32 v177, v27, v26, s84
v_accvgpr_read_b32 v17, a110
v_mfma_f32_16x16x32_bf16 v[56:59], v[184:187], a[232:235], v[56:59]
s_waitcnt lgkmcnt(2)
ds_read_b128 a[216:219], v6 offset:20480
v_perm_b32 v178, v29, v28, s84
v_accvgpr_read_b32 v18, a114
v_mfma_f32_16x16x32_bf16 v[60:63], v[184:187], a[236:239], v[60:63]
v_perm_b32 v179, v31, v30, s84
v_accvgpr_read_b32 v19, a118
v_mfma_f32_16x16x32_bf16 v[76:79], v[188:191], a[236:239], v[76:79]
ds_read_b128 a[220:223], v6 offset:22528
v_perm_b32 v180, v25, v24, s85
v_accvgpr_read_b32 v20, a122
v_mfma_f32_16x16x32_bf16 v[72:75], v[188:191], a[232:235], v[72:75]
v_perm_b32 v181, v27, v26, s85
v_accvgpr_read_b32 v21, a126
v_mfma_f32_16x16x32_bf16 v[68:71], v[188:191], a[228:231], v[68:71]
v_perm_b32 v182, v29, v28, s85
v_accvgpr_read_b32 v22, a130
v_mfma_f32_16x16x32_bf16 v[64:67], v[188:191], a[224:227], v[64:67]
v_perm_b32 v183, v31, v30, s85
v_accvgpr_read_b32 v23, a134
v_mfma_f32_16x16x32_bf16 v[80:83], v[176:179], a[224:227], v[80:83]
v_perm_b32 v184, v17, v16, s84
v_accvgpr_read_b32 v24, a107
v_mfma_f32_16x16x32_bf16 v[84:87], v[176:179], a[228:231], v[84:87]
v_perm_b32 v185, v19, v18, s84
v_accvgpr_read_b32 v25, a111
v_mfma_f32_16x16x32_bf16 v[88:91], v[176:179], a[232:235], v[88:91]
v_perm_b32 v186, v21, v20, s84
v_accvgpr_read_b32 v26, a115
v_mfma_f32_16x16x32_bf16 v[92:95], v[176:179], a[236:239], v[92:95]
v_perm_b32 v187, v23, v22, s84
v_accvgpr_read_b32 v27, a119
v_mfma_f32_16x16x32_bf16 v[108:111], v[180:183], a[236:239], v[108:111]
v_perm_b32 v188, v17, v16, s85
v_accvgpr_read_b32 v28, a123
v_mfma_f32_16x16x32_bf16 v[104:107], v[180:183], a[232:235], v[104:107]
v_perm_b32 v189, v19, v18, s85
v_accvgpr_read_b32 v29, a127
v_mfma_f32_16x16x32_bf16 v[100:103], v[180:183], a[228:231], v[100:103]
v_perm_b32 v190, v21, v20, s85
v_accvgpr_read_b32 v30, a131
v_mfma_f32_16x16x32_bf16 v[96:99], v[180:183], a[224:227], v[96:99]
s_bitcmp1_b32 s24, 11
s_cbranch_scc0 Lckw
v_cmp_gt_u32 vcc, 10, v12
s_nop 4
s_cmp_lg_u64 vcc, 0
s_cbranch_scc1 Lslow
Lsync_back:
Lckw:
s_barrier
v_add_u32 v32, 217088, v1
v_add_u32 v33, 241664, v1
v_perm_b32 v191, v23, v22, s85
v_accvgpr_read_b32 v31, a135
v_mfma_f32_16x16x32_bf16 v[112:115], v[184:187], a[224:227], v[112:115]
s_waitcnt vmcnt(8)
global_load_dwordx4 a[200:203], v33, s[20:21] offset:-4096 sc1
v_perm_b32 v176, v25, v24, s84
v_accvgpr_read_b32 v16, a136
v_mfma_f32_16x16x32_bf16 v[116:119], v[184:187], a[228:231], v[116:119]
global_load_dwordx4 a[104:107], v32, s[20:21] offset:-4096 sc1
v_perm_b32 v177, v27, v26, s84
v_accvgpr_read_b32 v17, a140
v_mfma_f32_16x16x32_bf16 v[120:123], v[184:187], a[232:235], v[120:123]
global_load_dwordx4 a[204:207], v33, s[20:21] offset:-3072 sc1
v_perm_b32 v178, v29, v28, s84
v_accvgpr_read_b32 v18, a144
v_mfma_f32_16x16x32_bf16 v[124:127], v[184:187], a[236:239], v[124:127]
global_load_dwordx4 a[108:111], v32, s[20:21] offset:-3072 sc1
v_perm_b32 v179, v31, v30, s84
v_accvgpr_read_b32 v19, a148
v_mfma_f32_16x16x32_bf16 v[140:143], v[188:191], a[236:239], v[140:143]
v_perm_b32 v180, v25, v24, s85
v_accvgpr_read_b32 v20, a152
v_mfma_f32_16x16x32_bf16 v[136:139], v[188:191], a[232:235], v[136:139]
global_load_dwordx4 a[112:115], v32, s[20:21] offset:-2048 sc1
v_perm_b32 v181, v27, v26, s85
v_accvgpr_read_b32 v21, a156
v_mfma_f32_16x16x32_bf16 v[132:135], v[188:191], a[228:231], v[132:135]
v_perm_b32 v182, v29, v28, s85
v_accvgpr_read_b32 v22, a160
v_mfma_f32_16x16x32_bf16 v[128:131], v[188:191], a[224:227], v[128:131]
global_load_dwordx4 a[116:119], v32, s[20:21] offset:-1024 sc1
v_perm_b32 v183, v31, v30, s85
v_accvgpr_read_b32 v23, a164
v_mfma_f32_16x16x32_bf16 v[144:147], v[176:179], a[224:227], v[144:147]
v_perm_b32 v184, v17, v16, s84
v_accvgpr_read_b32 v24, a137
v_mfma_f32_16x16x32_bf16 v[148:151], v[176:179], a[228:231], v[148:151]
global_load_dwordx4 a[120:123], v32, s[20:21] offset:0 sc1
v_perm_b32 v185, v19, v18, s84
v_accvgpr_read_b32 v25, a141
v_mfma_f32_16x16x32_bf16 v[152:155], v[176:179], a[232:235], v[152:155]
v_perm_b32 v186, v21, v20, s84
v_accvgpr_read_b32 v26, a145
v_mfma_f32_16x16x32_bf16 v[156:159], v[176:179], a[236:239], v[156:159]
global_load_dwordx4 a[124:127], v32, s[20:21] offset:1024 sc1
v_perm_b32 v187, v23, v22, s84
v_accvgpr_read_b32 v27, a149
v_mfma_f32_16x16x32_bf16 v[172:175], v[180:183], a[236:239], v[172:175]
v_perm_b32 v188, v17, v16, s85
v_accvgpr_read_b32 v28, a153
v_mfma_f32_16x16x32_bf16 v[168:171], v[180:183], a[232:235], v[168:171]
global_load_dwordx4 a[128:131], v32, s[20:21] offset:2048 sc1
v_perm_b32 v189, v19, v18, s85
v_accvgpr_read_b32 v29, a157
v_mfma_f32_16x16x32_bf16 v[164:167], v[180:183], a[228:231], v[164:167]
v_perm_b32 v190, v21, v20, s85
v_accvgpr_read_b32 v30, a161
v_mfma_f32_16x16x32_bf16 v[160:163], v[180:183], a[224:227], v[160:163]
s_waitcnt lgkmcnt(3)
global_load_dwordx4 a[132:135], v32, s[20:21] offset:3072 sc1
v_perm_b32 v191, v23, v22, s85
v_accvgpr_read_b32 v31, a165
v_mfma_f32_16x16x32_bf16 v[48:51], v[184:187], a[208:211], v[48:51]
s_waitcnt lgkmcnt(2)
ds_read_b128 a[224:227], v47 offset:16384
v_perm_b32 v176, v25, v24, s84
v_accvgpr_read_b32 v16, a138
v_mfma_f32_16x16x32_bf16 v[52:55], v[184:187], a[212:215], v[52:55]
s_waitcnt lgkmcnt(2)
ds_read_b128 a[228:231], v47 offset:18432
v_perm_b32 v177, v27, v26, s84
v_accvgpr_read_b32 v17, a142
v_add_u32 v32, 8192, v32
v_mfma_f32_16x16x32_bf16 v[56:59], v[184:187], a[216:219], v[56:59]
s_waitcnt lgkmcnt(2)
ds_read_b128 a[232:235], v47 offset:20480
v_perm_b32 v178, v29, v28, s84
v_accvgpr_read_b32 v18, a146
v_mfma_f32_16x16x32_bf16 v[60:63], v[184:187], a[220:223], v[60:63]
v_perm_b32 v179, v31, v30, s84
v_accvgpr_read_b32 v19, a150
v_mfma_f32_16x16x32_bf16 v[76:79], v[188:191], a[220:223], v[76:79]
ds_read_b128 a[236:239], v47 offset:22528
v_perm_b32 v180, v25, v24, s85
v_accvgpr_read_b32 v20, a154
v_mfma_f32_16x16x32_bf16 v[72:75], v[188:191], a[216:219], v[72:75]
v_perm_b32 v181, v27, v26, s85
v_accvgpr_read_b32 v21, a158
v_mfma_f32_16x16x32_bf16 v[68:71], v[188:191], a[212:215], v[68:71]
v_perm_b32 v182, v29, v28, s85
v_accvgpr_read_b32 v22, a162
v_mfma_f32_16x16x32_bf16 v[64:67], v[188:191], a[208:211], v[64:67]
v_perm_b32 v183, v31, v30, s85
v_accvgpr_read_b32 v23, a166
v_mfma_f32_16x16x32_bf16 v[80:83], v[176:179], a[208:211], v[80:83]
v_perm_b32 v184, v17, v16, s84
v_accvgpr_read_b32 v24, a139
v_mfma_f32_16x16x32_bf16 v[84:87], v[176:179], a[212:215], v[84:87]
v_perm_b32 v185, v19, v18, s84
v_accvgpr_read_b32 v25, a143
v_mfma_f32_16x16x32_bf16 v[88:91], v[176:179], a[216:219], v[88:91]
v_perm_b32 v186, v21, v20, s84
v_accvgpr_read_b32 v26, a147
v_mfma_f32_16x16x32_bf16 v[92:95], v[176:179], a[220:223], v[92:95]
v_perm_b32 v187, v23, v22, s84
v_accvgpr_read_b32 v27, a151
v_mfma_f32_16x16x32_bf16 v[108:111], v[180:183], a[220:223], v[108:111]
v_perm_b32 v188, v17, v16, s85
v_accvgpr_read_b32 v28, a155
v_mfma_f32_16x16x32_bf16 v[104:107], v[180:183], a[216:219], v[104:107]
v_perm_b32 v189, v19, v18, s85
v_accvgpr_read_b32 v29, a159
v_mfma_f32_16x16x32_bf16 v[100:103], v[180:183], a[212:215], v[100:103]
v_perm_b32 v190, v21, v20, s85
v_accvgpr_read_b32 v30, a163
v_mfma_f32_16x16x32_bf16 v[96:99], v[180:183], a[208:211], v[96:99]
v_perm_b32 v191, v23, v22, s85
v_accvgpr_read_b32 v31, a167
v_mfma_f32_16x16x32_bf16 v[112:115], v[184:187], a[208:211], v[112:115]
s_waitcnt vmcnt(10)
v_perm_b32 v176, v25, v24, s84
v_accvgpr_read_b32 v16, a168
v_mfma_f32_16x16x32_bf16 v[116:119], v[184:187], a[212:215], v[116:119]
global_load_dwordx4 a[136:139], v32, s[20:21] offset:-4096 sc1
v_perm_b32 v177, v27, v26, s84
v_accvgpr_read_b32 v17, a172
v_mfma_f32_16x16x32_bf16 v[120:123], v[184:187], a[216:219], v[120:123]
v_perm_b32 v178, v29, v28, s84
v_accvgpr_read_b32 v18, a176
v_mfma_f32_16x16x32_bf16 v[124:127], v[184:187], a[220:223], v[124:127]
global_load_dwordx4 a[140:143], v32, s[20:21] offset:-3072 sc1
v_perm_b32 v179, v31, v30, s84
v_accvgpr_read_b32 v19, a180
v_mfma_f32_16x16x32_bf16 v[140:143], v[188:191], a[220:223], v[140:143]
v_perm_b32 v180, v25, v24, s85
v_accvgpr_read_b32 v20, a184
v_mfma_f32_16x16x32_bf16 v[136:139], v[188:191], a[216:219], v[136:139]
global_load_dwordx4 a[144:147], v32, s[20:21] offset:-2048 sc1
v_perm_b32 v181, v27, v26, s85
v_accvgpr_read_b32 v21, a188
v_mfma_f32_16x16x32_bf16 v[132:135], v[188:191], a[212:215], v[132:135]
v_perm_b32 v182, v29, v28, s85
v_accvgpr_read_b32 v22, a192
v_mfma_f32_16x16x32_bf16 v[128:131], v[188:191], a[208:211], v[128:131]
global_load_dwordx4 a[148:151], v32, s[20:21] offset:-1024 sc1
v_perm_b32 v183, v31, v30, s85
v_accvgpr_read_b32 v23, a196
v_mfma_f32_16x16x32_bf16 v[144:147], v[176:179], a[208:211], v[144:147]
v_perm_b32 v184, v17, v16, s84
v_accvgpr_read_b32 v24, a169
v_mfma_f32_16x16x32_bf16 v[148:151], v[176:179], a[212:215], v[148:151]
global_load_dwordx4 a[152:155], v32, s[20:21] offset:0 sc1
v_perm_b32 v185, v19, v18, s84
v_accvgpr_read_b32 v25, a173
v_mfma_f32_16x16x32_bf16 v[152:155], v[176:179], a[216:219], v[152:155]
v_perm_b32 v186, v21, v20, s84
v_accvgpr_read_b32 v26, a177
v_mfma_f32_16x16x32_bf16 v[156:159], v[176:179], a[220:223], v[156:159]
global_load_dwordx4 a[156:159], v32, s[20:21] offset:1024 sc1
v_perm_b32 v187, v23, v22, s84
v_accvgpr_read_b32 v27, a181
v_mfma_f32_16x16x32_bf16 v[172:175], v[180:183], a[220:223], v[172:175]
v_perm_b32 v188, v17, v16, s85
v_accvgpr_read_b32 v28, a185
v_mfma_f32_16x16x32_bf16 v[168:171], v[180:183], a[216:219], v[168:171]
global_load_dwordx4 a[160:163], v32, s[20:21] offset:2048 sc1
v_perm_b32 v189, v19, v18, s85
v_accvgpr_read_b32 v29, a189
v_mfma_f32_16x16x32_bf16 v[164:167], v[180:183], a[212:215], v[164:167]
v_perm_b32 v190, v21, v20, s85
v_accvgpr_read_b32 v30, a193
v_mfma_f32_16x16x32_bf16 v[160:163], v[180:183], a[208:211], v[160:163]
s_waitcnt lgkmcnt(3)
global_load_dwordx4 a[164:167], v32, s[20:21] offset:3072 sc1
v_perm_b32 v191, v23, v22, s85
v_accvgpr_read_b32 v31, a197
v_mfma_f32_16x16x32_bf16 v[48:51], v[184:187], a[224:227], v[48:51]
s_waitcnt lgkmcnt(2)
ds_read_b128 a[208:211], v3 offset:0
v_perm_b32 v176, v25, v24, s84
v_accvgpr_read_b32 v16, a170
v_mfma_f32_16x16x32_bf16 v[52:55], v[184:187], a[228:231], v[52:55]
s_waitcnt lgkmcnt(2)
ds_read_b128 a[212:215], v3 offset:2048
v_perm_b32 v177, v27, v26, s84
v_accvgpr_read_b32 v17, a174
v_add_u32 v32, 8192, v32
v_mfma_f32_16x16x32_bf16 v[56:59], v[184:187], a[232:235], v[56:59]
s_waitcnt lgkmcnt(2)
ds_read_b128 a[216:219], v3 offset:4096
v_perm_b32 v178, v29, v28, s84
v_accvgpr_read_b32 v18, a178
v_mfma_f32_16x16x32_bf16 v[60:63], v[184:187], a[236:239], v[60:63]
v_perm_b32 v179, v31, v30, s84
v_accvgpr_read_b32 v19, a182
v_mfma_f32_16x16x32_bf16 v[76:79], v[188:191], a[236:239], v[76:79]
ds_read_b128 a[220:223], v3 offset:6144
v_perm_b32 v180, v25, v24, s85
v_accvgpr_read_b32 v20, a186
v_mfma_f32_16x16x32_bf16 v[72:75], v[188:191], a[232:235], v[72:75]
v_perm_b32 v181, v27, v26, s85
v_accvgpr_read_b32 v21, a190
v_mfma_f32_16x16x32_bf16 v[68:71], v[188:191], a[228:231], v[68:71]
v_perm_b32 v182, v29, v28, s85
v_accvgpr_read_b32 v22, a194
v_mfma_f32_16x16x32_bf16 v[64:67], v[188:191], a[224:227], v[64:67]
v_perm_b32 v183, v31, v30, s85
v_accvgpr_read_b32 v23, a198
v_mfma_f32_16x16x32_bf16 v[80:83], v[176:179], a[224:227], v[80:83]
v_perm_b32 v184, v17, v16, s84
v_accvgpr_read_b32 v24, a171
v_mfma_f32_16x16x32_bf16 v[84:87], v[176:179], a[228:231], v[84:87]
v_perm_b32 v185, v19, v18, s84
v_accvgpr_read_b32 v25, a175
v_mfma_f32_16x16x32_bf16 v[88:91], v[176:179], a[232:235], v[88:91]
v_perm_b32 v186, v21, v20, s84
v_accvgpr_read_b32 v26, a179
v_mfma_f32_16x16x32_bf16 v[92:95], v[176:179], a[236:239], v[92:95]
v_perm_b32 v187, v23, v22, s84
v_accvgpr_read_b32 v27, a183
v_mfma_f32_16x16x32_bf16 v[108:111], v[180:183], a[236:239], v[108:111]
v_perm_b32 v188, v17, v16, s85
v_accvgpr_read_b32 v28, a187
v_mfma_f32_16x16x32_bf16 v[104:107], v[180:183], a[232:235], v[104:107]
v_perm_b32 v189, v19, v18, s85
v_accvgpr_read_b32 v29, a191
v_mfma_f32_16x16x32_bf16 v[100:103], v[180:183], a[228:231], v[100:103]
v_perm_b32 v190, v21, v20, s85
v_accvgpr_read_b32 v30, a195
v_mfma_f32_16x16x32_bf16 v[96:99], v[180:183], a[224:227], v[96:99]
v_perm_b32 v191, v23, v22, s85
v_accvgpr_read_b32 v31, a199
v_mfma_f32_16x16x32_bf16 v[112:115], v[184:187], a[224:227], v[112:115]
v_perm_b32 v176, v25, v24, s84
v_mfma_f32_16x16x32_bf16 v[116:119], v[184:187], a[228:231], v[116:119]
global_load_dwordx4 a[168:171], v32, s[20:21] offset:-4096 sc1
v_perm_b32 v177, v27, v26, s84
v_mfma_f32_16x16x32_bf16 v[120:123], v[184:187], a[232:235], v[120:123]
v_perm_b32 v178, v29, v28, s84
v_mfma_f32_16x16x32_bf16 v[124:127], v[184:187], a[236:239], v[124:127]
global_load_dwordx4 a[172:175], v32, s[20:21] offset:-3072 sc1
v_perm_b32 v179, v31, v30, s84
v_mfma_f32_16x16x32_bf16 v[140:143], v[188:191], a[236:239], v[140:143]
ds_read_b128 v[204:207], v13 offset:528
v_perm_b32 v180, v25, v24, s85
v_mfma_f32_16x16x32_bf16 v[136:139], v[188:191], a[232:235], v[136:139]
global_load_dwordx4 a[176:179], v32, s[20:21] offset:-2048 sc1
ds_read_b128 v[220:223], v13 offset:640
v_perm_b32 v181, v27, v26, s85
v_mfma_f32_16x16x32_bf16 v[132:135], v[188:191], a[228:231], v[132:135]
ds_read_b128 v[236:239], v13 offset:656
v_perm_b32 v182, v29, v28, s85
v_mfma_f32_16x16x32_bf16 v[128:131], v[188:191], a[224:227], v[128:131]
global_load_dwordx4 a[180:183], v32, s[20:21] offset:-1024 sc1
ds_read_b128 v[252:255], v14
v_perm_b32 v183, v31, v30, s85
v_mfma_f32_16x16x32_bf16 v[144:147], v[176:179], a[224:227], v[144:147]
ds_read_b128 v[188:191], v13 offset:512
v_mfma_f32_16x16x32_bf16 v[148:151], v[176:179], a[228:231], v[148:151]
global_load_dwordx4 a[184:187], v32, s[20:21] offset:0 sc1
v_mfma_f32_16x16x32_bf16 v[152:155], v[176:179], a[232:235], v[152:155]
v_mfma_f32_16x16x32_bf16 v[156:159], v[176:179], a[236:239], v[156:159]
global_load_dwordx4 a[188:191], v32, s[20:21] offset:1024 sc1
v_mfma_f32_16x16x32_bf16 v[172:175], v[180:183], a[236:239], v[172:175]
v_mfma_f32_16x16x32_bf16 v[168:171], v[180:183], a[232:235], v[168:171]
global_load_dwordx4 a[192:195], v32, s[20:21] offset:2048 sc1
v_mfma_f32_16x16x32_bf16 v[164:167], v[180:183], a[228:231], v[164:167]
v_mfma_f32_16x16x32_bf16 v[160:163], v[180:183], a[224:227], v[160:163]
global_load_dwordx4 a[196:199], v32, s[20:21] offset:3072 sc1
.p2align 6
Lloop:
s_waitcnt vmcnt(24) lgkmcnt(0)
v_mfma_f32_16x16x32_bf16 v[176:179], a[104:107], a[208:211], v[188:191]
s_waitcnt lgkmcnt(2)
ds_read_b128 a[224:227], v4 offset:0
ds_read_b128 v[16:19], v40 offset:0
v_mfma_f32_16x16x32_bf16 v[180:183], a[104:107], a[212:215], v[188:191]
s_waitcnt lgkmcnt(3)
ds_read_b128 a[228:231], v4 offset:2048
ds_read_b128 v[20:23], v41 offset:0
v_mfma_f32_16x16x32_bf16 v[184:187], a[104:107], a[216:219], v[188:191]
s_waitcnt lgkmcnt(4)
ds_read_b128 a[232:235], v4 offset:4096
v_accvgpr_read_b32 v24, a0
v_mfma_f32_16x16x32_bf16 v[188:191], a[104:107], a[220:223], v[188:191]
s_waitcnt vmcnt(22)
global_load_dwordx4 a[104:107], v2, s[20:21] offset:-4096 sc1
v_accvgpr_read_b32 v25, a1
v_mfma_f32_16x16x32_bf16 v[192:195], a[108:111], a[208:211], v[204:207]
ds_read_b128 a[236:239], v4 offset:6144
v_accvgpr_read_b32 v26, a2
v_mfma_f32_16x16x32_bf16 v[196:199], a[108:111], a[212:215], v[204:207]
v_accvgpr_read_b32 v27, a3
v_lshlrev_b32 v28, 16, v24
v_mfma_f32_16x16x32_bf16 v[200:203], a[108:111], a[216:219], v[204:207]
s_waitcnt lgkmcnt(4)
v_and_b32 v29, s25, v24
v_lshlrev_b32 v30, 16, v16
v_mfma_f32_16x16x32_bf16 v[204:207], a[108:111], a[220:223], v[204:207]
s_waitcnt vmcnt(22)
global_load_dwordx4 a[108:111], v2, s[20:21] offset:-3072 sc1
v_and_b32 v31, s25, v16
v_mfma_f32_16x16x32_bf16 v[208:211], a[112:115], a[208:211], v[220:223]
v_fma_f32 v48, v28, v48, v30
v_fma_f32 v64, v29, v64, v31
v_mfma_f32_16x16x32_bf16 v[212:215], a[112:115], a[212:215], v[220:223]
v_cvt_pk_bf16_f32 v48, v48, v64
v_accvgpr_write_b32 a240, v48
v_mfma_f32_16x16x32_bf16 v[216:219], a[112:115], a[216:219], v[220:223]
v_lshlrev_b32 v32, 16, v25
v_and_b32 v33, s25, v25
v_mfma_f32_16x16x32_bf16 v[220:223], a[112:115], a[220:223], v[220:223]
s_waitcnt vmcnt(22)
global_load_dwordx4 a[112:115], v2, s[20:21] offset:-2048 sc1
v_lshlrev_b32 v34, 16, v17
v_mfma_f32_16x16x32_bf16 v[224:227], a[116:119], a[208:211], v[236:239]
v_and_b32 v35, s25, v17
v_fma_f32 v80, v32, v80, v34
v_mfma_f32_16x16x32_bf16 v[228:231], a[116:119], a[212:215], v[236:239]
v_fma_f32 v96, v33, v96, v35
v_cvt_pk_bf16_f32 v80, v80, v96
v_mfma_f32_16x16x32_bf16 v[232:235], a[116:119], a[216:219], v[236:239]
v_accvgpr_write_b32 a241, v80
v_lshlrev_b32 v28, 16, v26
v_mfma_f32_16x16x32_bf16 v[236:239], a[116:119], a[220:223], v[236:239]
s_waitcnt vmcnt(22)
global_load_dwordx4 a[116:119], v2, s[20:21] offset:-1024 sc1
v_and_b32 v29, s25, v26
v_mfma_f32_16x16x32_bf16 v[240:243], a[120:123], a[208:211], v[252:255]
v_lshlrev_b32 v30, 16, v18
v_and_b32 v31, s25, v18
v_mfma_f32_16x16x32_bf16 v[244:247], a[120:123], a[212:215], v[252:255]
v_fma_f32 v112, v28, v112, v30
v_fma_f32 v128, v29, v128, v31
v_mfma_f32_16x16x32_bf16 v[248:251], a[120:123], a[216:219], v[252:255]
v_cvt_pk_bf16_f32 v112, v112, v128
v_accvgpr_write_b32 a242, v112
v_mfma_f32_16x16x32_bf16 v[252:255], a[120:123], a[220:223], v[252:255]
s_waitcnt vmcnt(22)
global_load_dwordx4 a[120:123], v2, s[20:21] offset:0 sc1
v_lshlrev_b32 v32, 16, v27
v_mfma_f32_16x16x32_bf16 v[176:179], a[124:127], a[224:227], v[176:179]
s_waitcnt lgkmcnt(3)
ds_read_b128 a[208:211], v5 offset:0
v_and_b32 v33, s25, v27
v_mfma_f32_16x16x32_bf16 v[180:183], a[124:127], a[228:231], v[180:183]
s_waitcnt lgkmcnt(2)
ds_read_b128 a[212:215], v5 offset:2048
v_lshlrev_b32 v34, 16, v19
v_mfma_f32_16x16x32_bf16 v[184:187], a[124:127], a[232:235], v[184:187]
s_waitcnt lgkmcnt(2)
ds_read_b128 a[216:219], v5 offset:4096
v_and_b32 v35, s25, v19
v_mfma_f32_16x16x32_bf16 v[188:191], a[124:127], a[236:239], v[188:191]
s_waitcnt vmcnt(22)
global_load_dwordx4 a[124:127], v2, s[20:21] offset:1024 sc1
v_fma_f32 v144, v32, v144, v34
v_mfma_f32_16x16x32_bf16 v[204:207], a[128:131], a[236:239], v[204:207]
ds_read_b128 a[220:223], v5 offset:6144
v_fma_f32 v160, v33, v160, v35
v_mfma_f32_16x16x32_bf16 v[200:203], a[128:131], a[232:235], v[200:203]
v_cvt_pk_bf16_f32 v144, v144, v160
v_accvgpr_write_b32 a243, v144
v_mfma_f32_16x16x32_bf16 v[196:199], a[128:131], a[228:231], v[196:199]
v_mfma_f32_16x16x32_bf16 v[192:195], a[128:131], a[224:227], v[192:195]
s_waitcnt vmcnt(22)
global_load_dwordx4 a[128:131], v2, s[20:21] offset:2048 sc1
v_mfma_f32_16x16x32_bf16 v[208:211], a[132:135], a[224:227], v[208:211]
ds_read_b128 v[16:19], v42 offset:0
v_accvgpr_read_b32 v24, a16
v_mfma_f32_16x16x32_bf16 v[212:215], a[132:135], a[228:231], v[212:215]
v_accvgpr_read_b32 v25, a17
v_accvgpr_read_b32 v26, a18
v_mfma_f32_16x16x32_bf16 v[216:219], a[132:135], a[232:235], v[216:219]
v_accvgpr_read_b32 v27, a19
v_lshlrev_b32 v28, 16, v24
v_mfma_f32_16x16x32_bf16 v[220:223], a[132:135], a[236:239], v[220:223]
s_waitcnt vmcnt(22)
global_load_dwordx4 a[132:135], v2, s[20:21] offset:3072 sc1
v_add_u32 v2, 8192, v2
v_mfma_f32_16x16x32_bf16 v[236:239], a[136:139], a[236:239], v[236:239]
v_and_b32 v29, s25, v24
v_lshlrev_b32 v30, 16, v20
v_mfma_f32_16x16x32_bf16 v[232:235], a[136:139], a[232:235], v[232:235]
v_and_b32 v31, s25, v20
v_fma_f32 v49, v28, v49, v30
v_mfma_f32_16x16x32_bf16 v[228:231], a[136:139], a[228:231], v[228:231]
v_fma_f32 v65, v29, v65, v31
v_cvt_pk_bf16_f32 v49, v49, v65
v_mfma_f32_16x16x32_bf16 v[224:227], a[136:139], a[224:227], v[224:227]
s_waitcnt vmcnt(22)
global_load_dwordx4 a[136:139], v2, s[20:21] offset:-4096 sc1
v_accvgpr_write_b32 a244, v49
v_mfma_f32_16x16x32_bf16 v[240:243], a[140:143], a[224:227], v[240:243]
v_lshlrev_b32 v32, 16, v25
v_and_b32 v33, s25, v25
v_mfma_f32_16x16x32_bf16 v[244:247], a[140:143], a[228:231], v[244:247]
v_lshlrev_b32 v34, 16, v21
v_and_b32 v35, s25, v21
v_mfma_f32_16x16x32_bf16 v[248:251], a[140:143], a[232:235], v[248:251]
v_fma_f32 v81, v32, v81, v34
v_fma_f32 v97, v33, v97, v35
v_mfma_f32_16x16x32_bf16 v[252:255], a[140:143], a[236:239], v[252:255]
s_waitcnt vmcnt(22) lgkmcnt(4)
global_load_dwordx4 a[140:143], v2, s[20:21] offset:-3072 sc1
v_cvt_pk_bf16_f32 v81, v81, v97
v_mfma_f32_16x16x32_bf16 v[176:179], a[144:147], a[208:211], v[176:179]
s_waitcnt lgkmcnt(3)
ds_read_b128 a[224:227], v6 offset:0
v_accvgpr_write_b32 a245, v81
v_mfma_f32_16x16x32_bf16 v[180:183], a[144:147], a[212:215], v[180:183]
s_waitcnt lgkmcnt(3)
ds_read_b128 a[228:231], v6 offset:2048
v_lshlrev_b32 v28, 16, v26
v_mfma_f32_16x16x32_bf16 v[184:187], a[144:147], a[216:219], v[184:187]
s_waitcnt lgkmcnt(3)
ds_read_b128 a[232:235], v6 offset:4096
v_and_b32 v29, s25, v26
v_mfma_f32_16x16x32_bf16 v[188:191], a[144:147], a[220:223], v[188:191]
s_waitcnt vmcnt(22)
global_load_dwordx4 a[144:147], v2, s[20:21] offset:-2048 sc1
v_lshlrev_b32 v30, 16, v22
v_mfma_f32_16x16x32_bf16 v[204:207], a[148:151], a[220:223], v[204:207]
ds_read_b128 a[236:239], v6 offset:6144
v_and_b32 v31, s25, v22
v_mfma_f32_16x16x32_bf16 v[200:203], a[148:151], a[216:219], v[200:203]
v_fma_f32 v113, v28, v113, v30
v_fma_f32 v129, v29, v129, v31
v_mfma_f32_16x16x32_bf16 v[196:199], a[148:151], a[212:215], v[196:199]
v_cvt_pk_bf16_f32 v113, v113, v129
v_accvgpr_write_b32 a246, v113
v_mfma_f32_16x16x32_bf16 v[192:195], a[148:151], a[208:211], v[192:195]
s_waitcnt vmcnt(22)
global_load_dwordx4 a[148:151], v2, s[20:21] offset:-1024 sc1
v_lshlrev_b32 v32, 16, v27
v_mfma_f32_16x16x32_bf16 v[208:211], a[152:155], a[208:211], v[208:211]
v_and_b32 v33, s25, v27
v_lshlrev_b32 v34, 16, v23
v_mfma_f32_16x16x32_bf16 v[212:215], a[152:155], a[212:215], v[212:215]
v_and_b32 v35, s25, v23
v_fma_f32 v145, v32, v145, v34
v_mfma_f32_16x16x32_bf16 v[216:219], a[152:155], a[216:219], v[216:219]
v_fma_f32 v161, v33, v161, v35
v_cvt_pk_bf16_f32 v145, v145, v161
v_mfma_f32_16x16x32_bf16 v[220:223], a[152:155], a[220:223], v[220:223]
s_waitcnt vmcnt(22)
global_load_dwordx4 a[152:155], v2, s[20:21] offset:0 sc1
v_accvgpr_write_b32 a247, v145
v_mfma_f32_16x16x32_bf16 v[236:239], a[156:159], a[220:223], v[236:239]
v_mfma_f32_16x16x32_bf16 v[232:235], a[156:159], a[216:219], v[232:235]
v_mfma_f32_16x16x32_bf16 v[228:231], a[156:159], a[212:215], v[228:231]
v_mfma_f32_16x16x32_bf16 v[224:227], a[156:159], a[208:211], v[224:227]
s_waitcnt vmcnt(22)
global_load_dwordx4 a[156:159], v2, s[20:21] offset:1024 sc1
v_mfma_f32_16x16x32_bf16 v[240:243], a[160:163], a[208:211], v[240:243]
v_mfma_f32_16x16x32_bf16 v[244:247], a[160:163], a[212:215], v[244:247]
ds_read_b128 v[20:23], v43 offset:0
v_accvgpr_read_b32 v24, a32
v_mfma_f32_16x16x32_bf16 v[248:251], a[160:163], a[216:219], v[248:251]
v_accvgpr_read_b32 v25, a33
v_accvgpr_read_b32 v26, a34
v_mfma_f32_16x16x32_bf16 v[252:255], a[160:163], a[220:223], v[252:255]
s_waitcnt vmcnt(22) lgkmcnt(4)
global_load_dwordx4 a[160:163], v2, s[20:21] offset:2048 sc1
v_accvgpr_read_b32 v27, a35
v_mfma_f32_16x16x32_bf16 v[176:179], a[164:167], a[224:227], v[176:179]
s_waitcnt lgkmcnt(3)
ds_read_b128 a[208:211], v44 offset:0
v_lshlrev_b32 v28, 16, v24
v_mfma_f32_16x16x32_bf16 v[180:183], a[164:167], a[228:231], v[180:183]
s_waitcnt lgkmcnt(3)
ds_read_b128 a[212:215], v44 offset:2048
v_and_b32 v29, s25, v24
v_mfma_f32_16x16x32_bf16 v[184:187], a[164:167], a[232:235], v[184:187]
s_waitcnt lgkmcnt(3)
ds_read_b128 a[216:219], v44 offset:4096
v_lshlrev_b32 v30, 16, v16
v_mfma_f32_16x16x32_bf16 v[188:191], a[164:167], a[236:239], v[188:191]
s_waitcnt vmcnt(22)
global_load_dwordx4 a[164:167], v2, s[20:21] offset:3072 sc1
v_add_u32 v2, 8192, v2
v_mfma_f32_16x16x32_bf16 v[204:207], a[168:171], a[236:239], v[204:207]
ds_read_b128 a[220:223], v44 offset:6144
v_and_b32 v31, s25, v16
v_mfma_f32_16x16x32_bf16 v[200:203], a[168:171], a[232:235], v[200:203]
v_fma_f32 v50, v28, v50, v30
v_fma_f32 v66, v29, v66, v31
v_mfma_f32_16x16x32_bf16 v[196:199], a[168:171], a[228:231], v[196:199]
v_cvt_pk_bf16_f32 v50, v50, v66
v_accvgpr_write_b32 a248, v50
v_mfma_f32_16x16x32_bf16 v[192:195], a[168:171], a[224:227], v[192:195]
s_waitcnt vmcnt(22)
global_load_dwordx4 a[168:171], v2, s[20:21] offset:-4096 sc1
v_lshlrev_b32 v32, 16, v25
v_mfma_f32_16x16x32_bf16 v[208:211], a[172:175], a[224:227], v[208:211]
v_and_b32 v33, s25, v25
v_lshlrev_b32 v34, 16, v17
v_mfma_f32_16x16x32_bf16 v[212:215], a[172:175], a[228:231], v[212:215]
v_and_b32 v35, s25, v17
v_fma_f32 v82, v32, v82, v34
v_mfma_f32_16x16x32_bf16 v[216:219], a[172:175], a[232:235], v[216:219]
v_fma_f32 v98, v33, v98, v35
v_cvt_pk_bf16_f32 v82, v82, v98
v_mfma_f32_16x16x32_bf16 v[220:223], a[172:175], a[236:239], v[220:223]
s_waitcnt vmcnt(22)
global_load_dwordx4 a[172:175], v2, s[20:21] offset:-3072 sc1
v_accvgpr_write_b32 a249, v82
v_mfma_f32_16x16x32_bf16 v[236:239], a[176:179], a[236:239], v[236:239]
v_lshlrev_b32 v28, 16, v26
v_and_b32 v29, s25, v26
v_mfma_f32_16x16x32_bf16 v[232:235], a[176:179], a[232:235], v[232:235]
v_lshlrev_b32 v30, 16, v18
v_and_b32 v31, s25, v18
v_mfma_f32_16x16x32_bf16 v[228:231], a[176:179], a[228:231], v[228:231]
v_fma_f32 v114, v28, v114, v30
v_fma_f32 v130, v29, v130, v31
v_mfma_f32_16x16x32_bf16 v[224:227], a[176:179], a[224:227], v[224:227]
s_waitcnt vmcnt(22)
global_load_dwordx4 a[176:179], v2, s[20:21] offset:-2048 sc1
v_cvt_pk_bf16_f32 v114, v114, v130
v_mfma_f32_16x16x32_bf16 v[240:243], a[180:183], a[224:227], v[240:243]
v_accvgpr_write_b32 a250, v114
v_lshlrev_b32 v32, 16, v27
v_mfma_f32_16x16x32_bf16 v[244:247], a[180:183], a[228:231], v[244:247]
v_and_b32 v33, s25, v27
v_lshlrev_b32 v34, 16, v19
v_mfma_f32_16x16x32_bf16 v[248:251], a[180:183], a[232:235], v[248:251]
v_and_b32 v35, s25, v19
v_fma_f32 v146, v32, v146, v34
v_mfma_f32_16x16x32_bf16 v[252:255], a[180:183], a[236:239], v[252:255]
s_waitcnt vmcnt(22) lgkmcnt(3)
global_load_dwordx4 a[180:183], v2, s[20:21] offset:-1024 sc1
v_fma_f32 v162, v33, v162, v35
v_mfma_f32_16x16x32_bf16 v[176:179], a[184:187], a[208:211], v[176:179]
s_waitcnt lgkmcnt(2)
ds_read_b128 a[224:227], v45 offset:0
v_cvt_pk_bf16_f32 v146, v146, v162
v_mfma_f32_16x16x32_bf16 v[180:183], a[184:187], a[212:215], v[180:183]
s_waitcnt lgkmcnt(2)
ds_read_b128 a[228:231], v45 offset:2048
v_accvgpr_write_b32 a251, v146
v_mfma_f32_16x16x32_bf16 v[184:187], a[184:187], a[216:219], v[184:187]
s_waitcnt lgkmcnt(2)
ds_read_b128 a[232:235], v45 offset:4096
v_mfma_f32_16x16x32_bf16 v[188:191], a[184:187], a[220:223], v[188:191]
s_waitcnt vmcnt(22)
global_load_dwordx4 a[184:187], v2, s[20:21] offset:0 sc1
v_mfma_f32_16x16x32_bf16 v[204:207], a[188:191], a[220:223], v[204:207]
ds_read_b128 a[236:239], v45 offset:6144
v_mfma_f32_16x16x32_bf16 v[200:203], a[188:191], a[216:219], v[200:203]
v_mfma_f32_16x16x32_bf16 v[196:199], a[188:191], a[212:215], v[196:199]
ds_read_b128 v[16:19], v40 offset:2048
v_accvgpr_read_b32 v24, a48
v_mfma_f32_16x16x32_bf16 v[192:195], a[188:191], a[208:211], v[192:195]
s_waitcnt vmcnt(22)
global_load_dwordx4 a[188:191], v2, s[20:21] offset:1024 sc1
v_accvgpr_read_b32 v25, a49
v_mfma_f32_16x16x32_bf16 v[208:211], a[192:195], a[208:211], v[208:211]
v_accvgpr_read_b32 v26, a50
v_accvgpr_read_b32 v27, a51
v_mfma_f32_16x16x32_bf16 v[212:215], a[192:195], a[212:215], v[212:215]
v_lshlrev_b32 v28, 16, v24
v_and_b32 v29, s25, v24
v_mfma_f32_16x16x32_bf16 v[216:219], a[192:195], a[216:219], v[216:219]
v_lshlrev_b32 v30, 16, v20
v_and_b32 v31, s25, v20
v_mfma_f32_16x16x32_bf16 v[220:223], a[192:195], a[220:223], v[220:223]
s_waitcnt vmcnt(22)
global_load_dwordx4 a[192:195], v2, s[20:21] offset:2048 sc1
v_fma_f32 v51, v28, v51, v30
v_mfma_f32_16x16x32_bf16 v[236:239], a[196:199], a[220:223], v[236:239]
v_fma_f32 v67, v29, v67, v31
v_cvt_pk_bf16_f32 v51, v51, v67
v_mfma_f32_16x16x32_bf16 v[232:235], a[196:199], a[216:219], v[232:235]
v_accvgpr_write_b32 a252, v51
v_lshlrev_b32 v32, 16, v25
v_mfma_f32_16x16x32_bf16 v[228:231], a[196:199], a[212:215], v[228:231]
v_and_b32 v33, s25, v25
v_lshlrev_b32 v34, 16, v21
v_mfma_f32_16x16x32_bf16 v[224:227], a[196:199], a[208:211], v[224:227]
s_waitcnt vmcnt(24)
global_load_dwordx4 a[196:199], v2, s[20:21] offset:3072 sc1
v_add_u32 v2, 8192, v2
v_mfma_f32_16x16x32_bf16 v[240:243], a[200:203], a[208:211], v[240:243]
v_and_b32 v35, s25, v21
v_fma_f32 v83, v32, v83, v34
v_mfma_f32_16x16x32_bf16 v[244:247], a[200:203], a[212:215], v[244:247]
v_fma_f32 v99, v33, v99, v35
v_cvt_pk_bf16_f32 v83, v83, v99
v_mfma_f32_16x16x32_bf16 v[248:251], a[200:203], a[216:219], v[248:251]
v_accvgpr_write_b32 a253, v83
v_lshlrev_b32 v28, 16, v26
v_mfma_f32_16x16x32_bf16 v[252:255], a[200:203], a[220:223], v[252:255]
s_waitcnt vmcnt(24) lgkmcnt(4)
global_load_dwordx4 a[200:203], v2, s[20:21] offset:-4096 sc1
v_and_b32 v29, s25, v26
v_mfma_f32_16x16x32_bf16 v[176:179], a[204:207], a[224:227], v[176:179]
s_waitcnt lgkmcnt(3)
ds_read_b128 a[208:211], v46 offset:0
v_lshlrev_b32 v30, 16, v22
v_mfma_f32_16x16x32_bf16 v[180:183], a[204:207], a[228:231], v[180:183]
s_waitcnt lgkmcnt(3)
ds_read_b128 a[212:215], v46 offset:2048
v_and_b32 v31, s25, v22
v_mfma_f32_16x16x32_bf16 v[184:187], a[204:207], a[232:235], v[184:187]
s_waitcnt lgkmcnt(3)
ds_read_b128 a[216:219], v46 offset:4096
v_fma_f32 v115, v28, v115, v30
v_mfma_f32_16x16x32_bf16 v[188:191], a[204:207], a[236:239], v[188:191]
s_waitcnt vmcnt(24)
global_load_dwordx4 a[204:207], v2, s[20:21] offset:-3072 sc1
v_fma_f32 v131, v29, v131, v31
v_mfma_f32_16x16x32_bf16 v[204:207], a[104:107], a[236:239], v[204:207]
ds_read_b128 a[220:223], v46 offset:6144
v_cvt_pk_bf16_f32 v115, v115, v131
v_mfma_f32_16x16x32_bf16 v[200:203], a[104:107], a[232:235], v[200:203]
v_accvgpr_write_b32 a254, v115
v_lshlrev_b32 v32, 16, v27
v_mfma_f32_16x16x32_bf16 v[196:199], a[104:107], a[228:231], v[196:199]
v_and_b32 v33, s25, v27
v_lshlrev_b32 v34, 16, v23
v_mfma_f32_16x16x32_bf16 v[192:195], a[104:107], a[224:227], v[192:195]
s_waitcnt vmcnt(24)
global_load_dwordx4 a[104:107], v2, s[20:21] offset:-2048 sc1
v_and_b32 v35, s25, v23
v_mfma_f32_16x16x32_bf16 v[208:211], a[108:111], a[224:227], v[208:211]
v_fma_f32 v147, v32, v147, v34
v_fma_f32 v163, v33, v163, v35
v_mfma_f32_16x16x32_bf16 v[212:215], a[108:111], a[228:231], v[212:215]
v_cvt_pk_bf16_f32 v147, v147, v163
v_accvgpr_write_b32 a255, v147
v_mfma_f32_16x16x32_bf16 v[216:219], a[108:111], a[232:235], v[216:219]
v_mfma_f32_16x16x32_bf16 v[220:223], a[108:111], a[236:239], v[220:223]
s_waitcnt vmcnt(24)
global_load_dwordx4 a[108:111], v2, s[20:21] offset:-1024 sc1
v_mfma_f32_16x16x32_bf16 v[236:239], a[112:115], a[236:239], v[236:239]
v_mfma_f32_16x16x32_bf16 v[232:235], a[112:115], a[232:235], v[232:235]
v_mfma_f32_16x16x32_bf16 v[228:231], a[112:115], a[228:231], v[228:231]
ds_read_b128 v[20:23], v41 offset:2048
v_accvgpr_read_b32 v24, a4
v_mfma_f32_16x16x32_bf16 v[224:227], a[112:115], a[224:227], v[224:227]
s_waitcnt vmcnt(24)
global_load_dwordx4 a[112:115], v2, s[20:21] offset:0 sc1
v_accvgpr_read_b32 v25, a5
v_mfma_f32_16x16x32_bf16 v[240:243], a[116:119], a[224:227], v[240:243]
v_accvgpr_read_b32 v26, a6
v_accvgpr_read_b32 v27, a7
v_mfma_f32_16x16x32_bf16 v[244:247], a[116:119], a[228:231], v[244:247]
v_lshlrev_b32 v28, 16, v24
v_and_b32 v29, s25, v24
v_mfma_f32_16x16x32_bf16 v[248:251], a[116:119], a[232:235], v[248:251]
s_waitcnt lgkmcnt(5)
v_lshlrev_b32 v30, 16, v16
v_and_b32 v31, s25, v16
v_mfma_f32_16x16x32_bf16 v[252:255], a[116:119], a[236:239], v[252:255]
s_waitcnt vmcnt(24) lgkmcnt(4)
global_load_dwordx4 a[116:119], v2, s[20:21] offset:1024 sc1
v_fma_f32 v52, v28, v52, v30
v_mfma_f32_16x16x32_bf16 v[176:179], a[120:123], a[208:211], v[176:179]
s_waitcnt lgkmcnt(3)
ds_read_b128 a[224:227], v47 offset:0
v_fma_f32 v68, v29, v68, v31
v_mfma_f32_16x16x32_bf16 v[180:183], a[120:123], a[212:215], v[180:183]
s_waitcnt lgkmcnt(3)
ds_read_b128 a[228:231], v47 offset:2048
v_cvt_pk_bf16_f32 v48, v52, v68
v_mfma_f32_16x16x32_bf16 v[184:187], a[120:123], a[216:219], v[184:187]
s_waitcnt lgkmcnt(3)
ds_read_b128 a[232:235], v47 offset:4096
v_lshlrev_b32 v32, 16, v25
v_mfma_f32_16x16x32_bf16 v[188:191], a[120:123], a[220:223], v[188:191]
s_waitcnt vmcnt(24)
global_load_dwordx4 a[120:123], v2, s[20:21] offset:2048 sc1
v_and_b32 v33, s25, v25
v_mfma_f32_16x16x32_bf16 v[204:207], a[124:127], a[220:223], v[204:207]
ds_read_b128 a[236:239], v47 offset:6144
v_lshlrev_b32 v34, 16, v17
v_mfma_f32_16x16x32_bf16 v[200:203], a[124:127], a[216:219], v[200:203]
v_and_b32 v35, s25, v17
v_fma_f32 v84, v32, v84, v34
v_mfma_f32_16x16x32_bf16 v[196:199], a[124:127], a[212:215], v[196:199]
v_fma_f32 v100, v33, v100, v35
v_cvt_pk_bf16_f32 v49, v84, v100
v_mfma_f32_16x16x32_bf16 v[192:195], a[124:127], a[208:211], v[192:195]
s_waitcnt vmcnt(24)
global_load_dwordx4 a[124:127], v2, s[20:21] offset:3072 sc1
v_add_u32 v2, 8192, v2
v_mfma_f32_16x16x32_bf16 v[208:211], a[128:131], a[208:211], v[208:211]
v_lshlrev_b32 v28, 16, v26
v_and_b32 v29, s25, v26
v_mfma_f32_16x16x32_bf16 v[212:215], a[128:131], a[212:215], v[212:215]
v_lshlrev_b32 v30, 16, v18
v_and_b32 v31, s25, v18
v_mfma_f32_16x16x32_bf16 v[216:219], a[128:131], a[216:219], v[216:219]
v_fma_f32 v116, v28, v116, v30
v_fma_f32 v132, v29, v132, v31
v_mfma_f32_16x16x32_bf16 v[220:223], a[128:131], a[220:223], v[220:223]
s_waitcnt vmcnt(24)
global_load_dwordx4 a[128:131], v2, s[20:21] offset:-4096 sc1
v_cvt_pk_bf16_f32 v50, v116, v132
v_mfma_f32_16x16x32_bf16 v[236:239], a[132:135], a[220:223], v[236:239]
v_lshlrev_b32 v32, 16, v27
v_and_b32 v33, s25, v27
v_mfma_f32_16x16x32_bf16 v[232:235], a[132:135], a[216:219], v[232:235]
v_lshlrev_b32 v34, 16, v19
v_and_b32 v35, s25, v19
v_mfma_f32_16x16x32_bf16 v[228:231], a[132:135], a[212:215], v[228:231]
v_fma_f32 v148, v32, v148, v34
v_fma_f32 v164, v33, v164, v35
v_mfma_f32_16x16x32_bf16 v[224:227], a[132:135], a[208:211], v[224:227]
s_waitcnt vmcnt(24)
global_load_dwordx4 a[132:135], v2, s[20:21] offset:-3072 sc1
v_cvt_pk_bf16_f32 v51, v148, v164
v_mfma_f32_16x16x32_bf16 v[240:243], a[136:139], a[208:211], v[240:243]
v_mfma_f32_16x16x32_bf16 v[244:247], a[136:139], a[212:215], v[244:247]
v_mfma_f32_16x16x32_bf16 v[248:251], a[136:139], a[216:219], v[248:251]
v_mfma_f32_16x16x32_bf16 v[252:255], a[136:139], a[220:223], v[252:255]
s_waitcnt vmcnt(24) lgkmcnt(3)
global_load_dwordx4 a[136:139], v2, s[20:21] offset:-2048 sc1
v_mfma_f32_16x16x32_bf16 v[176:179], a[140:143], a[224:227], v[176:179]
s_waitcnt lgkmcnt(2)
ds_read_b128 a[208:211], v3 offset:8192
v_mfma_f32_16x16x32_bf16 v[180:183], a[140:143], a[228:231], v[180:183]
s_waitcnt lgkmcnt(2)
ds_read_b128 a[212:215], v3 offset:10240
v_mfma_f32_16x16x32_bf16 v[184:187], a[140:143], a[232:235], v[184:187]
s_waitcnt lgkmcnt(2)
ds_read_b128 a[216:219], v3 offset:12288
v_mfma_f32_16x16x32_bf16 v[188:191], a[140:143], a[236:239], v[188:191]
s_waitcnt vmcnt(24)
global_load_dwordx4 a[140:143], v2, s[20:21] offset:-1024 sc1
ds_read_b128 v[16:19], v42 offset:2048
v_mfma_f32_16x16x32_bf16 v[204:207], a[144:147], a[236:239], v[204:207]
ds_read_b128 a[220:223], v3 offset:14336
v_accvgpr_read_b32 v24, a20
v_mfma_f32_16x16x32_bf16 v[200:203], a[144:147], a[232:235], v[200:203]
v_accvgpr_read_b32 v25, a21
v_accvgpr_read_b32 v26, a22
v_mfma_f32_16x16x32_bf16 v[196:199], a[144:147], a[228:231], v[196:199]
v_accvgpr_read_b32 v27, a23
v_lshlrev_b32 v28, 16, v24
v_mfma_f32_16x16x32_bf16 v[192:195], a[144:147], a[224:227], v[192:195]
s_waitcnt vmcnt(24)
global_load_dwordx4 a[144:147], v2, s[20:21] offset:0 sc1
v_and_b32 v29, s25, v24
v_mfma_f32_16x16x32_bf16 v[208:211], a[148:151], a[224:227], v[208:211]
v_lshlrev_b32 v30, 16, v20
v_and_b32 v31, s25, v20
v_mfma_f32_16x16x32_bf16 v[212:215], a[148:151], a[228:231], v[212:215]
v_fma_f32 v53, v28, v53, v30
v_fma_f32 v69, v29, v69, v31
v_mfma_f32_16x16x32_bf16 v[216:219], a[148:151], a[232:235], v[216:219]
v_cvt_pk_bf16_f32 v64, v53, v69
v_lshlrev_b32 v32, 16, v25
v_mfma_f32_16x16x32_bf16 v[220:223], a[148:151], a[236:239], v[220:223]
s_waitcnt vmcnt(24)
global_load_dwordx4 a[148:151], v2, s[20:21] offset:1024 sc1
v_and_b32 v33, s25, v25
v_mfma_f32_16x16x32_bf16 v[236:239], a[152:155], a[236:239], v[236:239]
v_lshlrev_b32 v34, 16, v21
v_and_b32 v35, s25, v21
v_mfma_f32_16x16x32_bf16 v[232:235], a[152:155], a[232:235], v[232:235]
v_fma_f32 v85, v32, v85, v34
v_fma_f32 v101, v33, v101, v35
v_mfma_f32_16x16x32_bf16 v[228:231], a[152:155], a[228:231], v[228:231]
v_cvt_pk_bf16_f32 v65, v85, v101
v_lshlrev_b32 v28, 16, v26
v_mfma_f32_16x16x32_bf16 v[224:227], a[152:155], a[224:227], v[224:227]
s_waitcnt vmcnt(24)
global_load_dwordx4 a[152:155], v2, s[20:21] offset:2048 sc1
v_and_b32 v29, s25, v26
v_mfma_f32_16x16x32_bf16 v[240:243], a[156:159], a[224:227], v[240:243]
v_lshlrev_b32 v30, 16, v22
v_and_b32 v31, s25, v22
v_mfma_f32_16x16x32_bf16 v[244:247], a[156:159], a[228:231], v[244:247]
v_fma_f32 v117, v28, v117, v30
v_fma_f32 v133, v29, v133, v31
v_mfma_f32_16x16x32_bf16 v[248:251], a[156:159], a[232:235], v[248:251]
v_cvt_pk_bf16_f32 v66, v117, v133
v_lshlrev_b32 v32, 16, v27
v_mfma_f32_16x16x32_bf16 v[252:255], a[156:159], a[236:239], v[252:255]
s_waitcnt vmcnt(24) lgkmcnt(4)
global_load_dwordx4 a[156:159], v2, s[20:21] offset:3072 sc1
v_add_u32 v2, 8192, v2
v_mfma_f32_16x16x32_bf16 v[176:179], a[160:163], a[208:211], v[176:179]
s_waitcnt lgkmcnt(3)
ds_read_b128 a[224:227], v4 offset:8192
v_and_b32 v33, s25, v27
v_mfma_f32_16x16x32_bf16 v[180:183], a[160:163], a[212:215], v[180:183]
s_waitcnt lgkmcnt(3)
ds_read_b128 a[228:231], v4 offset:10240
v_lshlrev_b32 v34, 16, v23
v_mfma_f32_16x16x32_bf16 v[184:187], a[160:163], a[216:219], v[184:187]
s_waitcnt lgkmcnt(2)
ds_read_b128 a[232:235], v4 offset:12288
v_and_b32 v35, s25, v23
v_mfma_f32_16x16x32_bf16 v[188:191], a[160:163], a[220:223], v[188:191]
s_waitcnt vmcnt(24)
global_load_dwordx4 a[160:163], v2, s[20:21] offset:-4096 sc1
v_fma_f32 v149, v32, v149, v34
v_mfma_f32_16x16x32_bf16 v[204:207], a[164:167], a[220:223], v[204:207]
ds_read_b128 a[236:239], v4 offset:14336
v_fma_f32 v165, v33, v165, v35
v_mfma_f32_16x16x32_bf16 v[200:203], a[164:167], a[216:219], v[200:203]
v_cvt_pk_bf16_f32 v67, v149, v165
v_mfma_f32_16x16x32_bf16 v[196:199], a[164:167], a[212:215], v[196:199]
v_mfma_f32_16x16x32_bf16 v[192:195], a[164:167], a[208:211], v[192:195]
s_waitcnt vmcnt(24)
global_load_dwordx4 a[164:167], v2, s[20:21] offset:-3072 sc1
v_mfma_f32_16x16x32_bf16 v[208:211], a[168:171], a[208:211], v[208:211]
v_mfma_f32_16x16x32_bf16 v[212:215], a[168:171], a[212:215], v[212:215]
v_mfma_f32_16x16x32_bf16 v[216:219], a[168:171], a[216:219], v[216:219]
v_mfma_f32_16x16x32_bf16 v[220:223], a[168:171], a[220:223], v[220:223]
s_waitcnt vmcnt(24)
global_load_dwordx4 a[168:171], v2, s[20:21] offset:-2048 sc1
v_mfma_f32_16x16x32_bf16 v[236:239], a[172:175], a[220:223], v[236:239]
ds_read_b128 v[20:23], v43 offset:2048
v_accvgpr_read_b32 v24, a36
v_mfma_f32_16x16x32_bf16 v[232:235], a[172:175], a[216:219], v[232:235]
v_accvgpr_read_b32 v25, a37
v_accvgpr_read_b32 v26, a38
v_mfma_f32_16x16x32_bf16 v[228:231], a[172:175], a[212:215], v[228:231]
v_accvgpr_read_b32 v27, a39
v_lshlrev_b32 v28, 16, v24
v_mfma_f32_16x16x32_bf16 v[224:227], a[172:175], a[208:211], v[224:227]
s_waitcnt vmcnt(24)
global_load_dwordx4 a[172:175], v2, s[20:21] offset:-1024 sc1
v_and_b32 v29, s25, v24
v_mfma_f32_16x16x32_bf16 v[240:243], a[176:179], a[208:211], v[240:243]
v_lshlrev_b32 v30, 16, v16
v_and_b32 v31, s25, v16
v_mfma_f32_16x16x32_bf16 v[244:247], a[176:179], a[212:215], v[244:247]
v_fma_f32 v54, v28, v54, v30
v_fma_f32 v70, v29, v70, v31
v_mfma_f32_16x16x32_bf16 v[248:251], a[176:179], a[216:219], v[248:251]
v_cvt_pk_bf16_f32 v80, v54, v70
v_lshlrev_b32 v32, 16, v25
v_mfma_f32_16x16x32_bf16 v[252:255], a[176:179], a[220:223], v[252:255]
s_waitcnt vmcnt(24) lgkmcnt(4)
global_load_dwordx4 a[176:179], v2, s[20:21] offset:0 sc1
v_and_b32 v33, s25, v25
v_mfma_f32_16x16x32_bf16 v[176:179], a[180:183], a[224:227], v[176:179]
s_waitcnt lgkmcnt(3)
ds_read_b128 a[208:211], v5 offset:8192
v_lshlrev_b32 v34, 16, v17
v_mfma_f32_16x16x32_bf16 v[180:183], a[180:183], a[228:231], v[180:183]
s_waitcnt lgkmcnt(3)
ds_read_b128 a[212:215], v5 offset:10240
v_and_b32 v35, s25, v17
v_mfma_f32_16x16x32_bf16 v[184:187], a[180:183], a[232:235], v[184:187]
s_waitcnt lgkmcnt(3)
ds_read_b128 a[216:219], v5 offset:12288
v_fma_f32 v86, v32, v86, v34
v_mfma_f32_16x16x32_bf16 v[188:191], a[180:183], a[236:239], v[188:191]
s_waitcnt vmcnt(24)
global_load_dwordx4 a[180:183], v2, s[20:21] offset:1024 sc1
v_fma_f32 v102, v33, v102, v35
v_mfma_f32_16x16x32_bf16 v[204:207], a[184:187], a[236:239], v[204:207]
ds_read_b128 a[220:223], v5 offset:14336
v_cvt_pk_bf16_f32 v81, v86, v102
v_mfma_f32_16x16x32_bf16 v[200:203], a[184:187], a[232:235], v[200:203]
v_lshlrev_b32 v28, 16, v26
v_and_b32 v29, s25, v26
v_mfma_f32_16x16x32_bf16 v[196:199], a[184:187], a[228:231], v[196:199]
v_lshlrev_b32 v30, 16, v18
v_and_b32 v31, s25, v18
v_mfma_f32_16x16x32_bf16 v[192:195], a[184:187], a[224:227], v[192:195]
s_waitcnt vmcnt(24)
global_load_dwordx4 a[184:187], v2, s[20:21] offset:2048 sc1
v_fma_f32 v118, v28, v118, v30
v_mfma_f32_16x16x32_bf16 v[208:211], a[188:191], a[224:227], v[208:211]
v_fma_f32 v134, v29, v134, v31
v_cvt_pk_bf16_f32 v82, v118, v134
v_mfma_f32_16x16x32_bf16 v[212:215], a[188:191], a[228:231], v[212:215]
v_lshlrev_b32 v32, 16, v27
v_and_b32 v33, s25, v27
v_mfma_f32_16x16x32_bf16 v[216:219], a[188:191], a[232:235], v[216:219]
v_lshlrev_b32 v34, 16, v19
v_and_b32 v35, s25, v19
v_mfma_f32_16x16x32_bf16 v[220:223], a[188:191], a[236:239], v[220:223]
s_waitcnt vmcnt(24)
global_load_dwordx4 a[188:191], v2, s[20:21] offset:3072 sc1
v_add_u32 v2, 8192, v2
v_mfma_f32_16x16x32_bf16 v[236:239], a[192:195], a[236:239], v[236:239]
v_fma_f32 v150, v32, v150, v34
v_fma_f32 v166, v33, v166, v35
v_mfma_f32_16x16x32_bf16 v[232:235], a[192:195], a[232:235], v[232:235]
v_cvt_pk_bf16_f32 v83, v150, v166
v_mfma_f32_16x16x32_bf16 v[228:231], a[192:195], a[228:231], v[228:231]
v_mfma_f32_16x16x32_bf16 v[224:227], a[192:195], a[224:227], v[224:227]
s_waitcnt vmcnt(24)
global_load_dwordx4 a[192:195], v2, s[20:21] offset:-4096 sc1
v_mfma_f32_16x16x32_bf16 v[240:243], a[196:199], a[224:227], v[240:243]
v_mfma_f32_16x16x32_bf16 v[244:247], a[196:199], a[228:231], v[244:247]
v_mfma_f32_16x16x32_bf16 v[248:251], a[196:199], a[232:235], v[248:251]
v_mfma_f32_16x16x32_bf16 v[252:255], a[196:199], a[236:239], v[252:255]
s_waitcnt vmcnt(24) lgkmcnt(3)
global_load_dwordx4 a[196:199], v2, s[20:21] offset:-3072 sc1
v_mfma_f32_16x16x32_bf16 v[176:179], a[200:203], a[208:211], v[176:179]
s_waitcnt lgkmcnt(2)
ds_read_b128 a[224:227], v6 offset:8192
ds_read_b128 v[16:19], v40 offset:4096
v_mfma_f32_16x16x32_bf16 v[180:183], a[200:203], a[212:215], v[180:183]
s_waitcnt lgkmcnt(3)
ds_read_b128 a[228:231], v6 offset:10240
v_accvgpr_read_b32 v24, a52
v_mfma_f32_16x16x32_bf16 v[184:187], a[200:203], a[216:219], v[184:187]
s_waitcnt lgkmcnt(3)
ds_read_b128 a[232:235], v6 offset:12288
v_accvgpr_read_b32 v25, a53
v_mfma_f32_16x16x32_bf16 v[188:191], a[200:203], a[220:223], v[188:191]
s_waitcnt vmcnt(24)
global_load_dwordx4 a[200:203], v2, s[20:21] offset:-2048 sc1
v_accvgpr_read_b32 v26, a54
v_mfma_f32_16x16x32_bf16 v[204:207], a[204:207], a[220:223], v[204:207]
ds_read_b128 a[236:239], v6 offset:14336
v_accvgpr_read_b32 v27, a55
v_mfma_f32_16x16x32_bf16 v[200:203], a[204:207], a[216:219], v[200:203]
v_lshlrev_b32 v28, 16, v24
v_and_b32 v29, s25, v24
v_mfma_f32_16x16x32_bf16 v[196:199], a[204:207], a[212:215], v[196:199]
v_lshlrev_b32 v30, 16, v20
v_and_b32 v31, s25, v20
v_mfma_f32_16x16x32_bf16 v[192:195], a[204:207], a[208:211], v[192:195]
s_waitcnt vmcnt(24)
global_load_dwordx4 a[204:207], v2, s[20:21] offset:-1024 sc1
v_fma_f32 v55, v28, v55, v30
v_mfma_f32_16x16x32_bf16 v[208:211], a[104:107], a[208:211], v[208:211]
v_fma_f32 v71, v29, v71, v31
v_cvt_pk_bf16_f32 v96, v55, v71
v_mfma_f32_16x16x32_bf16 v[212:215], a[104:107], a[212:215], v[212:215]
v_lshlrev_b32 v32, 16, v25
v_and_b32 v33, s25, v25
v_mfma_f32_16x16x32_bf16 v[216:219], a[104:107], a[216:219], v[216:219]
v_lshlrev_b32 v34, 16, v21
v_and_b32 v35, s25, v21
v_mfma_f32_16x16x32_bf16 v[220:223], a[104:107], a[220:223], v[220:223]
s_waitcnt vmcnt(24)
global_load_dwordx4 a[104:107], v2, s[20:21] offset:0 sc1
v_fma_f32 v87, v32, v87, v34
v_mfma_f32_16x16x32_bf16 v[236:239], a[108:111], a[220:223], v[236:239]
v_fma_f32 v103, v33, v103, v35
v_cvt_pk_bf16_f32 v97, v87, v103
v_mfma_f32_16x16x32_bf16 v[232:235], a[108:111], a[216:219], v[232:235]
v_lshlrev_b32 v28, 16, v26
v_and_b32 v29, s25, v26
v_mfma_f32_16x16x32_bf16 v[228:231], a[108:111], a[212:215], v[228:231]
v_lshlrev_b32 v30, 16, v22
v_and_b32 v31, s25, v22
v_mfma_f32_16x16x32_bf16 v[224:227], a[108:111], a[208:211], v[224:227]
s_waitcnt vmcnt(24)
global_load_dwordx4 a[108:111], v2, s[20:21] offset:1024 sc1
v_fma_f32 v119, v28, v119, v30
v_mfma_f32_16x16x32_bf16 v[240:243], a[112:115], a[208:211], v[240:243]
v_fma_f32 v135, v29, v135, v31
v_cvt_pk_bf16_f32 v98, v119, v135
v_mfma_f32_16x16x32_bf16 v[244:247], a[112:115], a[212:215], v[244:247]
v_lshlrev_b32 v32, 16, v27
v_and_b32 v33, s25, v27
v_mfma_f32_16x16x32_bf16 v[248:251], a[112:115], a[216:219], v[248:251]
v_lshlrev_b32 v34, 16, v23
v_and_b32 v35, s25, v23
v_mfma_f32_16x16x32_bf16 v[252:255], a[112:115], a[220:223], v[252:255]
s_waitcnt vmcnt(24) lgkmcnt(4)
global_load_dwordx4 a[112:115], v2, s[20:21] offset:2048 sc1
v_fma_f32 v151, v32, v151, v34
v_mfma_f32_16x16x32_bf16 v[176:179], a[116:119], a[224:227], v[176:179]
s_waitcnt lgkmcnt(2)
ds_read_b128 a[208:211], v44 offset:8192
v_fma_f32 v167, v33, v167, v35
v_mfma_f32_16x16x32_bf16 v[180:183], a[116:119], a[228:231], v[180:183]
s_waitcnt lgkmcnt(2)
ds_read_b128 a[212:215], v44 offset:10240
v_cvt_pk_bf16_f32 v99, v151, v167
v_mfma_f32_16x16x32_bf16 v[184:187], a[116:119], a[232:235], v[184:187]
s_waitcnt lgkmcnt(2)
ds_read_b128 a[216:219], v44 offset:12288
v_mfma_f32_16x16x32_bf16 v[188:191], a[116:119], a[236:239], v[188:191]
s_waitcnt vmcnt(24)
global_load_dwordx4 a[116:119], v2, s[20:21] offset:3072 sc1
v_add_u32 v2, 8192, v2
v_mfma_f32_16x16x32_bf16 v[204:207], a[120:123], a[236:239], v[204:207]
ds_read_b128 a[220:223], v44 offset:14336
v_mfma_f32_16x16x32_bf16 v[200:203], a[120:123], a[232:235], v[200:203]
v_mfma_f32_16x16x32_bf16 v[196:199], a[120:123], a[228:231], v[196:199]
v_mfma_f32_16x16x32_bf16 v[192:195], a[120:123], a[224:227], v[192:195]
s_waitcnt vmcnt(24)
global_load_dwordx4 a[120:123], v2, s[20:21] offset:-4096 sc1
v_mfma_f32_16x16x32_bf16 v[208:211], a[124:127], a[224:227], v[208:211]
v_mfma_f32_16x16x32_bf16 v[212:215], a[124:127], a[228:231], v[212:215]
ds_read_b128 v[20:23], v41 offset:4096
v_accvgpr_read_b32 v24, a8
v_mfma_f32_16x16x32_bf16 v[216:219], a[124:127], a[232:235], v[216:219]
v_accvgpr_read_b32 v25, a9
v_accvgpr_read_b32 v26, a10
v_mfma_f32_16x16x32_bf16 v[220:223], a[124:127], a[236:239], v[220:223]
s_waitcnt vmcnt(24)
global_load_dwordx4 a[124:127], v2, s[20:21] offset:-3072 sc1
v_accvgpr_read_b32 v27, a11
v_mfma_f32_16x16x32_bf16 v[236:239], a[128:131], a[236:239], v[236:239]
v_lshlrev_b32 v28, 16, v24
v_and_b32 v29, s25, v24
v_mfma_f32_16x16x32_bf16 v[232:235], a[128:131], a[232:235], v[232:235]
v_lshlrev_b32 v30, 16, v16
v_and_b32 v31, s25, v16
v_mfma_f32_16x16x32_bf16 v[228:231], a[128:131], a[228:231], v[228:231]
v_fma_f32 v56, v28, v56, v30
v_fma_f32 v72, v29, v72, v31
v_mfma_f32_16x16x32_bf16 v[224:227], a[128:131], a[224:227], v[224:227]
s_waitcnt vmcnt(24)
global_load_dwordx4 a[128:131], v2, s[20:21] offset:-2048 sc1
v_cvt_pk_bf16_f32 v52, v56, v72
v_mfma_f32_16x16x32_bf16 v[240:243], a[132:135], a[224:227], v[240:243]
v_lshlrev_b32 v32, 16, v25
v_and_b32 v33, s25, v25
v_mfma_f32_16x16x32_bf16 v[244:247], a[132:135], a[228:231], v[244:247]
v_lshlrev_b32 v34, 16, v17
v_and_b32 v35, s25, v17
v_mfma_f32_16x16x32_bf16 v[248:251], a[132:135], a[232:235], v[248:251]
v_fma_f32 v88, v32, v88, v34
v_fma_f32 v104, v33, v104, v35
v_mfma_f32_16x16x32_bf16 v[252:255], a[132:135], a[236:239], v[252:255]
s_waitcnt vmcnt(24) lgkmcnt(4)
global_load_dwordx4 a[132:135], v2, s[20:21] offset:-1024 sc1
v_cvt_pk_bf16_f32 v53, v88, v104
v_mfma_f32_16x16x32_bf16 v[176:179], a[136:139], a[208:211], v[176:179]
s_waitcnt lgkmcnt(3)
ds_read_b128 a[224:227], v45 offset:8192
v_lshlrev_b32 v28, 16, v26
v_mfma_f32_16x16x32_bf16 v[180:183], a[136:139], a[212:215], v[180:183]
s_waitcnt lgkmcnt(3)
ds_read_b128 a[228:231], v45 offset:10240
v_and_b32 v29, s25, v26
v_mfma_f32_16x16x32_bf16 v[184:187], a[136:139], a[216:219], v[184:187]
s_waitcnt lgkmcnt(3)
ds_read_b128 a[232:235], v45 offset:12288
v_lshlrev_b32 v30, 16, v18
v_mfma_f32_16x16x32_bf16 v[188:191], a[136:139], a[220:223], v[188:191]
s_waitcnt vmcnt(24)
global_load_dwordx4 a[136:139], v2, s[20:21] offset:0 sc1
v_and_b32 v31, s25, v18
v_mfma_f32_16x16x32_bf16 v[204:207], a[140:143], a[220:223], v[204:207]
ds_read_b128 a[236:239], v45 offset:14336
v_fma_f32 v120, v28, v120, v30
v_mfma_f32_16x16x32_bf16 v[200:203], a[140:143], a[216:219], v[200:203]
v_fma_f32 v136, v29, v136, v31
v_cvt_pk_bf16_f32 v54, v120, v136
v_mfma_f32_16x16x32_bf16 v[196:199], a[140:143], a[212:215], v[196:199]
v_lshlrev_b32 v32, 16, v27
v_and_b32 v33, s25, v27
v_mfma_f32_16x16x32_bf16 v[192:195], a[140:143], a[208:211], v[192:195]
s_waitcnt vmcnt(24)
global_load_dwordx4 a[140:143], v2, s[20:21] offset:1024 sc1
v_lshlrev_b32 v34, 16, v19
v_mfma_f32_16x16x32_bf16 v[208:211], a[144:147], a[208:211], v[208:211]
v_and_b32 v35, s25, v19
v_fma_f32 v152, v32, v152, v34
v_mfma_f32_16x16x32_bf16 v[212:215], a[144:147], a[212:215], v[212:215]
v_fma_f32 v168, v33, v168, v35
v_cvt_pk_bf16_f32 v55, v152, v168
v_mfma_f32_16x16x32_bf16 v[216:219], a[144:147], a[216:219], v[216:219]
v_mfma_f32_16x16x32_bf16 v[220:223], a[144:147], a[220:223], v[220:223]
s_waitcnt vmcnt(24)
global_load_dwordx4 a[144:147], v2, s[20:21] offset:2048 sc1
v_mfma_f32_16x16x32_bf16 v[236:239], a[148:151], a[220:223], v[236:239]
v_mfma_f32_16x16x32_bf16 v[232:235], a[148:151], a[216:219], v[232:235]
v_mfma_f32_16x16x32_bf16 v[228:231], a[148:151], a[212:215], v[228:231]
v_mfma_f32_16x16x32_bf16 v[224:227], a[148:151], a[208:211], v[224:227]
s_waitcnt vmcnt(24)
global_load_dwordx4 a[148:151], v2, s[20:21] offset:3072 sc1
v_add_u32 v2, 8192, v2
v_mfma_f32_16x16x32_bf16 v[240:243], a[152:155], a[208:211], v[240:243]
v_mfma_f32_16x16x32_bf16 v[244:247], a[152:155], a[212:215], v[244:247]
v_mfma_f32_16x16x32_bf16 v[248:251], a[152:155], a[216:219], v[248:251]
ds_read_b128 v[16:19], v42 offset:4096
v_accvgpr_read_b32 v24, a24
v_mfma_f32_16x16x32_bf16 v[252:255], a[152:155], a[220:223], v[252:255]
s_waitcnt vmcnt(24) lgkmcnt(4)
global_load_dwordx4 a[152:155], v2, s[20:21] offset:-4096 sc1
v_accvgpr_read_b32 v25, a25
v_mfma_f32_16x16x32_bf16 v[176:179], a[156:159], a[224:227], v[176:179]
s_waitcnt lgkmcnt(3)
ds_read_b128 a[208:211], v46 offset:8192
v_accvgpr_read_b32 v26, a26
v_mfma_f32_16x16x32_bf16 v[180:183], a[156:159], a[228:231], v[180:183]
s_waitcnt lgkmcnt(3)
ds_read_b128 a[212:215], v46 offset:10240
v_accvgpr_read_b32 v27, a27
v_mfma_f32_16x16x32_bf16 v[184:187], a[156:159], a[232:235], v[184:187]
s_waitcnt lgkmcnt(3)
ds_read_b128 a[216:219], v46 offset:12288
v_lshlrev_b32 v28, 16, v24
v_mfma_f32_16x16x32_bf16 v[188:191], a[156:159], a[236:239], v[188:191]
s_waitcnt vmcnt(24)
global_load_dwordx4 a[156:159], v2, s[20:21] offset:-3072 sc1
v_and_b32 v29, s25, v24
v_mfma_f32_16x16x32_bf16 v[204:207], a[160:163], a[236:239], v[204:207]
ds_read_b128 a[220:223], v46 offset:14336
v_lshlrev_b32 v30, 16, v20
v_mfma_f32_16x16x32_bf16 v[200:203], a[160:163], a[232:235], v[200:203]
v_and_b32 v31, s25, v20
v_fma_f32 v57, v28, v57, v30
v_mfma_f32_16x16x32_bf16 v[196:199], a[160:163], a[228:231], v[196:199]
v_fma_f32 v73, v29, v73, v31
v_cvt_pk_bf16_f32 v68, v57, v73
v_mfma_f32_16x16x32_bf16 v[192:195], a[160:163], a[224:227], v[192:195]
s_waitcnt vmcnt(24)
global_load_dwordx4 a[160:163], v2, s[20:21] offset:-2048 sc1
v_lshlrev_b32 v32, 16, v25
v_mfma_f32_16x16x32_bf16 v[208:211], a[164:167], a[224:227], v[208:211]
v_and_b32 v33, s25, v25
v_lshlrev_b32 v34, 16, v21
v_mfma_f32_16x16x32_bf16 v[212:215], a[164:167], a[228:231], v[212:215]
v_and_b32 v35, s25, v21
v_fma_f32 v89, v32, v89, v34
v_mfma_f32_16x16x32_bf16 v[216:219], a[164:167], a[232:235], v[216:219]
v_fma_f32 v105, v33, v105, v35
v_cvt_pk_bf16_f32 v69, v89, v105
v_mfma_f32_16x16x32_bf16 v[220:223], a[164:167], a[236:239], v[220:223]
s_waitcnt vmcnt(24)
global_load_dwordx4 a[164:167], v2, s[20:21] offset:-1024 sc1
v_lshlrev_b32 v28, 16, v26
v_mfma_f32_16x16x32_bf16 v[236:239], a[168:171], a[236:239], v[236:239]
v_and_b32 v29, s25, v26
v_lshlrev_b32 v30, 16, v22
v_mfma_f32_16x16x32_bf16 v[232:235], a[168:171], a[232:235], v[232:235]
v_and_b32 v31, s25, v22
v_fma_f32 v121, v28, v121, v30
v_mfma_f32_16x16x32_bf16 v[228:231], a[168:171], a[228:231], v[228:231]
v_fma_f32 v137, v29, v137, v31
v_cvt_pk_bf16_f32 v70, v121, v137
v_mfma_f32_16x16x32_bf16 v[224:227], a[168:171], a[224:227], v[224:227]
s_waitcnt vmcnt(24)
global_load_dwordx4 a[168:171], v2, s[20:21] offset:0 sc1
v_lshlrev_b32 v32, 16, v27
v_mfma_f32_16x16x32_bf16 v[240:243], a[172:175], a[224:227], v[240:243]
v_and_b32 v33, s25, v27
v_lshlrev_b32 v34, 16, v23
v_mfma_f32_16x16x32_bf16 v[244:247], a[172:175], a[228:231], v[244:247]
v_and_b32 v35, s25, v23
v_fma_f32 v153, v32, v153, v34
v_mfma_f32_16x16x32_bf16 v[248:251], a[172:175], a[232:235], v[248:251]
v_fma_f32 v169, v33, v169, v35
v_cvt_pk_bf16_f32 v71, v153, v169
v_mfma_f32_16x16x32_bf16 v[252:255], a[172:175], a[236:239], v[252:255]
s_waitcnt vmcnt(24) lgkmcnt(3)
global_load_dwordx4 a[172:175], v2, s[20:21] offset:1024 sc1
v_mfma_f32_16x16x32_bf16 v[176:179], a[176:179], a[208:211], v[176:179]
s_waitcnt lgkmcnt(2)
ds_read_b128 a[224:227], v47 offset:8192
v_mfma_f32_16x16x32_bf16 v[180:183], a[176:179], a[212:215], v[180:183]
s_waitcnt lgkmcnt(2)
ds_read_b128 a[228:231], v47 offset:10240
v_mfma_f32_16x16x32_bf16 v[184:187], a[176:179], a[216:219], v[184:187]
s_waitcnt lgkmcnt(2)
ds_read_b128 a[232:235], v47 offset:12288
v_mfma_f32_16x16x32_bf16 v[188:191], a[176:179], a[220:223], v[188:191]
s_waitcnt vmcnt(24)
global_load_dwordx4 a[176:179], v2, s[20:21] offset:2048 sc1
v_mfma_f32_16x16x32_bf16 v[204:207], a[180:183], a[220:223], v[204:207]
ds_read_b128 a[236:239], v47 offset:14336
v_mfma_f32_16x16x32_bf16 v[200:203], a[180:183], a[216:219], v[200:203]
v_mfma_f32_16x16x32_bf16 v[196:199], a[180:183], a[212:215], v[196:199]
ds_read_b128 v[20:23], v43 offset:4096
v_accvgpr_read_b32 v24, a40
v_mfma_f32_16x16x32_bf16 v[192:195], a[180:183], a[208:211], v[192:195]
s_waitcnt vmcnt(24)
global_load_dwordx4 a[180:183], v2, s[20:21] offset:3072 sc1
v_add_u32 v2, 8192, v2
v_mfma_f32_16x16x32_bf16 v[208:211], a[184:187], a[208:211], v[208:211]
v_accvgpr_read_b32 v25, a41
v_accvgpr_read_b32 v26, a42
v_mfma_f32_16x16x32_bf16 v[212:215], a[184:187], a[212:215], v[212:215]
v_accvgpr_read_b32 v27, a43
v_lshlrev_b32 v28, 16, v24
v_mfma_f32_16x16x32_bf16 v[216:219], a[184:187], a[216:219], v[216:219]
v_and_b32 v29, s25, v24
v_lshlrev_b32 v30, 16, v16
v_mfma_f32_16x16x32_bf16 v[220:223], a[184:187], a[220:223], v[220:223]
s_waitcnt vmcnt(24)
global_load_dwordx4 a[184:187], v2, s[20:21] offset:-4096 sc1
v_and_b32 v31, s25, v16
v_mfma_f32_16x16x32_bf16 v[236:239], a[188:191], a[220:223], v[236:239]
v_fma_f32 v58, v28, v58, v30
v_fma_f32 v74, v29, v74, v31
v_mfma_f32_16x16x32_bf16 v[232:235], a[188:191], a[216:219], v[232:235]
v_cvt_pk_bf16_f32 v84, v58, v74
v_lshlrev_b32 v32, 16, v25
v_mfma_f32_16x16x32_bf16 v[228:231], a[188:191], a[212:215], v[228:231]
v_and_b32 v33, s25, v25
v_lshlrev_b32 v34, 16, v17
v_mfma_f32_16x16x32_bf16 v[224:227], a[188:191], a[208:211], v[224:227]
s_waitcnt vmcnt(24)
global_load_dwordx4 a[188:191], v2, s[20:21] offset:-3072 sc1
v_and_b32 v35, s25, v17
v_mfma_f32_16x16x32_bf16 v[240:243], a[192:195], a[208:211], v[240:243]
v_fma_f32 v90, v32, v90, v34
v_fma_f32 v106, v33, v106, v35
v_mfma_f32_16x16x32_bf16 v[244:247], a[192:195], a[212:215], v[244:247]
v_cvt_pk_bf16_f32 v85, v90, v106
v_lshlrev_b32 v28, 16, v26
v_mfma_f32_16x16x32_bf16 v[248:251], a[192:195], a[216:219], v[248:251]
v_and_b32 v29, s25, v26
v_lshlrev_b32 v30, 16, v18
v_mfma_f32_16x16x32_bf16 v[252:255], a[192:195], a[220:223], v[252:255]
s_waitcnt vmcnt(24) lgkmcnt(1)
s_barrier
global_load_dwordx4 a[192:195], v2, s[20:21] offset:-2048 sc1
v_and_b32 v31, s25, v18
v_mfma_f32_16x16x32_bf16 v[176:179], a[196:199], a[224:227], v[176:179]
ds_read_b128 a[208:211], v3 offset:16384
v_fma_f32 v122, v28, v122, v30
v_mfma_f32_16x16x32_bf16 v[180:183], a[196:199], a[228:231], v[180:183]
ds_read_b128 a[212:215], v3 offset:18432
v_fma_f32 v138, v29, v138, v31
v_mfma_f32_16x16x32_bf16 v[184:187], a[196:199], a[232:235], v[184:187]
ds_read_b128 a[216:219], v3 offset:20480
v_cvt_pk_bf16_f32 v86, v122, v138
v_mfma_f32_16x16x32_bf16 v[188:191], a[196:199], a[236:239], v[188:191]
s_waitcnt vmcnt(24)
global_load_dwordx4 a[196:199], v2, s[20:21] offset:-1024 sc1
v_lshlrev_b32 v32, 16, v27
v_mfma_f32_16x16x32_bf16 v[204:207], a[200:203], a[236:239], v[204:207]
ds_read_b128 a[220:223], v3 offset:22528
v_and_b32 v33, s25, v27
v_mfma_f32_16x16x32_bf16 v[200:203], a[200:203], a[232:235], v[200:203]
ds_write_b128 v40, a[240:243] offset:0
v_mfma_f32_16x16x32_bf16 v[196:199], a[200:203], a[228:231], v[196:199]
ds_write_b128 v41, a[244:247] offset:0
v_mfma_f32_16x16x32_bf16 v[192:195], a[200:203], a[224:227], v[192:195]
s_waitcnt vmcnt(24)
global_load_dwordx4 a[200:203], v2, s[20:21] offset:0 sc1
v_lshlrev_b32 v34, 16, v19
v_mfma_f32_16x16x32_bf16 v[208:211], a[204:207], a[224:227], v[208:211]
ds_write_b128 v42, a[248:251] offset:0
v_mfma_f32_16x16x32_bf16 v[212:215], a[204:207], a[228:231], v[212:215]
ds_write_b128 v43, a[252:255] offset:0
v_mfma_f32_16x16x32_bf16 v[216:219], a[204:207], a[232:235], v[216:219]
ds_write_b128 v40, v[48:51] offset:2048
v_mfma_f32_16x16x32_bf16 v[220:223], a[204:207], a[236:239], v[220:223]
s_waitcnt vmcnt(24)
global_load_dwordx4 a[204:207], v2, s[20:21] offset:1024 sc1
v_and_b32 v35, s25, v19
v_mfma_f32_16x16x32_bf16 v[236:239], a[104:107], a[236:239], v[236:239]
ds_write_b128 v41, v[64:67] offset:2048
v_mfma_f32_16x16x32_bf16 v[232:235], a[104:107], a[232:235], v[232:235]
ds_write_b128 v42, v[80:83] offset:2048
v_mfma_f32_16x16x32_bf16 v[228:231], a[104:107], a[228:231], v[228:231]
ds_write_b128 v43, v[96:99] offset:2048
v_mfma_f32_16x16x32_bf16 v[224:227], a[104:107], a[224:227], v[224:227]
s_waitcnt vmcnt(24)
global_load_dwordx4 a[104:107], v2, s[20:21] offset:2048 sc1
v_fma_f32 v154, v32, v154, v34
v_mfma_f32_16x16x32_bf16 v[240:243], a[108:111], a[224:227], v[240:243]
ds_write_b128 v40, v[52:55] offset:4096
v_mfma_f32_16x16x32_bf16 v[244:247], a[108:111], a[228:231], v[244:247]
ds_write_b128 v41, v[68:71] offset:4096
v_mfma_f32_16x16x32_bf16 v[248:251], a[108:111], a[232:235], v[248:251]
v_fma_f32 v170, v33, v170, v35
v_cvt_pk_bf16_f32 v87, v154, v170
v_mfma_f32_16x16x32_bf16 v[252:255], a[108:111], a[236:239], v[252:255]
s_waitcnt vmcnt(24) lgkmcnt(13)
global_load_dwordx4 a[108:111], v2, s[20:21] offset:3072 sc1
v_add_u32 v2, 8192, v2
v_mfma_f32_16x16x32_bf16 v[176:179], a[112:115], a[208:211], v[176:179]
s_waitcnt lgkmcnt(12)
ds_read_b128 a[224:227], v44 offset:16384
v_mfma_f32_16x16x32_bf16 v[180:183], a[112:115], a[212:215], v[180:183]
s_waitcnt lgkmcnt(12)
ds_read_b128 a[228:231], v44 offset:18432
v_mfma_f32_16x16x32_bf16 v[184:187], a[112:115], a[216:219], v[184:187]
s_waitcnt lgkmcnt(12)
ds_read_b128 a[232:235], v44 offset:20480
v_mfma_f32_16x16x32_bf16 v[188:191], a[112:115], a[220:223], v[188:191]
s_waitcnt vmcnt(24)
global_load_dwordx4 a[112:115], v2, s[20:21] offset:-4096 sc1
v_mfma_f32_16x16x32_bf16 v[204:207], a[116:119], a[220:223], v[204:207]
ds_read_b128 a[236:239], v44 offset:22528
v_mfma_f32_16x16x32_bf16 v[200:203], a[116:119], a[216:219], v[200:203]
ds_write_b128 v42, v[84:87] offset:4096
v_mfma_f32_16x16x32_bf16 v[196:199], a[116:119], a[212:215], v[196:199]
ds_read_b128 v[16:19], v40 offset:6144
v_accvgpr_read_b32 v24, a56
v_mfma_f32_16x16x32_bf16 v[192:195], a[116:119], a[208:211], v[192:195]
s_waitcnt vmcnt(24)
global_load_dwordx4 a[116:119], v2, s[20:21] offset:-3072 sc1
v_accvgpr_read_b32 v25, a57
v_mfma_f32_16x16x32_bf16 v[208:211], a[120:123], a[208:211], v[208:211]
v_accvgpr_read_b32 v26, a58
v_accvgpr_read_b32 v27, a59
v_mfma_f32_16x16x32_bf16 v[212:215], a[120:123], a[212:215], v[212:215]
v_lshlrev_b32 v28, 16, v24
v_and_b32 v29, s25, v24
v_mfma_f32_16x16x32_bf16 v[216:219], a[120:123], a[216:219], v[216:219]
v_lshlrev_b32 v30, 16, v20
v_and_b32 v31, s25, v20
v_mfma_f32_16x16x32_bf16 v[220:223], a[120:123], a[220:223], v[220:223]
s_waitcnt vmcnt(24)
global_load_dwordx4 a[120:123], v2, s[20:21] offset:-2048 sc1
v_fma_f32 v59, v28, v59, v30
v_mfma_f32_16x16x32_bf16 v[236:239], a[124:127], a[220:223], v[236:239]
v_fma_f32 v75, v29, v75, v31
v_cvt_pk_bf16_f32 v100, v59, v75
v_mfma_f32_16x16x32_bf16 v[232:235], a[124:127], a[216:219], v[232:235]
v_lshlrev_b32 v32, 16, v25
v_and_b32 v33, s25, v25
v_mfma_f32_16x16x32_bf16 v[228:231], a[124:127], a[212:215], v[228:231]
v_lshlrev_b32 v34, 16, v21
v_and_b32 v35, s25, v21
v_mfma_f32_16x16x32_bf16 v[224:227], a[124:127], a[208:211], v[224:227]
s_waitcnt vmcnt(24)
global_load_dwordx4 a[124:127], v2, s[20:21] offset:-1024 sc1
v_fma_f32 v91, v32, v91, v34
v_mfma_f32_16x16x32_bf16 v[240:243], a[128:131], a[208:211], v[240:243]
v_fma_f32 v107, v33, v107, v35
v_cvt_pk_bf16_f32 v101, v91, v107
v_mfma_f32_16x16x32_bf16 v[244:247], a[128:131], a[212:215], v[244:247]
v_lshlrev_b32 v28, 16, v26
v_and_b32 v29, s25, v26
v_mfma_f32_16x16x32_bf16 v[248:251], a[128:131], a[216:219], v[248:251]
v_lshlrev_b32 v30, 16, v22
v_and_b32 v31, s25, v22
v_mfma_f32_16x16x32_bf16 v[252:255], a[128:131], a[220:223], v[252:255]
s_waitcnt vmcnt(24) lgkmcnt(5)
global_load_dwordx4 a[128:131], v2, s[20:21] offset:0 sc1
v_fma_f32 v123, v28, v123, v30
v_mfma_f32_16x16x32_bf16 v[176:179], a[132:135], a[224:227], v[176:179]
s_waitcnt lgkmcnt(4)
ds_read_b128 a[208:211], v7 offset:0
v_fma_f32 v139, v29, v139, v31
v_mfma_f32_16x16x32_bf16 v[180:183], a[132:135], a[228:231], v[180:183]
s_waitcnt lgkmcnt(4)
ds_read_b128 a[212:215], v7 offset:2048
v_cvt_pk_bf16_f32 v102, v123, v139
v_mfma_f32_16x16x32_bf16 v[184:187], a[132:135], a[232:235], v[184:187]
s_waitcnt lgkmcnt(4)
ds_read_b128 a[216:219], v7 offset:4096
v_lshlrev_b32 v32, 16, v27
v_mfma_f32_16x16x32_bf16 v[188:191], a[132:135], a[236:239], v[188:191]
s_waitcnt vmcnt(24)
global_load_dwordx4 a[132:135], v2, s[20:21] offset:1024 sc1
v_and_b32 v33, s25, v27
v_mfma_f32_16x16x32_bf16 v[204:207], a[136:139], a[236:239], v[204:207]
ds_read_b128 a[220:223], v7 offset:6144
v_lshlrev_b32 v34, 16, v23
v_mfma_f32_16x16x32_bf16 v[200:203], a[136:139], a[232:235], v[200:203]
v_and_b32 v35, s25, v23
v_fma_f32 v155, v32, v155, v34
v_mfma_f32_16x16x32_bf16 v[196:199], a[136:139], a[228:231], v[196:199]
v_fma_f32 v171, v33, v171, v35
v_cvt_pk_bf16_f32 v103, v155, v171
v_mfma_f32_16x16x32_bf16 v[192:195], a[136:139], a[224:227], v[192:195]
s_waitcnt vmcnt(24)
global_load_dwordx4 a[136:139], v2, s[20:21] offset:2048 sc1
v_mfma_f32_16x16x32_bf16 v[208:211], a[140:143], a[224:227], v[208:211]
ds_write_b128 v43, v[100:103] offset:4096
v_mfma_f32_16x16x32_bf16 v[212:215], a[140:143], a[228:231], v[212:215]
ds_read_b128 v[20:23], v41 offset:6144
v_accvgpr_read_b32 v24, a12
v_mfma_f32_16x16x32_bf16 v[216:219], a[140:143], a[232:235], v[216:219]
v_accvgpr_read_b32 v25, a13
v_accvgpr_read_b32 v26, a14
v_mfma_f32_16x16x32_bf16 v[220:223], a[140:143], a[236:239], v[220:223]
s_waitcnt vmcnt(24)
global_load_dwordx4 a[140:143], v2, s[20:21] offset:3072 sc1
v_add_u32 v2, 8192, v2
v_mfma_f32_16x16x32_bf16 v[236:239], a[144:147], a[236:239], v[236:239]
v_accvgpr_read_b32 v27, a15
v_lshlrev_b32 v28, 16, v24
v_mfma_f32_16x16x32_bf16 v[232:235], a[144:147], a[232:235], v[232:235]
s_waitcnt lgkmcnt(6)
v_and_b32 v29, s25, v24
v_lshlrev_b32 v30, 16, v16
v_mfma_f32_16x16x32_bf16 v[228:231], a[144:147], a[228:231], v[228:231]
v_and_b32 v31, s25, v16
v_fma_f32 v60, v28, v60, v30
v_mfma_f32_16x16x32_bf16 v[224:227], a[144:147], a[224:227], v[224:227]
s_waitcnt vmcnt(24)
global_load_dwordx4 a[144:147], v2, s[20:21] offset:-4096 sc1
v_fma_f32 v76, v29, v76, v31
v_mfma_f32_16x16x32_bf16 v[240:243], a[148:151], a[224:227], v[240:243]
v_cvt_pk_bf16_f32 v56, v60, v76
v_lshlrev_b32 v32, 16, v25
v_mfma_f32_16x16x32_bf16 v[244:247], a[148:151], a[228:231], v[244:247]
v_and_b32 v33, s25, v25
v_lshlrev_b32 v34, 16, v17
v_mfma_f32_16x16x32_bf16 v[248:251], a[148:151], a[232:235], v[248:251]
v_and_b32 v35, s25, v17
v_fma_f32 v92, v32, v92, v34
v_mfma_f32_16x16x32_bf16 v[252:255], a[148:151], a[236:239], v[252:255]
s_waitcnt vmcnt(24) lgkmcnt(5)
global_load_dwordx4 a[148:151], v2, s[20:21] offset:-3072 sc1
v_fma_f32 v108, v33, v108, v35
v_mfma_f32_16x16x32_bf16 v[176:179], a[152:155], a[208:211], v[176:179]
s_waitcnt lgkmcnt(4)
ds_read_b128 a[224:227], v15 offset:0
v_cvt_pk_bf16_f32 v57, v92, v108
v_mfma_f32_16x16x32_bf16 v[180:183], a[152:155], a[212:215], v[180:183]
s_waitcnt lgkmcnt(4)
ds_read_b128 a[228:231], v15 offset:2048
v_lshlrev_b32 v28, 16, v26
v_mfma_f32_16x16x32_bf16 v[184:187], a[152:155], a[216:219], v[184:187]
s_waitcnt lgkmcnt(4)
ds_read_b128 a[232:235], v15 offset:4096
v_and_b32 v29, s25, v26
v_mfma_f32_16x16x32_bf16 v[188:191], a[152:155], a[220:223], v[188:191]
s_waitcnt vmcnt(24)
global_load_dwordx4 a[152:155], v2, s[20:21] offset:-2048 sc1
v_lshlrev_b32 v30, 16, v18
v_mfma_f32_16x16x32_bf16 v[204:207], a[156:159], a[220:223], v[204:207]
ds_read_b128 a[236:239], v15 offset:6144
v_and_b32 v31, s25, v18
v_mfma_f32_16x16x32_bf16 v[200:203], a[156:159], a[216:219], v[200:203]
v_fma_f32 v124, v28, v124, v30
v_fma_f32 v140, v29, v140, v31
v_mfma_f32_16x16x32_bf16 v[196:199], a[156:159], a[212:215], v[196:199]
v_cvt_pk_bf16_f32 v58, v124, v140
v_lshlrev_b32 v32, 16, v27
v_mfma_f32_16x16x32_bf16 v[192:195], a[156:159], a[208:211], v[192:195]
s_waitcnt vmcnt(24)
global_load_dwordx4 a[156:159], v2, s[20:21] offset:-1024 sc1
v_and_b32 v33, s25, v27
v_mfma_f32_16x16x32_bf16 v[208:211], a[160:163], a[208:211], v[208:211]
v_lshlrev_b32 v34, 16, v19
v_and_b32 v35, s25, v19
v_mfma_f32_16x16x32_bf16 v[212:215], a[160:163], a[212:215], v[212:215]
v_fma_f32 v156, v32, v156, v34
v_fma_f32 v172, v33, v172, v35
v_mfma_f32_16x16x32_bf16 v[216:219], a[160:163], a[216:219], v[216:219]
v_cvt_pk_bf16_f32 v59, v156, v172
v_mfma_f32_16x16x32_bf16 v[220:223], a[160:163], a[220:223], v[220:223]
s_waitcnt vmcnt(24)
global_load_dwordx4 a[160:163], v2, s[20:21] offset:0 sc1
v_mfma_f32_16x16x32_bf16 v[236:239], a[164:167], a[220:223], v[236:239]
ds_write_b128 v40, v[56:59] offset:6144
v_mfma_f32_16x16x32_bf16 v[232:235], a[164:167], a[216:219], v[232:235]
ds_read_b128 v[16:19], v42 offset:6144
v_accvgpr_read_b32 v24, a28
v_mfma_f32_16x16x32_bf16 v[228:231], a[164:167], a[212:215], v[228:231]
v_accvgpr_read_b32 v25, a29
v_accvgpr_read_b32 v26, a30
v_mfma_f32_16x16x32_bf16 v[224:227], a[164:167], a[208:211], v[224:227]
s_waitcnt vmcnt(24)
global_load_dwordx4 a[164:167], v2, s[20:21] offset:1024 sc1
v_accvgpr_read_b32 v27, a31
v_mfma_f32_16x16x32_bf16 v[240:243], a[168:171], a[208:211], v[240:243]
v_lshlrev_b32 v28, 16, v24
v_and_b32 v29, s25, v24
v_mfma_f32_16x16x32_bf16 v[244:247], a[168:171], a[212:215], v[244:247]
s_waitcnt lgkmcnt(6)
v_lshlrev_b32 v30, 16, v20
v_and_b32 v31, s25, v20
v_mfma_f32_16x16x32_bf16 v[248:251], a[168:171], a[216:219], v[248:251]
v_fma_f32 v61, v28, v61, v30
v_fma_f32 v77, v29, v77, v31
v_mfma_f32_16x16x32_bf16 v[252:255], a[168:171], a[220:223], v[252:255]
s_waitcnt vmcnt(24) lgkmcnt(5)
global_load_dwordx4 a[168:171], v2, s[20:21] offset:2048 sc1
v_cvt_pk_bf16_f32 v72, v61, v77
v_mfma_f32_16x16x32_bf16 v[176:179], a[172:175], a[224:227], v[176:179]
s_waitcnt lgkmcnt(4)
ds_read_b128 a[208:211], v4 offset:16384
v_lshlrev_b32 v32, 16, v25
v_mfma_f32_16x16x32_bf16 v[180:183], a[172:175], a[228:231], v[180:183]
s_waitcnt lgkmcnt(4)
ds_read_b128 a[212:215], v4 offset:18432
v_and_b32 v33, s25, v25
v_mfma_f32_16x16x32_bf16 v[184:187], a[172:175], a[232:235], v[184:187]
s_waitcnt lgkmcnt(4)
ds_read_b128 a[216:219], v4 offset:20480
v_lshlrev_b32 v34, 16, v21
v_mfma_f32_16x16x32_bf16 v[188:191], a[172:175], a[236:239], v[188:191]
s_waitcnt vmcnt(24)
global_load_dwordx4 a[172:175], v2, s[20:21] offset:3072 sc1
v_add_u32 v2, 8192, v2
v_mfma_f32_16x16x32_bf16 v[204:207], a[176:179], a[236:239], v[204:207]
ds_read_b128 a[220:223], v4 offset:22528
v_and_b32 v35, s25, v21
v_mfma_f32_16x16x32_bf16 v[200:203], a[176:179], a[232:235], v[200:203]
v_fma_f32 v93, v32, v93, v34
v_fma_f32 v109, v33, v109, v35
v_mfma_f32_16x16x32_bf16 v[196:199], a[176:179], a[228:231], v[196:199]
v_cvt_pk_bf16_f32 v73, v93, v109
v_lshlrev_b32 v28, 16, v26
v_mfma_f32_16x16x32_bf16 v[192:195], a[176:179], a[224:227], v[192:195]
s_waitcnt vmcnt(24)
global_load_dwordx4 a[176:179], v2, s[20:21] offset:-4096 sc1
v_and_b32 v29, s25, v26
v_mfma_f32_16x16x32_bf16 v[208:211], a[180:183], a[224:227], v[208:211]
v_lshlrev_b32 v30, 16, v22
v_and_b32 v31, s25, v22
v_mfma_f32_16x16x32_bf16 v[212:215], a[180:183], a[228:231], v[212:215]
v_fma_f32 v125, v28, v125, v30
v_fma_f32 v141, v29, v141, v31
v_mfma_f32_16x16x32_bf16 v[216:219], a[180:183], a[232:235], v[216:219]
v_cvt_pk_bf16_f32 v74, v125, v141
v_lshlrev_b32 v32, 16, v27
v_mfma_f32_16x16x32_bf16 v[220:223], a[180:183], a[236:239], v[220:223]
s_waitcnt vmcnt(24)
global_load_dwordx4 a[180:183], v2, s[20:21] offset:-3072 sc1
v_and_b32 v33, s25, v27
v_mfma_f32_16x16x32_bf16 v[236:239], a[184:187], a[236:239], v[236:239]
v_lshlrev_b32 v34, 16, v23
v_and_b32 v35, s25, v23
v_mfma_f32_16x16x32_bf16 v[232:235], a[184:187], a[232:235], v[232:235]
v_fma_f32 v157, v32, v157, v34
v_fma_f32 v173, v33, v173, v35
v_mfma_f32_16x16x32_bf16 v[228:231], a[184:187], a[228:231], v[228:231]
v_cvt_pk_bf16_f32 v75, v157, v173
v_mfma_f32_16x16x32_bf16 v[224:227], a[184:187], a[224:227], v[224:227]
s_waitcnt vmcnt(24)
global_load_dwordx4 a[184:187], v2, s[20:21] offset:-2048 sc1
v_mfma_f32_16x16x32_bf16 v[240:243], a[188:191], a[224:227], v[240:243]
ds_write_b128 v41, v[72:75] offset:6144
v_mfma_f32_16x16x32_bf16 v[244:247], a[188:191], a[228:231], v[244:247]
v_mfma_f32_16x16x32_bf16 v[248:251], a[188:191], a[232:235], v[248:251]
v_mfma_f32_16x16x32_bf16 v[252:255], a[188:191], a[236:239], v[252:255]
s_waitcnt vmcnt(24) lgkmcnt(4)
global_load_dwordx4 a[188:191], v2, s[20:21] offset:-1024 sc1
v_mfma_f32_16x16x32_bf16 v[176:179], a[192:195], a[208:211], v[176:179]
s_waitcnt lgkmcnt(3)
ds_read_b128 a[224:227], v45 offset:16384
v_mfma_f32_16x16x32_bf16 v[180:183], a[192:195], a[212:215], v[180:183]
s_waitcnt lgkmcnt(3)
ds_read_b128 a[228:231], v45 offset:18432
ds_read_b128 v[20:23], v43 offset:6144
v_mfma_f32_16x16x32_bf16 v[184:187], a[192:195], a[216:219], v[184:187]
s_waitcnt lgkmcnt(4)
ds_read_b128 a[232:235], v45 offset:20480
v_accvgpr_read_b32 v24, a44
v_mfma_f32_16x16x32_bf16 v[188:191], a[192:195], a[220:223], v[188:191]
s_waitcnt vmcnt(24)
global_load_dwordx4 a[192:195], v2, s[20:21] offset:0 sc1
v_accvgpr_read_b32 v25, a45
v_mfma_f32_16x16x32_bf16 v[204:207], a[196:199], a[220:223], v[204:207]
ds_read_b128 a[236:239], v45 offset:22528
v_accvgpr_read_b32 v26, a46
v_mfma_f32_16x16x32_bf16 v[200:203], a[196:199], a[216:219], v[200:203]
v_accvgpr_read_b32 v27, a47
v_lshlrev_b32 v28, 16, v24
v_mfma_f32_16x16x32_bf16 v[196:199], a[196:199], a[212:215], v[196:199]
v_and_b32 v29, s25, v24
v_lshlrev_b32 v30, 16, v16
v_mfma_f32_16x16x32_bf16 v[192:195], a[196:199], a[208:211], v[192:195]
s_waitcnt vmcnt(24)
global_load_dwordx4 a[196:199], v2, s[20:21] offset:1024 sc1
v_and_b32 v31, s25, v16
v_mfma_f32_16x16x32_bf16 v[208:211], a[200:203], a[208:211], v[208:211]
v_fma_f32 v62, v28, v62, v30
v_fma_f32 v78, v29, v78, v31
v_mfma_f32_16x16x32_bf16 v[212:215], a[200:203], a[212:215], v[212:215]
v_cvt_pk_bf16_f32 v88, v62, v78
v_lshlrev_b32 v32, 16, v25
v_mfma_f32_16x16x32_bf16 v[216:219], a[200:203], a[216:219], v[216:219]
v_and_b32 v33, s25, v25
v_lshlrev_b32 v34, 16, v17
v_mfma_f32_16x16x32_bf16 v[220:223], a[200:203], a[220:223], v[220:223]
s_waitcnt vmcnt(24)
global_load_dwordx4 a[200:203], v2, s[20:21] offset:2048 sc1
v_and_b32 v35, s25, v17
v_mfma_f32_16x16x32_bf16 v[236:239], a[204:207], a[220:223], v[236:239]
v_fma_f32 v94, v32, v94, v34
v_fma_f32 v110, v33, v110, v35
v_mfma_f32_16x16x32_bf16 v[232:235], a[204:207], a[216:219], v[232:235]
v_cvt_pk_bf16_f32 v89, v94, v110
v_lshlrev_b32 v28, 16, v26
v_mfma_f32_16x16x32_bf16 v[228:231], a[204:207], a[212:215], v[228:231]
v_and_b32 v29, s25, v26
v_lshlrev_b32 v30, 16, v18
v_mfma_f32_16x16x32_bf16 v[224:227], a[204:207], a[208:211], v[224:227]
s_waitcnt vmcnt(24)
global_load_dwordx4 a[204:207], v2, s[20:21] offset:3072 sc1
v_add_u32 v2, 8192, v2
v_mfma_f32_16x16x32_bf16 v[240:243], a[104:107], a[208:211], v[240:243]
v_and_b32 v31, s25, v18
v_fma_f32 v126, v28, v126, v30
v_mfma_f32_16x16x32_bf16 v[244:247], a[104:107], a[212:215], v[244:247]
v_fma_f32 v142, v29, v142, v31
v_cvt_pk_bf16_f32 v90, v126, v142
v_mfma_f32_16x16x32_bf16 v[248:251], a[104:107], a[216:219], v[248:251]
v_lshlrev_b32 v32, 16, v27
v_and_b32 v33, s25, v27
v_mfma_f32_16x16x32_bf16 v[252:255], a[104:107], a[220:223], v[252:255]
s_waitcnt vmcnt(24) lgkmcnt(4)
global_load_dwordx4 a[104:107], v2, s[20:21] offset:-4096 sc1
v_lshlrev_b32 v34, 16, v19
v_mfma_f32_16x16x32_bf16 v[176:179], a[108:111], a[224:227], v[176:179]
s_waitcnt lgkmcnt(3)
ds_read_b128 a[208:211], v5 offset:16384
v_and_b32 v35, s25, v19
v_mfma_f32_16x16x32_bf16 v[180:183], a[108:111], a[228:231], v[180:183]
s_waitcnt lgkmcnt(2)
ds_read_b128 a[212:215], v5 offset:18432
v_fma_f32 v158, v32, v158, v34
v_mfma_f32_16x16x32_bf16 v[184:187], a[108:111], a[232:235], v[184:187]
s_waitcnt lgkmcnt(2)
ds_read_b128 a[216:219], v5 offset:20480
v_fma_f32 v174, v33, v174, v35
v_mfma_f32_16x16x32_bf16 v[188:191], a[108:111], a[236:239], v[188:191]
s_waitcnt vmcnt(24)
global_load_dwordx4 a[108:111], v2, s[20:21] offset:-3072 sc1
v_cvt_pk_bf16_f32 v91, v158, v174
v_mfma_f32_16x16x32_bf16 v[204:207], a[112:115], a[236:239], v[204:207]
ds_read_b128 a[220:223], v5 offset:22528
v_mfma_f32_16x16x32_bf16 v[200:203], a[112:115], a[232:235], v[200:203]
ds_write_b128 v42, v[88:91] offset:6144
v_mfma_f32_16x16x32_bf16 v[196:199], a[112:115], a[228:231], v[196:199]
v_mfma_f32_16x16x32_bf16 v[192:195], a[112:115], a[224:227], v[192:195]
s_waitcnt vmcnt(24)
global_load_dwordx4 a[112:115], v2, s[20:21] offset:-2048 sc1
v_mfma_f32_16x16x32_bf16 v[208:211], a[116:119], a[224:227], v[208:211]
v_mfma_f32_16x16x32_bf16 v[212:215], a[116:119], a[228:231], v[212:215]
v_mfma_f32_16x16x32_bf16 v[216:219], a[116:119], a[232:235], v[216:219]
v_accvgpr_read_b32 v24, a60
v_accvgpr_read_b32 v25, a61
v_mfma_f32_16x16x32_bf16 v[220:223], a[116:119], a[236:239], v[220:223]
s_waitcnt vmcnt(24)
global_load_dwordx4 a[116:119], v2, s[20:21] offset:-1024 sc1
v_accvgpr_read_b32 v26, a62
v_mfma_f32_16x16x32_bf16 v[236:239], a[120:123], a[236:239], v[236:239]
v_accvgpr_read_b32 v27, a63
v_lshlrev_b32 v28, 16, v24
v_mfma_f32_16x16x32_bf16 v[232:235], a[120:123], a[232:235], v[232:235]
v_and_b32 v29, s25, v24
v_lshlrev_b32 v30, 16, v20
v_mfma_f32_16x16x32_bf16 v[228:231], a[120:123], a[228:231], v[228:231]
v_and_b32 v31, s25, v20
v_fma_f32 v63, v28, v63, v30
v_mfma_f32_16x16x32_bf16 v[224:227], a[120:123], a[224:227], v[224:227]
s_waitcnt vmcnt(24)
global_load_dwordx4 a[120:123], v2, s[20:21] offset:0 sc1
v_fma_f32 v79, v29, v79, v31
v_mfma_f32_16x16x32_bf16 v[240:243], a[124:127], a[224:227], v[240:243]
v_cvt_pk_bf16_f32 v104, v63, v79
v_lshlrev_b32 v32, 16, v25
v_mfma_f32_16x16x32_bf16 v[244:247], a[124:127], a[228:231], v[244:247]
v_and_b32 v33, s25, v25
v_lshlrev_b32 v34, 16, v21
v_mfma_f32_16x16x32_bf16 v[248:251], a[124:127], a[232:235], v[248:251]
v_and_b32 v35, s25, v21
v_fma_f32 v95, v32, v95, v34
v_mfma_f32_16x16x32_bf16 v[252:255], a[124:127], a[236:239], v[252:255]
s_waitcnt vmcnt(24) lgkmcnt(4)
global_load_dwordx4 a[124:127], v2, s[20:21] offset:1024 sc1
v_fma_f32 v111, v33, v111, v35
v_mfma_f32_16x16x32_bf16 v[176:179], a[128:131], a[208:211], v[176:179]
s_waitcnt lgkmcnt(3)
ds_read_b128 a[224:227], v46 offset:16384
v_cvt_pk_bf16_f32 v105, v95, v111
v_mfma_f32_16x16x32_bf16 v[180:183], a[128:131], a[212:215], v[180:183]
s_waitcnt lgkmcnt(3)
ds_read_b128 a[228:231], v46 offset:18432
v_lshlrev_b32 v28, 16, v26
v_mfma_f32_16x16x32_bf16 v[184:187], a[128:131], a[216:219], v[184:187]
s_waitcnt lgkmcnt(3)
ds_read_b128 a[232:235], v46 offset:20480
v_and_b32 v29, s25, v26
v_mfma_f32_16x16x32_bf16 v[188:191], a[128:131], a[220:223], v[188:191]
s_waitcnt vmcnt(24)
global_load_dwordx4 a[128:131], v2, s[20:21] offset:2048 sc1
v_lshlrev_b32 v30, 16, v22
v_mfma_f32_16x16x32_bf16 v[204:207], a[132:135], a[220:223], v[204:207]
ds_read_b128 a[236:239], v46 offset:22528
v_and_b32 v31, s25, v22
v_mfma_f32_16x16x32_bf16 v[200:203], a[132:135], a[216:219], v[200:203]
v_fma_f32 v127, v28, v127, v30
v_fma_f32 v143, v29, v143, v31
v_mfma_f32_16x16x32_bf16 v[196:199], a[132:135], a[212:215], v[196:199]
v_cvt_pk_bf16_f32 v106, v127, v143
v_lshlrev_b32 v32, 16, v27
v_mfma_f32_16x16x32_bf16 v[192:195], a[132:135], a[208:211], v[192:195]
s_waitcnt vmcnt(24)
global_load_dwordx4 a[132:135], v2, s[20:21] offset:3072 sc1
v_add_u32 v2, 8192, v2
v_mfma_f32_16x16x32_bf16 v[208:211], a[136:139], a[208:211], v[208:211]
v_and_b32 v33, s25, v27
v_lshlrev_b32 v34, 16, v23
v_mfma_f32_16x16x32_bf16 v[212:215], a[136:139], a[212:215], v[212:215]
v_and_b32 v35, s25, v23
v_fma_f32 v159, v32, v159, v34
v_mfma_f32_16x16x32_bf16 v[216:219], a[136:139], a[216:219], v[216:219]
v_fma_f32 v175, v33, v175, v35
v_cvt_pk_bf16_f32 v107, v159, v175
v_mfma_f32_16x16x32_bf16 v[220:223], a[136:139], a[220:223], v[220:223]
s_waitcnt vmcnt(24)
global_load_dwordx4 a[136:139], v2, s[20:21] offset:-4096 sc1
v_mfma_f32_16x16x32_bf16 v[236:239], a[140:143], a[220:223], v[236:239]
ds_write_b128 v43, v[104:107] offset:6144
v_mfma_f32_16x16x32_bf16 v[232:235], a[140:143], a[216:219], v[232:235]
v_mfma_f32_16x16x32_bf16 v[228:231], a[140:143], a[212:215], v[228:231]
v_mfma_f32_16x16x32_bf16 v[224:227], a[140:143], a[208:211], v[224:227]
s_waitcnt vmcnt(24)
global_load_dwordx4 a[140:143], v2, s[20:21] offset:-3072 sc1
v_mfma_f32_16x16x32_bf16 v[240:243], a[144:147], a[208:211], v[240:243]
v_mfma_f32_16x16x32_bf16 v[244:247], a[144:147], a[212:215], v[244:247]
v_mfma_f32_16x16x32_bf16 v[248:251], a[144:147], a[216:219], v[248:251]
v_mfma_f32_16x16x32_bf16 v[252:255], a[144:147], a[220:223], v[252:255]
s_waitcnt vmcnt(24) lgkmcnt(4)
global_load_dwordx4 a[144:147], v2, s[20:21] offset:-2048 sc1
v_mfma_f32_16x16x32_bf16 v[176:179], a[148:151], a[224:227], v[176:179]
s_waitcnt lgkmcnt(3)
ds_read_b128 a[208:211], v6 offset:16384
v_mfma_f32_16x16x32_bf16 v[180:183], a[148:151], a[228:231], v[180:183]
s_waitcnt lgkmcnt(3)
ds_read_b128 a[212:215], v6 offset:18432
v_mfma_f32_16x16x32_bf16 v[184:187], a[148:151], a[232:235], v[184:187]
s_waitcnt lgkmcnt(3)
ds_read_b128 a[216:219], v6 offset:20480
v_mfma_f32_16x16x32_bf16 v[188:191], a[148:151], a[236:239], v[188:191]
s_waitcnt vmcnt(24)
global_load_dwordx4 a[148:151], v2, s[20:21] offset:-1024 sc1
v_mfma_f32_16x16x32_bf16 v[204:207], a[152:155], a[236:239], v[204:207]
ds_read_b128 a[220:223], v6 offset:22528
v_mfma_f32_16x16x32_bf16 v[200:203], a[152:155], a[232:235], v[200:203]
v_mfma_f32_16x16x32_bf16 v[196:199], a[152:155], a[228:231], v[196:199]
v_mfma_f32_16x16x32_bf16 v[192:195], a[152:155], a[224:227], v[192:195]
s_waitcnt vmcnt(24)
global_load_dwordx4 a[152:155], v2, s[20:21] offset:0 sc1
v_mfma_f32_16x16x32_bf16 v[208:211], a[156:159], a[224:227], v[208:211]
v_mfma_f32_16x16x32_bf16 v[212:215], a[156:159], a[228:231], v[212:215]
v_mfma_f32_16x16x32_bf16 v[216:219], a[156:159], a[232:235], v[216:219]
v_mfma_f32_16x16x32_bf16 v[220:223], a[156:159], a[236:239], v[220:223]
s_waitcnt vmcnt(24)
global_load_dwordx4 a[156:159], v2, s[20:21] offset:1024 sc1
v_mfma_f32_16x16x32_bf16 v[236:239], a[160:163], a[236:239], v[236:239]
v_mfma_f32_16x16x32_bf16 v[232:235], a[160:163], a[232:235], v[232:235]
v_mfma_f32_16x16x32_bf16 v[228:231], a[160:163], a[228:231], v[228:231]
v_mfma_f32_16x16x32_bf16 v[224:227], a[160:163], a[224:227], v[224:227]
s_waitcnt vmcnt(24)
global_load_dwordx4 a[160:163], v2, s[20:21] offset:2048 sc1
v_mfma_f32_16x16x32_bf16 v[240:243], a[164:167], a[224:227], v[240:243]
v_mfma_f32_16x16x32_bf16 v[244:247], a[164:167], a[228:231], v[244:247]
v_mfma_f32_16x16x32_bf16 v[248:251], a[164:167], a[232:235], v[248:251]
v_mfma_f32_16x16x32_bf16 v[252:255], a[164:167], a[236:239], v[252:255]
s_waitcnt vmcnt(24) lgkmcnt(3)
global_load_dwordx4 a[164:167], v2, s[20:21] offset:3072 sc1
v_add_u32 v2, 8192, v2
v_mfma_f32_16x16x32_bf16 v[176:179], a[168:171], a[208:211], v[176:179]
s_waitcnt lgkmcnt(2)
ds_read_b128 a[224:227], v47 offset:16384
v_mfma_f32_16x16x32_bf16 v[180:183], a[168:171], a[212:215], v[180:183]
s_waitcnt lgkmcnt(2)
ds_read_b128 a[228:231], v47 offset:18432
v_mfma_f32_16x16x32_bf16 v[184:187], a[168:171], a[216:219], v[184:187]
s_waitcnt lgkmcnt(2)
ds_read_b128 a[232:235], v47 offset:20480
v_mfma_f32_16x16x32_bf16 v[188:191], a[168:171], a[220:223], v[188:191]
s_waitcnt vmcnt(24)
global_load_dwordx4 a[168:171], v2, s[20:21] offset:-4096 sc1
v_mfma_f32_16x16x32_bf16 v[204:207], a[172:175], a[220:223], v[204:207]
ds_read_b128 a[236:239], v47 offset:22528
v_mfma_f32_16x16x32_bf16 v[200:203], a[172:175], a[216:219], v[200:203]
v_mfma_f32_16x16x32_bf16 v[196:199], a[172:175], a[212:215], v[196:199]
v_mfma_f32_16x16x32_bf16 v[192:195], a[172:175], a[208:211], v[192:195]
s_waitcnt vmcnt(24)
global_load_dwordx4 a[172:175], v2, s[20:21] offset:-3072 sc1
v_mfma_f32_16x16x32_bf16 v[208:211], a[176:179], a[208:211], v[208:211]
v_mfma_f32_16x16x32_bf16 v[212:215], a[176:179], a[212:215], v[212:215]
v_mfma_f32_16x16x32_bf16 v[216:219], a[176:179], a[216:219], v[216:219]
v_mfma_f32_16x16x32_bf16 v[220:223], a[176:179], a[220:223], v[220:223]
s_waitcnt vmcnt(24)
global_load_dwordx4 a[176:179], v2, s[20:21] offset:-2048 sc1
v_mfma_f32_16x16x32_bf16 v[236:239], a[180:183], a[220:223], v[236:239]
v_mfma_f32_16x16x32_bf16 v[232:235], a[180:183], a[216:219], v[232:235]
v_mfma_f32_16x16x32_bf16 v[228:231], a[180:183], a[212:215], v[228:231]
v_mfma_f32_16x16x32_bf16 v[224:227], a[180:183], a[208:211], v[224:227]
s_waitcnt vmcnt(24)
global_load_dwordx4 a[180:183], v2, s[20:21] offset:-1024 sc1
v_mfma_f32_16x16x32_bf16 v[240:243], a[184:187], a[208:211], v[240:243]
v_mfma_f32_16x16x32_bf16 v[244:247], a[184:187], a[212:215], v[244:247]
v_mfma_f32_16x16x32_bf16 v[248:251], a[184:187], a[216:219], v[248:251]
v_mfma_f32_16x16x32_bf16 v[252:255], a[184:187], a[220:223], v[252:255]
s_waitcnt vmcnt(24) lgkmcnt(3)
global_load_dwordx4 a[184:187], v2, s[20:21] offset:0 sc1
v_mfma_f32_16x16x32_bf16 v[176:179], a[188:191], a[224:227], v[176:179]
s_waitcnt lgkmcnt(2)
ds_read_b128 a[208:211], v3 offset:0
ds_read2_b32 v[60:61], v0 offset0:0 offset1:8
v_mfma_f32_16x16x32_bf16 v[180:183], a[188:191], a[228:231], v[180:183]
s_waitcnt lgkmcnt(3)
ds_read_b128 a[212:215], v3 offset:2048
ds_read2_b32 v[62:63], v0 offset0:16 offset1:24
v_mfma_f32_16x16x32_bf16 v[184:187], a[188:191], a[232:235], v[184:187]
s_waitcnt lgkmcnt(4)
ds_read_b128 a[216:219], v3 offset:4096
ds_read2_b32 v[76:77], v0 offset0:1 offset1:9
v_mfma_f32_16x16x32_bf16 v[188:191], a[188:191], a[236:239], v[188:191]
s_waitcnt vmcnt(24)
global_load_dwordx4 a[188:191], v2, s[20:21] offset:1024 sc1
ds_read2_b32 v[78:79], v0 offset0:17 offset1:25
v_mfma_f32_16x16x32_bf16 v[204:207], a[192:195], a[236:239], v[204:207]
ds_read_b128 a[220:223], v3 offset:6144
ds_read2_b32 v[92:93], v0 offset0:2 offset1:10
v_mfma_f32_16x16x32_bf16 v[200:203], a[192:195], a[232:235], v[200:203]
ds_read2_b32 v[94:95], v0 offset0:18 offset1:26
v_mfma_f32_16x16x32_bf16 v[196:199], a[192:195], a[228:231], v[196:199]
ds_read2_b32 v[108:109], v0 offset0:3 offset1:11
v_mfma_f32_16x16x32_bf16 v[192:195], a[192:195], a[224:227], v[192:195]
s_waitcnt vmcnt(24)
global_load_dwordx4 a[192:195], v2, s[20:21] offset:2048 sc1
ds_read2_b32 v[110:111], v0 offset0:19 offset1:27
v_mfma_f32_16x16x32_bf16 v[208:211], a[196:199], a[224:227], v[208:211]
ds_read2_b32 v[124:125], v0 offset0:4 offset1:12
v_mfma_f32_16x16x32_bf16 v[212:215], a[196:199], a[228:231], v[212:215]
ds_read2_b32 v[126:127], v0 offset0:20 offset1:28
v_mfma_f32_16x16x32_bf16 v[216:219], a[196:199], a[232:235], v[216:219]
ds_read2_b32 v[140:141], v0 offset0:5 offset1:13
v_mfma_f32_16x16x32_bf16 v[220:223], a[196:199], a[236:239], v[220:223]
s_waitcnt vmcnt(24)
global_load_dwordx4 a[196:199], v2, s[20:21] offset:3072 sc1
v_add_u32 v2, 8192, v2
v_mfma_f32_16x16x32_bf16 v[236:239], a[200:203], a[236:239], v[236:239]
ds_read2_b32 v[142:143], v0 offset0:21 offset1:29
v_mfma_f32_16x16x32_bf16 v[232:235], a[200:203], a[232:235], v[232:235]
ds_read2_b32 v[156:157], v0 offset0:6 offset1:14
v_mfma_f32_16x16x32_bf16 v[228:231], a[200:203], a[228:231], v[228:231]
ds_read2_b32 v[158:159], v0 offset0:22 offset1:30
v_mfma_f32_16x16x32_bf16 v[224:227], a[200:203], a[224:227], v[224:227]
s_waitcnt vmcnt(24)
global_load_dwordx4 a[200:203], v2, s[20:21] offset:-4096 sc1
ds_read2_b32 v[172:173], v0 offset0:7 offset1:15
v_mfma_f32_16x16x32_bf16 v[240:243], a[204:207], a[224:227], v[240:243]
ds_read2_b32 v[174:175], v0 offset0:23 offset1:31
v_mfma_f32_16x16x32_bf16 v[244:247], a[204:207], a[228:231], v[244:247]
v_mfma_f32_16x16x32_bf16 v[248:251], a[204:207], a[232:235], v[248:251]
v_mfma_f32_16x16x32_bf16 v[252:255], a[204:207], a[236:239], v[252:255]
s_barrier
global_load_dwordx4 a[204:207], v2, s[20:21] offset:-3072 sc1
v_add_u32 v2, 2048, v2
s_add_u32 s26, s26, 1
s_waitcnt vmcnt(25) lgkmcnt(15)
v_mfma_f32_16x16x32_bf16 v[48:51], a[104:107], a[208:211], v[60:63]
ds_read_b128 a[224:227], v4 offset:0
v_add_u32 v13, 3328, v13
v_mfma_f32_16x16x32_bf16 v[52:55], a[104:107], a[212:215], v[60:63]
ds_read_b128 a[228:231], v4 offset:2048
v_add_u32 v14, 3328, v14
v_mfma_f32_16x16x32_bf16 v[56:59], a[104:107], a[216:219], v[60:63]
s_waitcnt lgkmcnt(14)
ds_read_b128 a[232:235], v4 offset:4096
v_add_u32 v0, 3328, v0
v_mfma_f32_16x16x32_bf16 v[60:63], a[104:107], a[220:223], v[60:63]
s_waitcnt vmcnt(24)
global_load_dwordx4 a[104:107], v2, s[20:21] offset:-4096 sc1
ds_read_b128 v[16:19], v3 offset:16384
v_mfma_f32_16x16x32_bf16 v[64:67], a[108:111], a[208:211], v[76:79]
ds_read_b128 a[236:239], v4 offset:6144
ds_read_b128 v[20:23], v3 offset:18432
v_mfma_f32_16x16x32_bf16 v[68:71], a[108:111], a[212:215], v[76:79]
v_accvgpr_read_b32 v24, a64
v_accvgpr_read_b32 v25, a65
v_mfma_f32_16x16x32_bf16 v[72:75], a[108:111], a[216:219], v[76:79]
v_accvgpr_read_b32 v26, a66
v_accvgpr_read_b32 v27, a67
v_mfma_f32_16x16x32_bf16 v[76:79], a[108:111], a[220:223], v[76:79]
s_waitcnt vmcnt(24) lgkmcnt(15)
global_load_dwordx4 a[108:111], v2, s[20:21] offset:-3072 sc1
v_lshlrev_b32 v28, 16, v24
v_mfma_f32_16x16x32_bf16 v[80:83], a[112:115], a[208:211], v[92:95]
s_waitcnt lgkmcnt(2)
v_and_b32 v29, s25, v24
v_lshlrev_b32 v30, 16, v16
v_mfma_f32_16x16x32_bf16 v[84:87], a[112:115], a[212:215], v[92:95]
v_and_b32 v31, s25, v16
v_fma_f32 v176, v28, v176, v30
v_mfma_f32_16x16x32_bf16 v[88:91], a[112:115], a[216:219], v[92:95]
v_fma_f32 v177, v29, v177, v31
v_cvt_pk_bf16_f32 v176, v176, v177
v_mfma_f32_16x16x32_bf16 v[92:95], a[112:115], a[220:223], v[92:95]
s_waitcnt vmcnt(24)
global_load_dwordx4 a[112:115], v2, s[20:21] offset:-2048 sc1
v_lshlrev_b32 v32, 16, v25
v_mfma_f32_16x16x32_bf16 v[96:99], a[116:119], a[208:211], v[108:111]
v_and_b32 v33, s25, v25
v_lshlrev_b32 v34, 16, v17
v_mfma_f32_16x16x32_bf16 v[100:103], a[116:119], a[212:215], v[108:111]
v_and_b32 v35, s25, v17
v_fma_f32 v178, v32, v178, v34
v_mfma_f32_16x16x32_bf16 v[104:107], a[116:119], a[216:219], v[108:111]
v_fma_f32 v179, v33, v179, v35
v_cvt_pk_bf16_f32 v177, v178, v179
v_mfma_f32_16x16x32_bf16 v[108:111], a[116:119], a[220:223], v[108:111]
s_waitcnt vmcnt(24)
global_load_dwordx4 a[116:119], v2, s[20:21] offset:-1024 sc1
v_lshlrev_b32 v28, 16, v26
v_mfma_f32_16x16x32_bf16 v[112:115], a[120:123], a[208:211], v[124:127]
v_and_b32 v29, s25, v26
v_lshlrev_b32 v30, 16, v18
v_mfma_f32_16x16x32_bf16 v[116:119], a[120:123], a[212:215], v[124:127]
v_and_b32 v31, s25, v18
v_fma_f32 v192, v28, v192, v30
v_mfma_f32_16x16x32_bf16 v[120:123], a[120:123], a[216:219], v[124:127]
v_fma_f32 v193, v29, v193, v31
v_cvt_pk_bf16_f32 v178, v192, v193
v_mfma_f32_16x16x32_bf16 v[124:127], a[120:123], a[220:223], v[124:127]
s_waitcnt vmcnt(24)
global_load_dwordx4 a[120:123], v2, s[20:21] offset:0 sc1
v_lshlrev_b32 v32, 16, v27
v_mfma_f32_16x16x32_bf16 v[128:131], a[124:127], a[208:211], v[140:143]
v_and_b32 v33, s25, v27
v_lshlrev_b32 v34, 16, v19
v_mfma_f32_16x16x32_bf16 v[132:135], a[124:127], a[212:215], v[140:143]
v_and_b32 v35, s25, v19
v_fma_f32 v194, v32, v194, v34
v_mfma_f32_16x16x32_bf16 v[136:139], a[124:127], a[216:219], v[140:143]
v_fma_f32 v195, v33, v195, v35
v_cvt_pk_bf16_f32 v179, v194, v195
v_mfma_f32_16x16x32_bf16 v[140:143], a[124:127], a[220:223], v[140:143]
s_waitcnt vmcnt(24)
global_load_dwordx4 a[124:127], v2, s[20:21] offset:1024 sc1
v_mfma_f32_16x16x32_bf16 v[144:147], a[128:131], a[208:211], v[156:159]
ds_write_b128 v3, v[176:179] offset:16384
v_mfma_f32_16x16x32_bf16 v[148:151], a[128:131], a[212:215], v[156:159]
v_mfma_f32_16x16x32_bf16 v[152:155], a[128:131], a[216:219], v[156:159]
v_mfma_f32_16x16x32_bf16 v[156:159], a[128:131], a[220:223], v[156:159]
s_waitcnt vmcnt(24)
global_load_dwordx4 a[128:131], v2, s[20:21] offset:2048 sc1
v_mfma_f32_16x16x32_bf16 v[160:163], a[132:135], a[208:211], v[172:175]
v_mfma_f32_16x16x32_bf16 v[164:167], a[132:135], a[212:215], v[172:175]
v_mfma_f32_16x16x32_bf16 v[168:171], a[132:135], a[216:219], v[172:175]
v_mfma_f32_16x16x32_bf16 v[172:175], a[132:135], a[220:223], v[172:175]
s_waitcnt vmcnt(24)
global_load_dwordx4 a[132:135], v2, s[20:21] offset:3072 sc1
v_add_u32 v2, 8192, v2
v_mfma_f32_16x16x32_bf16 v[48:51], a[136:139], a[224:227], v[48:51]
ds_read_b128 a[208:211], v5 offset:0
v_mfma_f32_16x16x32_bf16 v[52:55], a[136:139], a[228:231], v[52:55]
ds_read_b128 a[212:215], v5 offset:2048
v_mfma_f32_16x16x32_bf16 v[56:59], a[136:139], a[232:235], v[56:59]
s_waitcnt lgkmcnt(4)
ds_read_b128 a[216:219], v5 offset:4096
v_mfma_f32_16x16x32_bf16 v[60:63], a[136:139], a[236:239], v[60:63]
s_waitcnt vmcnt(24)
global_load_dwordx4 a[136:139], v2, s[20:21] offset:-4096 sc1
v_mfma_f32_16x16x32_bf16 v[76:79], a[140:143], a[236:239], v[76:79]
ds_read_b128 a[220:223], v5 offset:6144
v_mfma_f32_16x16x32_bf16 v[72:75], a[140:143], a[232:235], v[72:75]
v_mfma_f32_16x16x32_bf16 v[68:71], a[140:143], a[228:231], v[68:71]
v_mfma_f32_16x16x32_bf16 v[64:67], a[140:143], a[224:227], v[64:67]
s_waitcnt vmcnt(24)
global_load_dwordx4 a[140:143], v2, s[20:21] offset:-3072 sc1
ds_read_b128 v[16:19], v3 offset:20480
v_mfma_f32_16x16x32_bf16 v[80:83], a[144:147], a[224:227], v[80:83]
v_accvgpr_read_b32 v24, a68
v_accvgpr_read_b32 v25, a69
v_mfma_f32_16x16x32_bf16 v[84:87], a[144:147], a[228:231], v[84:87]
v_accvgpr_read_b32 v26, a70
v_accvgpr_read_b32 v27, a71
v_mfma_f32_16x16x32_bf16 v[88:91], a[144:147], a[232:235], v[88:91]
v_lshlrev_b32 v28, 16, v24
v_and_b32 v29, s25, v24
v_mfma_f32_16x16x32_bf16 v[92:95], a[144:147], a[236:239], v[92:95]
s_waitcnt vmcnt(24) lgkmcnt(6)
global_load_dwordx4 a[144:147], v2, s[20:21] offset:-2048 sc1
v_lshlrev_b32 v30, 16, v20
v_mfma_f32_16x16x32_bf16 v[108:111], a[148:151], a[236:239], v[108:111]
v_and_b32 v31, s25, v20
v_fma_f32 v180, v28, v180, v30
v_mfma_f32_16x16x32_bf16 v[104:107], a[148:151], a[232:235], v[104:107]
v_fma_f32 v181, v29, v181, v31
v_cvt_pk_bf16_f32 v180, v180, v181
v_mfma_f32_16x16x32_bf16 v[100:103], a[148:151], a[228:231], v[100:103]
v_lshlrev_b32 v32, 16, v25
v_and_b32 v33, s25, v25
v_mfma_f32_16x16x32_bf16 v[96:99], a[148:151], a[224:227], v[96:99]
s_waitcnt vmcnt(24)
global_load_dwordx4 a[148:151], v2, s[20:21] offset:-1024 sc1
v_lshlrev_b32 v34, 16, v21
v_mfma_f32_16x16x32_bf16 v[112:115], a[152:155], a[224:227], v[112:115]
v_and_b32 v35, s25, v21
v_fma_f32 v182, v32, v182, v34
v_mfma_f32_16x16x32_bf16 v[116:119], a[152:155], a[228:231], v[116:119]
v_fma_f32 v183, v33, v183, v35
v_cvt_pk_bf16_f32 v181, v182, v183
v_mfma_f32_16x16x32_bf16 v[120:123], a[152:155], a[232:235], v[120:123]
v_lshlrev_b32 v28, 16, v26
v_and_b32 v29, s25, v26
v_mfma_f32_16x16x32_bf16 v[124:127], a[152:155], a[236:239], v[124:127]
s_waitcnt vmcnt(24)
global_load_dwordx4 a[152:155], v2, s[20:21] offset:0 sc1
v_lshlrev_b32 v30, 16, v22
v_mfma_f32_16x16x32_bf16 v[140:143], a[156:159], a[236:239], v[140:143]
v_and_b32 v31, s25, v22
v_fma_f32 v196, v28, v196, v30
v_mfma_f32_16x16x32_bf16 v[136:139], a[156:159], a[232:235], v[136:139]
v_fma_f32 v197, v29, v197, v31
v_cvt_pk_bf16_f32 v182, v196, v197
v_mfma_f32_16x16x32_bf16 v[132:135], a[156:159], a[228:231], v[132:135]
v_lshlrev_b32 v32, 16, v27
v_and_b32 v33, s25, v27
v_mfma_f32_16x16x32_bf16 v[128:131], a[156:159], a[224:227], v[128:131]
s_waitcnt vmcnt(24)
global_load_dwordx4 a[156:159], v2, s[20:21] offset:1024 sc1
v_lshlrev_b32 v34, 16, v23
v_mfma_f32_16x16x32_bf16 v[144:147], a[160:163], a[224:227], v[144:147]
v_and_b32 v35, s25, v23
v_fma_f32 v198, v32, v198, v34
v_mfma_f32_16x16x32_bf16 v[148:151], a[160:163], a[228:231], v[148:151]
v_fma_f32 v199, v33, v199, v35
v_cvt_pk_bf16_f32 v183, v198, v199
v_mfma_f32_16x16x32_bf16 v[152:155], a[160:163], a[232:235], v[152:155]
ds_write_b128 v3, v[180:183] offset:18432
v_mfma_f32_16x16x32_bf16 v[156:159], a[160:163], a[236:239], v[156:159]
s_waitcnt vmcnt(24)
global_load_dwordx4 a[160:163], v2, s[20:21] offset:2048 sc1
v_mfma_f32_16x16x32_bf16 v[172:175], a[164:167], a[236:239], v[172:175]
v_mfma_f32_16x16x32_bf16 v[168:171], a[164:167], a[232:235], v[168:171]
v_mfma_f32_16x16x32_bf16 v[164:167], a[164:167], a[228:231], v[164:167]
v_mfma_f32_16x16x32_bf16 v[160:163], a[164:167], a[224:227], v[160:163]
s_waitcnt vmcnt(24) lgkmcnt(5)
global_load_dwordx4 a[164:167], v2, s[20:21] offset:3072 sc1
v_add_u32 v2, 8192, v2
v_mfma_f32_16x16x32_bf16 v[48:51], a[168:171], a[208:211], v[48:51]
s_waitcnt lgkmcnt(4)
ds_read_b128 a[224:227], v6 offset:0
v_mfma_f32_16x16x32_bf16 v[52:55], a[168:171], a[212:215], v[52:55]
s_waitcnt lgkmcnt(4)
ds_read_b128 a[228:231], v6 offset:2048
v_mfma_f32_16x16x32_bf16 v[56:59], a[168:171], a[216:219], v[56:59]
s_waitcnt lgkmcnt(4)
ds_read_b128 a[232:235], v6 offset:4096
v_mfma_f32_16x16x32_bf16 v[60:63], a[168:171], a[220:223], v[60:63]
s_waitcnt vmcnt(24)
global_load_dwordx4 a[168:171], v2, s[20:21] offset:-4096 sc1
v_mfma_f32_16x16x32_bf16 v[76:79], a[172:175], a[220:223], v[76:79]
ds_read_b128 a[236:239], v6 offset:6144
v_mfma_f32_16x16x32_bf16 v[72:75], a[172:175], a[216:219], v[72:75]
v_mfma_f32_16x16x32_bf16 v[68:71], a[172:175], a[212:215], v[68:71]
v_mfma_f32_16x16x32_bf16 v[64:67], a[172:175], a[208:211], v[64:67]
s_waitcnt vmcnt(24)
global_load_dwordx4 a[172:175], v2, s[20:21] offset:-3072 sc1
v_mfma_f32_16x16x32_bf16 v[80:83], a[176:179], a[208:211], v[80:83]
v_mfma_f32_16x16x32_bf16 v[84:87], a[176:179], a[212:215], v[84:87]
v_mfma_f32_16x16x32_bf16 v[88:91], a[176:179], a[216:219], v[88:91]
v_mfma_f32_16x16x32_bf16 v[92:95], a[176:179], a[220:223], v[92:95]
s_waitcnt vmcnt(24)
global_load_dwordx4 a[176:179], v2, s[20:21] offset:-2048 sc1
v_mfma_f32_16x16x32_bf16 v[108:111], a[180:183], a[220:223], v[108:111]
v_mfma_f32_16x16x32_bf16 v[104:107], a[180:183], a[216:219], v[104:107]
v_mfma_f32_16x16x32_bf16 v[100:103], a[180:183], a[212:215], v[100:103]
v_mfma_f32_16x16x32_bf16 v[96:99], a[180:183], a[208:211], v[96:99]
s_waitcnt vmcnt(24)
global_load_dwordx4 a[180:183], v2, s[20:21] offset:-1024 sc1
ds_read_b128 v[20:23], v3 offset:22528
v_mfma_f32_16x16x32_bf16 v[112:115], a[184:187], a[208:211], v[112:115]
v_accvgpr_read_b32 v24, a72
v_accvgpr_read_b32 v25, a73
v_mfma_f32_16x16x32_bf16 v[116:119], a[184:187], a[212:215], v[116:119]
v_accvgpr_read_b32 v26, a74
v_accvgpr_read_b32 v27, a75
v_mfma_f32_16x16x32_bf16 v[120:123], a[184:187], a[216:219], v[120:123]
v_lshlrev_b32 v28, 16, v24
v_and_b32 v29, s25, v24
v_mfma_f32_16x16x32_bf16 v[124:127], a[184:187], a[220:223], v[124:127]
s_waitcnt vmcnt(24) lgkmcnt(6)
global_load_dwordx4 a[184:187], v2, s[20:21] offset:0 sc1
v_lshlrev_b32 v30, 16, v16
v_mfma_f32_16x16x32_bf16 v[140:143], a[188:191], a[220:223], v[140:143]
v_and_b32 v31, s25, v16
v_fma_f32 v184, v28, v184, v30
v_mfma_f32_16x16x32_bf16 v[136:139], a[188:191], a[216:219], v[136:139]
v_fma_f32 v185, v29, v185, v31
v_cvt_pk_bf16_f32 v184, v184, v185
v_mfma_f32_16x16x32_bf16 v[132:135], a[188:191], a[212:215], v[132:135]
v_lshlrev_b32 v32, 16, v25
v_and_b32 v33, s25, v25
v_mfma_f32_16x16x32_bf16 v[128:131], a[188:191], a[208:211], v[128:131]
s_waitcnt vmcnt(24)
global_load_dwordx4 a[188:191], v2, s[20:21] offset:1024 sc1
v_lshlrev_b32 v34, 16, v17
v_mfma_f32_16x16x32_bf16 v[144:147], a[192:195], a[208:211], v[144:147]
v_and_b32 v35, s25, v17
v_fma_f32 v186, v32, v186, v34
v_mfma_f32_16x16x32_bf16 v[148:151], a[192:195], a[212:215], v[148:151]
v_fma_f32 v187, v33, v187, v35
v_cvt_pk_bf16_f32 v185, v186, v187
v_mfma_f32_16x16x32_bf16 v[152:155], a[192:195], a[216:219], v[152:155]
v_lshlrev_b32 v28, 16, v26
v_and_b32 v29, s25, v26
v_mfma_f32_16x16x32_bf16 v[156:159], a[192:195], a[220:223], v[156:159]
s_waitcnt vmcnt(24)
global_load_dwordx4 a[192:195], v2, s[20:21] offset:2048 sc1
v_lshlrev_b32 v30, 16, v18
v_mfma_f32_16x16x32_bf16 v[172:175], a[196:199], a[220:223], v[172:175]
v_and_b32 v31, s25, v18
v_fma_f32 v200, v28, v200, v30
v_mfma_f32_16x16x32_bf16 v[168:171], a[196:199], a[216:219], v[168:171]
v_fma_f32 v201, v29, v201, v31
v_cvt_pk_bf16_f32 v186, v200, v201
v_mfma_f32_16x16x32_bf16 v[164:167], a[196:199], a[212:215], v[164:167]
v_lshlrev_b32 v32, 16, v27
v_and_b32 v33, s25, v27
v_mfma_f32_16x16x32_bf16 v[160:163], a[196:199], a[208:211], v[160:163]
s_waitcnt vmcnt(24) lgkmcnt(4)
global_load_dwordx4 a[196:199], v2, s[20:21] offset:3072 sc1
v_add_u32 v2, 8192, v2
v_mfma_f32_16x16x32_bf16 v[48:51], a[200:203], a[224:227], v[48:51]
s_waitcnt lgkmcnt(3)
ds_read_b128 a[208:211], v44 offset:0
v_lshlrev_b32 v34, 16, v19
v_mfma_f32_16x16x32_bf16 v[52:55], a[200:203], a[228:231], v[52:55]
s_waitcnt lgkmcnt(3)
ds_read_b128 a[212:215], v44 offset:2048
v_and_b32 v35, s25, v19
v_mfma_f32_16x16x32_bf16 v[56:59], a[200:203], a[232:235], v[56:59]
s_waitcnt lgkmcnt(3)
ds_read_b128 a[216:219], v44 offset:4096
v_fma_f32 v202, v32, v202, v34
v_mfma_f32_16x16x32_bf16 v[60:63], a[200:203], a[236:239], v[60:63]
s_waitcnt vmcnt(24)
global_load_dwordx4 a[200:203], v2, s[20:21] offset:-4096 sc1
v_fma_f32 v203, v33, v203, v35
v_mfma_f32_16x16x32_bf16 v[76:79], a[204:207], a[236:239], v[76:79]
ds_read_b128 a[220:223], v44 offset:6144
v_cvt_pk_bf16_f32 v187, v202, v203
v_mfma_f32_16x16x32_bf16 v[72:75], a[204:207], a[232:235], v[72:75]
ds_write_b128 v3, v[184:187] offset:20480
v_mfma_f32_16x16x32_bf16 v[68:71], a[204:207], a[228:231], v[68:71]
v_mfma_f32_16x16x32_bf16 v[64:67], a[204:207], a[224:227], v[64:67]
s_waitcnt vmcnt(24)
global_load_dwordx4 a[204:207], v2, s[20:21] offset:-3072 sc1
v_mfma_f32_16x16x32_bf16 v[80:83], a[104:107], a[224:227], v[80:83]
v_mfma_f32_16x16x32_bf16 v[84:87], a[104:107], a[228:231], v[84:87]
v_mfma_f32_16x16x32_bf16 v[88:91], a[104:107], a[232:235], v[88:91]
v_mfma_f32_16x16x32_bf16 v[92:95], a[104:107], a[236:239], v[92:95]
s_waitcnt vmcnt(24)
global_load_dwordx4 a[104:107], v2, s[20:21] offset:-2048 sc1
v_mfma_f32_16x16x32_bf16 v[108:111], a[108:111], a[236:239], v[108:111]
v_mfma_f32_16x16x32_bf16 v[104:107], a[108:111], a[232:235], v[104:107]
v_mfma_f32_16x16x32_bf16 v[100:103], a[108:111], a[228:231], v[100:103]
v_mfma_f32_16x16x32_bf16 v[96:99], a[108:111], a[224:227], v[96:99]
s_waitcnt vmcnt(24)
global_load_dwordx4 a[108:111], v2, s[20:21] offset:-1024 sc1
v_mfma_f32_16x16x32_bf16 v[112:115], a[112:115], a[224:227], v[112:115]
v_mfma_f32_16x16x32_bf16 v[116:119], a[112:115], a[228:231], v[116:119]
v_mfma_f32_16x16x32_bf16 v[120:123], a[112:115], a[232:235], v[120:123]
v_mfma_f32_16x16x32_bf16 v[124:127], a[112:115], a[236:239], v[124:127]
s_waitcnt vmcnt(24)
global_load_dwordx4 a[112:115], v2, s[20:21] offset:0 sc1
v_mfma_f32_16x16x32_bf16 v[140:143], a[116:119], a[236:239], v[140:143]
v_mfma_f32_16x16x32_bf16 v[136:139], a[116:119], a[232:235], v[136:139]
v_mfma_f32_16x16x32_bf16 v[132:135], a[116:119], a[228:231], v[132:135]
v_mfma_f32_16x16x32_bf16 v[128:131], a[116:119], a[224:227], v[128:131]
s_waitcnt vmcnt(24)
global_load_dwordx4 a[116:119], v2, s[20:21] offset:1024 sc1
ds_read_b128 v[16:19], v44 offset:16384
v_mfma_f32_16x16x32_bf16 v[144:147], a[120:123], a[224:227], v[144:147]
v_accvgpr_read_b32 v24, a76
v_accvgpr_read_b32 v25, a77
v_mfma_f32_16x16x32_bf16 v[148:151], a[120:123], a[228:231], v[148:151]
v_accvgpr_read_b32 v26, a78
v_accvgpr_read_b32 v27, a79
v_mfma_f32_16x16x32_bf16 v[152:155], a[120:123], a[232:235], v[152:155]
v_lshlrev_b32 v28, 16, v24
v_and_b32 v29, s25, v24
v_mfma_f32_16x16x32_bf16 v[156:159], a[120:123], a[236:239], v[156:159]
s_waitcnt vmcnt(24) lgkmcnt(6)
global_load_dwordx4 a[120:123], v2, s[20:21] offset:2048 sc1
v_lshlrev_b32 v30, 16, v20
v_mfma_f32_16x16x32_bf16 v[172:175], a[124:127], a[236:239], v[172:175]
v_and_b32 v31, s25, v20
v_fma_f32 v188, v28, v188, v30
v_mfma_f32_16x16x32_bf16 v[168:171], a[124:127], a[232:235], v[168:171]
v_fma_f32 v189, v29, v189, v31
v_cvt_pk_bf16_f32 v188, v188, v189
v_mfma_f32_16x16x32_bf16 v[164:167], a[124:127], a[228:231], v[164:167]
v_lshlrev_b32 v32, 16, v25
v_and_b32 v33, s25, v25
v_mfma_f32_16x16x32_bf16 v[160:163], a[124:127], a[224:227], v[160:163]
s_waitcnt vmcnt(24) lgkmcnt(5)
global_load_dwordx4 a[124:127], v2, s[20:21] offset:3072 sc1
v_add_u32 v2, 8192, v2
v_mfma_f32_16x16x32_bf16 v[48:51], a[128:131], a[208:211], v[48:51]
s_waitcnt lgkmcnt(4)
ds_read_b128 a[224:227], v45 offset:0
v_lshlrev_b32 v34, 16, v21
v_mfma_f32_16x16x32_bf16 v[52:55], a[128:131], a[212:215], v[52:55]
s_waitcnt lgkmcnt(4)
ds_read_b128 a[228:231], v45 offset:2048
v_and_b32 v35, s25, v21
v_mfma_f32_16x16x32_bf16 v[56:59], a[128:131], a[216:219], v[56:59]
s_waitcnt lgkmcnt(4)
ds_read_b128 a[232:235], v45 offset:4096
v_fma_f32 v190, v32, v190, v34
v_mfma_f32_16x16x32_bf16 v[60:63], a[128:131], a[220:223], v[60:63]
s_waitcnt vmcnt(24)
global_load_dwordx4 a[128:131], v2, s[20:21] offset:-4096 sc1
v_fma_f32 v191, v33, v191, v35
v_mfma_f32_16x16x32_bf16 v[76:79], a[132:135], a[220:223], v[76:79]
ds_read_b128 a[236:239], v45 offset:6144
v_cvt_pk_bf16_f32 v189, v190, v191
v_mfma_f32_16x16x32_bf16 v[72:75], a[132:135], a[216:219], v[72:75]
v_lshlrev_b32 v28, 16, v26
v_and_b32 v29, s25, v26
v_mfma_f32_16x16x32_bf16 v[68:71], a[132:135], a[212:215], v[68:71]
v_lshlrev_b32 v30, 16, v22
v_and_b32 v31, s25, v22
v_mfma_f32_16x16x32_bf16 v[64:67], a[132:135], a[208:211], v[64:67]
s_waitcnt vmcnt(24)
global_load_dwordx4 a[132:135], v2, s[20:21] offset:-3072 sc1
v_fma_f32 v204, v28, v204, v30
v_mfma_f32_16x16x32_bf16 v[80:83], a[136:139], a[208:211], v[80:83]
v_fma_f32 v205, v29, v205, v31
v_cvt_pk_bf16_f32 v190, v204, v205
v_mfma_f32_16x16x32_bf16 v[84:87], a[136:139], a[212:215], v[84:87]
v_lshlrev_b32 v32, 16, v27
v_and_b32 v33, s25, v27
v_mfma_f32_16x16x32_bf16 v[88:91], a[136:139], a[216:219], v[88:91]
v_lshlrev_b32 v34, 16, v23
v_and_b32 v35, s25, v23
v_mfma_f32_16x16x32_bf16 v[92:95], a[136:139], a[220:223], v[92:95]
s_waitcnt vmcnt(24)
global_load_dwordx4 a[136:139], v2, s[20:21] offset:-2048 sc1
v_fma_f32 v206, v32, v206, v34
v_mfma_f32_16x16x32_bf16 v[108:111], a[140:143], a[220:223], v[108:111]
v_fma_f32 v207, v33, v207, v35
v_cvt_pk_bf16_f32 v191, v206, v207
v_mfma_f32_16x16x32_bf16 v[104:107], a[140:143], a[216:219], v[104:107]
ds_write_b128 v3, v[188:191] offset:22528
v_mfma_f32_16x16x32_bf16 v[100:103], a[140:143], a[212:215], v[100:103]
v_mfma_f32_16x16x32_bf16 v[96:99], a[140:143], a[208:211], v[96:99]
s_waitcnt vmcnt(24)
global_load_dwordx4 a[140:143], v2, s[20:21] offset:-1024 sc1
v_mfma_f32_16x16x32_bf16 v[112:115], a[144:147], a[208:211], v[112:115]
v_mfma_f32_16x16x32_bf16 v[116:119], a[144:147], a[212:215], v[116:119]
v_mfma_f32_16x16x32_bf16 v[120:123], a[144:147], a[216:219], v[120:123]
v_mfma_f32_16x16x32_bf16 v[124:127], a[144:147], a[220:223], v[124:127]
s_waitcnt vmcnt(24)
global_load_dwordx4 a[144:147], v2, s[20:21] offset:0 sc1
v_mfma_f32_16x16x32_bf16 v[140:143], a[148:151], a[220:223], v[140:143]
v_mfma_f32_16x16x32_bf16 v[136:139], a[148:151], a[216:219], v[136:139]
v_mfma_f32_16x16x32_bf16 v[132:135], a[148:151], a[212:215], v[132:135]
global_load_dwordx4 a[240:243], v38, s[32:33]
v_mfma_f32_16x16x32_bf16 v[128:131], a[148:151], a[208:211], v[128:131]
s_waitcnt vmcnt(25)
global_load_dwordx4 a[148:151], v2, s[20:21] offset:1024 sc1
v_mfma_f32_16x16x32_bf16 v[144:147], a[152:155], a[208:211], v[144:147]
v_mfma_f32_16x16x32_bf16 v[148:151], a[152:155], a[212:215], v[148:151]
v_mfma_f32_16x16x32_bf16 v[152:155], a[152:155], a[216:219], v[152:155]
v_mfma_f32_16x16x32_bf16 v[156:159], a[152:155], a[220:223], v[156:159]
s_waitcnt vmcnt(25)
global_load_dwordx4 a[152:155], v2, s[20:21] offset:2048 sc1
v_mfma_f32_16x16x32_bf16 v[172:175], a[156:159], a[220:223], v[172:175]
v_mfma_f32_16x16x32_bf16 v[168:171], a[156:159], a[216:219], v[168:171]
v_mfma_f32_16x16x32_bf16 v[164:167], a[156:159], a[212:215], v[164:167]
v_mfma_f32_16x16x32_bf16 v[160:163], a[156:159], a[208:211], v[160:163]
s_waitcnt vmcnt(25) lgkmcnt(4)
global_load_dwordx4 a[156:159], v2, s[20:21] offset:3072 sc1
v_add_u32 v2, 8192, v2
v_mfma_f32_16x16x32_bf16 v[48:51], a[160:163], a[224:227], v[48:51]
s_waitcnt lgkmcnt(3)
ds_read_b128 a[208:211], v46 offset:0
ds_read_b128 v[20:23], v44 offset:18432
v_mfma_f32_16x16x32_bf16 v[52:55], a[160:163], a[228:231], v[52:55]
s_waitcnt lgkmcnt(4)
ds_read_b128 a[212:215], v46 offset:2048
v_accvgpr_read_b32 v24, a80
v_mfma_f32_16x16x32_bf16 v[56:59], a[160:163], a[232:235], v[56:59]
s_waitcnt lgkmcnt(4)
ds_read_b128 a[216:219], v46 offset:4096
v_accvgpr_read_b32 v25, a81
v_mfma_f32_16x16x32_bf16 v[60:63], a[160:163], a[236:239], v[60:63]
s_waitcnt vmcnt(25)
global_load_dwordx4 a[160:163], v2, s[20:21] offset:-4096 sc1
v_accvgpr_read_b32 v26, a82
v_mfma_f32_16x16x32_bf16 v[76:79], a[164:167], a[236:239], v[76:79]
ds_read_b128 a[220:223], v46 offset:6144
v_accvgpr_read_b32 v27, a83
v_mfma_f32_16x16x32_bf16 v[72:75], a[164:167], a[232:235], v[72:75]
v_lshlrev_b32 v28, 16, v24
v_and_b32 v29, s25, v24
v_mfma_f32_16x16x32_bf16 v[68:71], a[164:167], a[228:231], v[68:71]
v_lshlrev_b32 v30, 16, v16
v_and_b32 v31, s25, v16
v_mfma_f32_16x16x32_bf16 v[64:67], a[164:167], a[224:227], v[64:67]
s_waitcnt vmcnt(25)
global_load_dwordx4 a[164:167], v2, s[20:21] offset:-3072 sc1
v_fma_f32 v208, v28, v208, v30
v_mfma_f32_16x16x32_bf16 v[80:83], a[168:171], a[224:227], v[80:83]
v_fma_f32 v209, v29, v209, v31
v_cvt_pk_bf16_f32 v208, v208, v209
v_mfma_f32_16x16x32_bf16 v[84:87], a[168:171], a[228:231], v[84:87]
v_lshlrev_b32 v32, 16, v25
v_and_b32 v33, s25, v25
v_mfma_f32_16x16x32_bf16 v[88:91], a[168:171], a[232:235], v[88:91]
v_lshlrev_b32 v34, 16, v17
v_and_b32 v35, s25, v17
v_mfma_f32_16x16x32_bf16 v[92:95], a[168:171], a[236:239], v[92:95]
s_waitcnt vmcnt(25)
global_load_dwordx4 a[168:171], v2, s[20:21] offset:-2048 sc1
v_fma_f32 v210, v32, v210, v34
v_mfma_f32_16x16x32_bf16 v[108:111], a[172:175], a[236:239], v[108:111]
v_fma_f32 v211, v33, v211, v35
v_cvt_pk_bf16_f32 v209, v210, v211
v_mfma_f32_16x16x32_bf16 v[104:107], a[172:175], a[232:235], v[104:107]
v_lshlrev_b32 v28, 16, v26
v_and_b32 v29, s25, v26
v_mfma_f32_16x16x32_bf16 v[100:103], a[172:175], a[228:231], v[100:103]
v_lshlrev_b32 v30, 16, v18
v_and_b32 v31, s25, v18
v_mfma_f32_16x16x32_bf16 v[96:99], a[172:175], a[224:227], v[96:99]
s_waitcnt vmcnt(25)
global_load_dwordx4 a[172:175], v2, s[20:21] offset:-1024 sc1
v_fma_f32 v224, v28, v224, v30
v_mfma_f32_16x16x32_bf16 v[112:115], a[176:179], a[224:227], v[112:115]
v_fma_f32 v225, v29, v225, v31
v_cvt_pk_bf16_f32 v210, v224, v225
v_mfma_f32_16x16x32_bf16 v[116:119], a[176:179], a[228:231], v[116:119]
v_lshlrev_b32 v32, 16, v27
v_and_b32 v33, s25, v27
v_mfma_f32_16x16x32_bf16 v[120:123], a[176:179], a[232:235], v[120:123]
v_lshlrev_b32 v34, 16, v19
v_and_b32 v35, s25, v19
v_mfma_f32_16x16x32_bf16 v[124:127], a[176:179], a[236:239], v[124:127]
s_waitcnt vmcnt(25)
global_load_dwordx4 a[176:179], v2, s[20:21] offset:0 sc1
v_fma_f32 v226, v32, v226, v34
v_mfma_f32_16x16x32_bf16 v[140:143], a[180:183], a[236:239], v[140:143]
v_fma_f32 v227, v33, v227, v35
v_cvt_pk_bf16_f32 v211, v226, v227
v_mfma_f32_16x16x32_bf16 v[136:139], a[180:183], a[232:235], v[136:139]
ds_write_b128 v44, v[208:211] offset:16384
v_mfma_f32_16x16x32_bf16 v[132:135], a[180:183], a[228:231], v[132:135]
v_mfma_f32_16x16x32_bf16 v[128:131], a[180:183], a[224:227], v[128:131]
s_waitcnt vmcnt(25)
global_load_dwordx4 a[180:183], v2, s[20:21] offset:1024 sc1
v_mfma_f32_16x16x32_bf16 v[144:147], a[184:187], a[224:227], v[144:147]
v_mfma_f32_16x16x32_bf16 v[148:151], a[184:187], a[228:231], v[148:151]
v_mfma_f32_16x16x32_bf16 v[152:155], a[184:187], a[232:235], v[152:155]
v_mfma_f32_16x16x32_bf16 v[156:159], a[184:187], a[236:239], v[156:159]
s_waitcnt vmcnt(25)
global_load_dwordx4 a[184:187], v2, s[20:21] offset:2048 sc1
v_mfma_f32_16x16x32_bf16 v[172:175], a[188:191], a[236:239], v[172:175]
v_mfma_f32_16x16x32_bf16 v[168:171], a[188:191], a[232:235], v[168:171]
v_mfma_f32_16x16x32_bf16 v[164:167], a[188:191], a[228:231], v[164:167]
v_mfma_f32_16x16x32_bf16 v[160:163], a[188:191], a[224:227], v[160:163]
s_waitcnt vmcnt(25) lgkmcnt(5)
global_load_dwordx4 a[188:191], v2, s[20:21] offset:3072 sc1
v_add_u32 v2, 8192, v2
v_mfma_f32_16x16x32_bf16 v[48:51], a[192:195], a[208:211], v[48:51]
s_waitcnt lgkmcnt(3)
ds_read_b128 a[224:227], v47 offset:0
v_mfma_f32_16x16x32_bf16 v[52:55], a[192:195], a[212:215], v[52:55]
s_waitcnt lgkmcnt(3)
ds_read_b128 a[228:231], v47 offset:2048
v_mfma_f32_16x16x32_bf16 v[56:59], a[192:195], a[216:219], v[56:59]
s_waitcnt lgkmcnt(3)
ds_read_b128 a[232:235], v47 offset:4096
v_mfma_f32_16x16x32_bf16 v[60:63], a[192:195], a[220:223], v[60:63]
s_waitcnt vmcnt(25)
global_load_dwordx4 a[192:195], v2, s[20:21] offset:-4096 sc1
v_mfma_f32_16x16x32_bf16 v[76:79], a[196:199], a[220:223], v[76:79]
ds_read_b128 a[236:239], v47 offset:6144
v_mfma_f32_16x16x32_bf16 v[72:75], a[196:199], a[216:219], v[72:75]
v_mfma_f32_16x16x32_bf16 v[68:71], a[196:199], a[212:215], v[68:71]
v_mfma_f32_16x16x32_bf16 v[64:67], a[196:199], a[208:211], v[64:67]
s_waitcnt vmcnt(25)
global_load_dwordx4 a[196:199], v2, s[20:21] offset:-3072 sc1
ds_read_b128 v[16:19], v44 offset:20480
v_mfma_f32_16x16x32_bf16 v[80:83], a[200:203], a[208:211], v[80:83]
v_accvgpr_read_b32 v24, a84
v_accvgpr_read_b32 v25, a85
v_mfma_f32_16x16x32_bf16 v[84:87], a[200:203], a[212:215], v[84:87]
v_accvgpr_read_b32 v26, a86
v_accvgpr_read_b32 v27, a87
v_mfma_f32_16x16x32_bf16 v[88:91], a[200:203], a[216:219], v[88:91]
v_lshlrev_b32 v28, 16, v24
v_and_b32 v29, s25, v24
v_mfma_f32_16x16x32_bf16 v[92:95], a[200:203], a[220:223], v[92:95]
s_waitcnt vmcnt(25)
global_load_dwordx4 a[200:203], v2, s[20:21] offset:-2048 sc1
v_lshlrev_b32 v30, 16, v20
v_mfma_f32_16x16x32_bf16 v[108:111], a[204:207], a[220:223], v[108:111]
v_and_b32 v31, s25, v20
v_fma_f32 v212, v28, v212, v30
v_mfma_f32_16x16x32_bf16 v[104:107], a[204:207], a[216:219], v[104:107]
v_fma_f32 v213, v29, v213, v31
v_cvt_pk_bf16_f32 v212, v212, v213
v_mfma_f32_16x16x32_bf16 v[100:103], a[204:207], a[212:215], v[100:103]
v_lshlrev_b32 v32, 16, v25
v_and_b32 v33, s25, v25
v_mfma_f32_16x16x32_bf16 v[96:99], a[204:207], a[208:211], v[96:99]
s_waitcnt vmcnt(25)
global_load_dwordx4 a[204:207], v2, s[20:21] offset:-1024 sc1
v_lshlrev_b32 v34, 16, v21
v_mfma_f32_16x16x32_bf16 v[112:115], a[104:107], a[208:211], v[112:115]
v_and_b32 v35, s25, v21
v_fma_f32 v214, v32, v214, v34
v_mfma_f32_16x16x32_bf16 v[116:119], a[104:107], a[212:215], v[116:119]
v_fma_f32 v215, v33, v215, v35
v_cvt_pk_bf16_f32 v213, v214, v215
v_mfma_f32_16x16x32_bf16 v[120:123], a[104:107], a[216:219], v[120:123]
v_lshlrev_b32 v28, 16, v26
v_and_b32 v29, s25, v26
v_mfma_f32_16x16x32_bf16 v[124:127], a[104:107], a[220:223], v[124:127]
s_waitcnt vmcnt(25)
global_load_dwordx4 a[104:107], v2, s[20:21] offset:0 sc1
v_lshlrev_b32 v30, 16, v22
v_mfma_f32_16x16x32_bf16 v[140:143], a[108:111], a[220:223], v[140:143]
v_and_b32 v31, s25, v22
v_fma_f32 v228, v28, v228, v30
v_mfma_f32_16x16x32_bf16 v[136:139], a[108:111], a[216:219], v[136:139]
v_fma_f32 v229, v29, v229, v31
v_cvt_pk_bf16_f32 v214, v228, v229
v_mfma_f32_16x16x32_bf16 v[132:135], a[108:111], a[212:215], v[132:135]
v_lshlrev_b32 v32, 16, v27
v_and_b32 v33, s25, v27
v_mfma_f32_16x16x32_bf16 v[128:131], a[108:111], a[208:211], v[128:131]
s_waitcnt vmcnt(25)
global_load_dwordx4 a[108:111], v2, s[20:21] offset:1024 sc1
v_lshlrev_b32 v34, 16, v23
v_mfma_f32_16x16x32_bf16 v[144:147], a[112:115], a[208:211], v[144:147]
v_and_b32 v35, s25, v23
v_fma_f32 v230, v32, v230, v34
v_mfma_f32_16x16x32_bf16 v[148:151], a[112:115], a[212:215], v[148:151]
v_fma_f32 v231, v33, v231, v35
v_cvt_pk_bf16_f32 v215, v230, v231
v_mfma_f32_16x16x32_bf16 v[152:155], a[112:115], a[216:219], v[152:155]
ds_write_b128 v44, v[212:215] offset:18432
v_mfma_f32_16x16x32_bf16 v[156:159], a[112:115], a[220:223], v[156:159]
s_waitcnt vmcnt(25)
global_load_dwordx4 a[112:115], v2, s[20:21] offset:2048 sc1
v_mfma_f32_16x16x32_bf16 v[172:175], a[116:119], a[220:223], v[172:175]
v_mfma_f32_16x16x32_bf16 v[168:171], a[116:119], a[216:219], v[168:171]
v_mfma_f32_16x16x32_bf16 v[164:167], a[116:119], a[212:215], v[164:167]
v_mfma_f32_16x16x32_bf16 v[160:163], a[116:119], a[208:211], v[160:163]
s_waitcnt vmcnt(25) lgkmcnt(5)
global_load_dwordx4 a[116:119], v2, s[20:21] offset:3072 sc1
v_add_u32 v2, 8192, v2
v_mfma_f32_16x16x32_bf16 v[48:51], a[120:123], a[224:227], v[48:51]
s_waitcnt lgkmcnt(4)
ds_read_b128 a[208:211], v3 offset:8192
v_mfma_f32_16x16x32_bf16 v[52:55], a[120:123], a[228:231], v[52:55]
s_waitcnt lgkmcnt(4)
ds_read_b128 a[212:215], v3 offset:10240
v_mfma_f32_16x16x32_bf16 v[56:59], a[120:123], a[232:235], v[56:59]
s_waitcnt lgkmcnt(4)
ds_read_b128 a[216:219], v3 offset:12288
v_mfma_f32_16x16x32_bf16 v[60:63], a[120:123], a[236:239], v[60:63]
s_waitcnt vmcnt(25)
global_load_dwordx4 a[120:123], v2, s[20:21] offset:-4096 sc1
v_mfma_f32_16x16x32_bf16 v[76:79], a[124:127], a[236:239], v[76:79]
ds_read_b128 a[220:223], v3 offset:14336
v_mfma_f32_16x16x32_bf16 v[72:75], a[124:127], a[232:235], v[72:75]
v_mfma_f32_16x16x32_bf16 v[68:71], a[124:127], a[228:231], v[68:71]
v_mfma_f32_16x16x32_bf16 v[64:67], a[124:127], a[224:227], v[64:67]
s_waitcnt vmcnt(25)
global_load_dwordx4 a[124:127], v2, s[20:21] offset:-3072 sc1
v_mfma_f32_16x16x32_bf16 v[80:83], a[128:131], a[224:227], v[80:83]
v_mfma_f32_16x16x32_bf16 v[84:87], a[128:131], a[228:231], v[84:87]
v_mfma_f32_16x16x32_bf16 v[88:91], a[128:131], a[232:235], v[88:91]
v_mfma_f32_16x16x32_bf16 v[92:95], a[128:131], a[236:239], v[92:95]
s_waitcnt vmcnt(25)
global_load_dwordx4 a[128:131], v2, s[20:21] offset:-2048 sc1
v_mfma_f32_16x16x32_bf16 v[108:111], a[132:135], a[236:239], v[108:111]
v_mfma_f32_16x16x32_bf16 v[104:107], a[132:135], a[232:235], v[104:107]
v_mfma_f32_16x16x32_bf16 v[100:103], a[132:135], a[228:231], v[100:103]
v_mfma_f32_16x16x32_bf16 v[96:99], a[132:135], a[224:227], v[96:99]
s_waitcnt vmcnt(25)
global_load_dwordx4 a[132:135], v2, s[20:21] offset:-1024 sc1
ds_read_b128 v[20:23], v44 offset:22528
v_mfma_f32_16x16x32_bf16 v[112:115], a[136:139], a[224:227], v[112:115]
v_accvgpr_read_b32 v24, a88
v_accvgpr_read_b32 v25, a89
v_mfma_f32_16x16x32_bf16 v[116:119], a[136:139], a[228:231], v[116:119]
v_accvgpr_read_b32 v26, a90
v_accvgpr_read_b32 v27, a91
v_mfma_f32_16x16x32_bf16 v[120:123], a[136:139], a[232:235], v[120:123]
v_lshlrev_b32 v28, 16, v24
v_and_b32 v29, s25, v24
v_mfma_f32_16x16x32_bf16 v[124:127], a[136:139], a[236:239], v[124:127]
s_waitcnt vmcnt(25) lgkmcnt(6)
global_load_dwordx4 a[136:139], v2, s[20:21] offset:0 sc1
v_lshlrev_b32 v30, 16, v16
v_mfma_f32_16x16x32_bf16 v[140:143], a[140:143], a[236:239], v[140:143]
v_and_b32 v31, s25, v16
v_fma_f32 v216, v28, v216, v30
v_mfma_f32_16x16x32_bf16 v[136:139], a[140:143], a[232:235], v[136:139]
v_fma_f32 v217, v29, v217, v31
v_cvt_pk_bf16_f32 v216, v216, v217
v_mfma_f32_16x16x32_bf16 v[132:135], a[140:143], a[228:231], v[132:135]
v_lshlrev_b32 v32, 16, v25
v_and_b32 v33, s25, v25
v_mfma_f32_16x16x32_bf16 v[128:131], a[140:143], a[224:227], v[128:131]
s_waitcnt vmcnt(25)
global_load_dwordx4 a[140:143], v2, s[20:21] offset:1024 sc1
v_lshlrev_b32 v34, 16, v17
v_mfma_f32_16x16x32_bf16 v[144:147], a[144:147], a[224:227], v[144:147]
v_and_b32 v35, s25, v17
v_fma_f32 v218, v32, v218, v34
v_mfma_f32_16x16x32_bf16 v[148:151], a[144:147], a[228:231], v[148:151]
v_fma_f32 v219, v33, v219, v35
v_cvt_pk_bf16_f32 v217, v218, v219
v_mfma_f32_16x16x32_bf16 v[152:155], a[144:147], a[232:235], v[152:155]
v_lshlrev_b32 v28, 16, v26
v_and_b32 v29, s25, v26
v_mfma_f32_16x16x32_bf16 v[156:159], a[144:147], a[236:239], v[156:159]
s_waitcnt vmcnt(24)
global_load_dwordx4 a[144:147], v2, s[20:21] offset:2048 sc1
v_lshlrev_b32 v30, 16, v18
v_mfma_f32_16x16x32_bf16 v[172:175], a[148:151], a[236:239], v[172:175]
v_and_b32 v31, s25, v18
v_fma_f32 v232, v28, v232, v30
v_mfma_f32_16x16x32_bf16 v[168:171], a[148:151], a[232:235], v[168:171]
v_fma_f32 v233, v29, v233, v31
v_cvt_pk_bf16_f32 v218, v232, v233
v_mfma_f32_16x16x32_bf16 v[164:167], a[148:151], a[228:231], v[164:167]
v_lshlrev_b32 v32, 16, v27
v_and_b32 v33, s25, v27
v_mfma_f32_16x16x32_bf16 v[160:163], a[148:151], a[224:227], v[160:163]
s_waitcnt vmcnt(24) lgkmcnt(4)
global_load_dwordx4 a[148:151], v2, s[20:21] offset:3072 sc1
v_add_u32 v2, 8192, v2
v_mfma_f32_16x16x32_bf16 v[48:51], a[152:155], a[208:211], v[48:51]
s_waitcnt lgkmcnt(3)
ds_read_b128 a[224:227], v4 offset:8192
v_lshlrev_b32 v34, 16, v19
v_mfma_f32_16x16x32_bf16 v[52:55], a[152:155], a[212:215], v[52:55]
s_waitcnt lgkmcnt(3)
ds_read_b128 a[228:231], v4 offset:10240
v_and_b32 v35, s25, v19
v_mfma_f32_16x16x32_bf16 v[56:59], a[152:155], a[216:219], v[56:59]
s_waitcnt lgkmcnt(3)
ds_read_b128 a[232:235], v4 offset:12288
v_fma_f32 v234, v32, v234, v34
v_mfma_f32_16x16x32_bf16 v[60:63], a[152:155], a[220:223], v[60:63]
s_waitcnt vmcnt(24)
global_load_dwordx4 a[152:155], v2, s[20:21] offset:-4096 sc1
v_fma_f32 v235, v33, v235, v35
v_mfma_f32_16x16x32_bf16 v[76:79], a[156:159], a[220:223], v[76:79]
ds_read_b128 a[236:239], v4 offset:14336
v_cvt_pk_bf16_f32 v219, v234, v235
v_mfma_f32_16x16x32_bf16 v[72:75], a[156:159], a[216:219], v[72:75]
ds_write_b128 v44, v[216:219] offset:20480
v_mfma_f32_16x16x32_bf16 v[68:71], a[156:159], a[212:215], v[68:71]
v_mfma_f32_16x16x32_bf16 v[64:67], a[156:159], a[208:211], v[64:67]
s_waitcnt vmcnt(24)
global_load_dwordx4 a[156:159], v2, s[20:21] offset:-3072 sc1
v_mfma_f32_16x16x32_bf16 v[80:83], a[160:163], a[208:211], v[80:83]
v_mfma_f32_16x16x32_bf16 v[84:87], a[160:163], a[212:215], v[84:87]
v_mfma_f32_16x16x32_bf16 v[88:91], a[160:163], a[216:219], v[88:91]
v_mfma_f32_16x16x32_bf16 v[92:95], a[160:163], a[220:223], v[92:95]
s_waitcnt vmcnt(24)
global_load_dwordx4 a[160:163], v2, s[20:21] offset:-2048 sc1
v_mfma_f32_16x16x32_bf16 v[108:111], a[164:167], a[220:223], v[108:111]
v_mfma_f32_16x16x32_bf16 v[104:107], a[164:167], a[216:219], v[104:107]
v_mfma_f32_16x16x32_bf16 v[100:103], a[164:167], a[212:215], v[100:103]
v_mfma_f32_16x16x32_bf16 v[96:99], a[164:167], a[208:211], v[96:99]
s_waitcnt vmcnt(24)
global_load_dwordx4 a[164:167], v2, s[20:21] offset:-1024 sc1
v_mfma_f32_16x16x32_bf16 v[112:115], a[168:171], a[208:211], v[112:115]
v_mfma_f32_16x16x32_bf16 v[116:119], a[168:171], a[212:215], v[116:119]
v_mfma_f32_16x16x32_bf16 v[120:123], a[168:171], a[216:219], v[120:123]
v_mfma_f32_16x16x32_bf16 v[124:127], a[168:171], a[220:223], v[124:127]
s_waitcnt vmcnt(24)
global_load_dwordx4 a[168:171], v2, s[20:21] offset:0 sc1
v_mfma_f32_16x16x32_bf16 v[140:143], a[172:175], a[220:223], v[140:143]
v_mfma_f32_16x16x32_bf16 v[136:139], a[172:175], a[216:219], v[136:139]
v_mfma_f32_16x16x32_bf16 v[132:135], a[172:175], a[212:215], v[132:135]
v_mfma_f32_16x16x32_bf16 v[128:131], a[172:175], a[208:211], v[128:131]
s_waitcnt vmcnt(24)
global_load_dwordx4 a[172:175], v2, s[20:21] offset:1024 sc1
ds_read_b64 v[16:17], v8 offset:0
v_mfma_f32_16x16x32_bf16 v[144:147], a[176:179], a[208:211], v[144:147]
v_accvgpr_read_b32 v24, a92
v_accvgpr_read_b32 v25, a93
v_mfma_f32_16x16x32_bf16 v[148:151], a[176:179], a[212:215], v[148:151]
v_accvgpr_read_b32 v26, a94
v_accvgpr_read_b32 v27, a95
v_mfma_f32_16x16x32_bf16 v[152:155], a[176:179], a[216:219], v[152:155]
v_lshlrev_b32 v28, 16, v24
v_and_b32 v29, s25, v24
v_mfma_f32_16x16x32_bf16 v[156:159], a[176:179], a[220:223], v[156:159]
s_waitcnt vmcnt(24) lgkmcnt(6)
global_load_dwordx4 a[176:179], v2, s[20:21] offset:2048 sc1
v_lshlrev_b32 v30, 16, v20
v_mfma_f32_16x16x32_bf16 v[172:175], a[180:183], a[220:223], v[172:175]
v_and_b32 v31, s25, v20
v_fma_f32 v220, v28, v220, v30
v_mfma_f32_16x16x32_bf16 v[168:171], a[180:183], a[216:219], v[168:171]
v_fma_f32 v221, v29, v221, v31
v_cvt_pk_bf16_f32 v220, v220, v221
v_mfma_f32_16x16x32_bf16 v[164:167], a[180:183], a[212:215], v[164:167]
v_lshlrev_b32 v32, 16, v25
v_and_b32 v33, s25, v25
v_mfma_f32_16x16x32_bf16 v[160:163], a[180:183], a[208:211], v[160:163]
s_waitcnt vmcnt(24) lgkmcnt(5)
global_load_dwordx4 a[180:183], v2, s[20:21] offset:3072 sc1
v_add_u32 v2, 8192, v2
v_mfma_f32_16x16x32_bf16 v[48:51], a[184:187], a[224:227], v[48:51]
s_waitcnt lgkmcnt(4)
ds_read_b128 a[208:211], v5 offset:8192
v_lshlrev_b32 v34, 16, v21
v_mfma_f32_16x16x32_bf16 v[52:55], a[184:187], a[228:231], v[52:55]
s_waitcnt lgkmcnt(4)
ds_read_b128 a[212:215], v5 offset:10240
v_and_b32 v35, s25, v21
v_mfma_f32_16x16x32_bf16 v[56:59], a[184:187], a[232:235], v[56:59]
s_waitcnt lgkmcnt(4)
ds_read_b128 a[216:219], v5 offset:12288
v_fma_f32 v222, v32, v222, v34
v_mfma_f32_16x16x32_bf16 v[60:63], a[184:187], a[236:239], v[60:63]
s_waitcnt vmcnt(24)
global_load_dwordx4 a[184:187], v2, s[20:21] offset:-4096 sc1
v_fma_f32 v223, v33, v223, v35
v_mfma_f32_16x16x32_bf16 v[76:79], a[188:191], a[236:239], v[76:79]
ds_read_b128 a[220:223], v5 offset:14336
v_cvt_pk_bf16_f32 v221, v222, v223
v_mfma_f32_16x16x32_bf16 v[72:75], a[188:191], a[232:235], v[72:75]
v_lshlrev_b32 v28, 16, v26
v_and_b32 v29, s25, v26
v_mfma_f32_16x16x32_bf16 v[68:71], a[188:191], a[228:231], v[68:71]
v_lshlrev_b32 v30, 16, v22
v_and_b32 v31, s25, v22
v_mfma_f32_16x16x32_bf16 v[64:67], a[188:191], a[224:227], v[64:67]
s_waitcnt vmcnt(24)
global_load_dwordx4 a[188:191], v2, s[20:21] offset:-3072 sc1
v_fma_f32 v236, v28, v236, v30
v_mfma_f32_16x16x32_bf16 v[80:83], a[192:195], a[224:227], v[80:83]
v_fma_f32 v237, v29, v237, v31
v_cvt_pk_bf16_f32 v222, v236, v237
v_mfma_f32_16x16x32_bf16 v[84:87], a[192:195], a[228:231], v[84:87]
v_lshlrev_b32 v32, 16, v27
v_and_b32 v33, s25, v27
v_mfma_f32_16x16x32_bf16 v[88:91], a[192:195], a[232:235], v[88:91]
v_lshlrev_b32 v34, 16, v23
v_and_b32 v35, s25, v23
v_mfma_f32_16x16x32_bf16 v[92:95], a[192:195], a[236:239], v[92:95]
s_waitcnt vmcnt(24)
global_load_dwordx4 a[192:195], v2, s[20:21] offset:-2048 sc1
v_fma_f32 v238, v32, v238, v34
v_mfma_f32_16x16x32_bf16 v[108:111], a[196:199], a[236:239], v[108:111]
v_fma_f32 v239, v33, v239, v35
v_cvt_pk_bf16_f32 v223, v238, v239
v_mfma_f32_16x16x32_bf16 v[104:107], a[196:199], a[232:235], v[104:107]
ds_write_b128 v44, v[220:223] offset:22528
v_mfma_f32_16x16x32_bf16 v[100:103], a[196:199], a[228:231], v[100:103]
v_mfma_f32_16x16x32_bf16 v[96:99], a[196:199], a[224:227], v[96:99]
s_waitcnt vmcnt(24)
global_load_dwordx4 a[196:199], v2, s[20:21] offset:-1024 sc1
v_mfma_f32_16x16x32_bf16 v[112:115], a[200:203], a[224:227], v[112:115]
v_mfma_f32_16x16x32_bf16 v[116:119], a[200:203], a[228:231], v[116:119]
v_mfma_f32_16x16x32_bf16 v[120:123], a[200:203], a[232:235], v[120:123]
v_mfma_f32_16x16x32_bf16 v[124:127], a[200:203], a[236:239], v[124:127]
s_waitcnt vmcnt(24)
global_load_dwordx4 a[200:203], v2, s[20:21] offset:0 sc1
v_mfma_f32_16x16x32_bf16 v[140:143], a[204:207], a[236:239], v[140:143]
v_mfma_f32_16x16x32_bf16 v[136:139], a[204:207], a[232:235], v[136:139]
v_mfma_f32_16x16x32_bf16 v[132:135], a[204:207], a[228:231], v[132:135]
v_mfma_f32_16x16x32_bf16 v[128:131], a[204:207], a[224:227], v[128:131]
s_waitcnt vmcnt(24)
global_load_dwordx4 a[204:207], v2, s[20:21] offset:1024 sc1
v_mfma_f32_16x16x32_bf16 v[144:147], a[104:107], a[224:227], v[144:147]
v_mfma_f32_16x16x32_bf16 v[148:151], a[104:107], a[228:231], v[148:151]
v_mfma_f32_16x16x32_bf16 v[152:155], a[104:107], a[232:235], v[152:155]
v_mfma_f32_16x16x32_bf16 v[156:159], a[104:107], a[236:239], v[156:159]
s_waitcnt vmcnt(24)
global_load_dwordx4 a[104:107], v2, s[20:21] offset:2048 sc1
v_mfma_f32_16x16x32_bf16 v[172:175], a[108:111], a[236:239], v[172:175]
v_mfma_f32_16x16x32_bf16 v[168:171], a[108:111], a[232:235], v[168:171]
v_mfma_f32_16x16x32_bf16 v[164:167], a[108:111], a[228:231], v[164:167]
v_mfma_f32_16x16x32_bf16 v[160:163], a[108:111], a[224:227], v[160:163]
s_waitcnt vmcnt(24) lgkmcnt(4)
global_load_dwordx4 a[108:111], v2, s[20:21] offset:3072 sc1
v_add_u32 v2, 8192, v2
v_mfma_f32_16x16x32_bf16 v[48:51], a[112:115], a[208:211], v[48:51]
s_waitcnt lgkmcnt(3)
ds_read_b128 a[224:227], v6 offset:8192
ds_read_b64 v[20:21], v8 offset:2048
v_mfma_f32_16x16x32_bf16 v[52:55], a[112:115], a[212:215], v[52:55]
s_waitcnt lgkmcnt(4)
ds_read_b128 a[228:231], v6 offset:10240
v_accvgpr_read_b32 v24, a96
v_mfma_f32_16x16x32_bf16 v[56:59], a[112:115], a[216:219], v[56:59]
s_waitcnt lgkmcnt(4)
ds_read_b128 a[232:235], v6 offset:12288
v_accvgpr_read_b32 v25, a97
v_mfma_f32_16x16x32_bf16 v[60:63], a[112:115], a[220:223], v[60:63]
s_waitcnt vmcnt(24)
global_load_dwordx4 a[112:115], v2, s[20:21] offset:-4096 sc1
v_lshlrev_b32 v28, 16, v24
v_mfma_f32_16x16x32_bf16 v[76:79], a[116:119], a[220:223], v[76:79]
ds_read_b128 a[236:239], v6 offset:14336
v_and_b32 v29, s25, v24
v_mfma_f32_16x16x32_bf16 v[72:75], a[116:119], a[216:219], v[72:75]
v_lshlrev_b32 v30, 16, v16
v_and_b32 v31, s25, v16
v_mfma_f32_16x16x32_bf16 v[68:71], a[116:119], a[212:215], v[68:71]
v_fma_f32 v240, v28, v240, v30
v_fma_f32 v241, v29, v241, v31
v_mfma_f32_16x16x32_bf16 v[64:67], a[116:119], a[208:211], v[64:67]
s_waitcnt vmcnt(24)
global_load_dwordx4 a[116:119], v2, s[20:21] offset:-3072 sc1
v_cvt_pk_bf16_f32 v240, v240, v241
v_mfma_f32_16x16x32_bf16 v[80:83], a[120:123], a[208:211], v[80:83]
v_lshlrev_b32 v32, 16, v25
v_and_b32 v33, s25, v25
v_mfma_f32_16x16x32_bf16 v[84:87], a[120:123], a[212:215], v[84:87]
v_lshlrev_b32 v34, 16, v17
v_and_b32 v35, s25, v17
v_mfma_f32_16x16x32_bf16 v[88:91], a[120:123], a[216:219], v[88:91]
v_fma_f32 v242, v32, v242, v34
v_fma_f32 v243, v33, v243, v35
v_mfma_f32_16x16x32_bf16 v[92:95], a[120:123], a[220:223], v[92:95]
s_waitcnt vmcnt(24)
global_load_dwordx4 a[120:123], v2, s[20:21] offset:-2048 sc1
v_cvt_pk_bf16_f32 v241, v242, v243
v_mfma_f32_16x16x32_bf16 v[108:111], a[124:127], a[220:223], v[108:111]
ds_write_b64 v8, v[240:241] offset:0
v_mfma_f32_16x16x32_bf16 v[104:107], a[124:127], a[216:219], v[104:107]
v_mfma_f32_16x16x32_bf16 v[100:103], a[124:127], a[212:215], v[100:103]
v_mfma_f32_16x16x32_bf16 v[96:99], a[124:127], a[208:211], v[96:99]
s_waitcnt vmcnt(24)
global_load_dwordx4 a[124:127], v2, s[20:21] offset:-1024 sc1
v_mfma_f32_16x16x32_bf16 v[112:115], a[128:131], a[208:211], v[112:115]
v_mfma_f32_16x16x32_bf16 v[116:119], a[128:131], a[212:215], v[116:119]
v_mfma_f32_16x16x32_bf16 v[120:123], a[128:131], a[216:219], v[120:123]
v_mfma_f32_16x16x32_bf16 v[124:127], a[128:131], a[220:223], v[124:127]
s_waitcnt vmcnt(24)
global_load_dwordx4 a[128:131], v2, s[20:21] offset:0 sc1
v_mfma_f32_16x16x32_bf16 v[140:143], a[132:135], a[220:223], v[140:143]
v_mfma_f32_16x16x32_bf16 v[136:139], a[132:135], a[216:219], v[136:139]
v_mfma_f32_16x16x32_bf16 v[132:135], a[132:135], a[212:215], v[132:135]
v_mfma_f32_16x16x32_bf16 v[128:131], a[132:135], a[208:211], v[128:131]
s_waitcnt vmcnt(24)
global_load_dwordx4 a[132:135], v2, s[20:21] offset:1024 sc1
v_mfma_f32_16x16x32_bf16 v[144:147], a[136:139], a[208:211], v[144:147]
v_mfma_f32_16x16x32_bf16 v[148:151], a[136:139], a[212:215], v[148:151]
v_mfma_f32_16x16x32_bf16 v[152:155], a[136:139], a[216:219], v[152:155]
v_mfma_f32_16x16x32_bf16 v[156:159], a[136:139], a[220:223], v[156:159]
s_waitcnt vmcnt(24)
global_load_dwordx4 a[136:139], v2, s[20:21] offset:2048 sc1
v_mfma_f32_16x16x32_bf16 v[172:175], a[140:143], a[220:223], v[172:175]
v_mfma_f32_16x16x32_bf16 v[168:171], a[140:143], a[216:219], v[168:171]
v_mfma_f32_16x16x32_bf16 v[164:167], a[140:143], a[212:215], v[164:167]
v_mfma_f32_16x16x32_bf16 v[160:163], a[140:143], a[208:211], v[160:163]
s_waitcnt vmcnt(24) lgkmcnt(5)
global_load_dwordx4 a[140:143], v2, s[20:21] offset:3072 sc1
v_add_u32 v2, 8192, v2
v_mfma_f32_16x16x32_bf16 v[48:51], a[144:147], a[224:227], v[48:51]
s_waitcnt lgkmcnt(3)
ds_read_b128 a[208:211], v44 offset:8192
v_mfma_f32_16x16x32_bf16 v[52:55], a[144:147], a[228:231], v[52:55]
s_waitcnt lgkmcnt(3)
ds_read_b128 a[212:215], v44 offset:10240
v_mfma_f32_16x16x32_bf16 v[56:59], a[144:147], a[232:235], v[56:59]
s_waitcnt lgkmcnt(3)
ds_read_b128 a[216:219], v44 offset:12288
v_mfma_f32_16x16x32_bf16 v[60:63], a[144:147], a[236:239], v[60:63]
s_waitcnt vmcnt(24)
global_load_dwordx4 a[144:147], v2, s[20:21] offset:-4096 sc1
v_mfma_f32_16x16x32_bf16 v[76:79], a[148:151], a[236:239], v[76:79]
ds_read_b128 a[220:223], v44 offset:14336
v_mfma_f32_16x16x32_bf16 v[72:75], a[148:151], a[232:235], v[72:75]
v_mfma_f32_16x16x32_bf16 v[68:71], a[148:151], a[228:231], v[68:71]
v_mfma_f32_16x16x32_bf16 v[64:67], a[148:151], a[224:227], v[64:67]
s_waitcnt vmcnt(24)
global_load_dwordx4 a[148:151], v2, s[20:21] offset:-3072 sc1
ds_read_b64 v[16:17], v8 offset:4096
v_mfma_f32_16x16x32_bf16 v[80:83], a[152:155], a[224:227], v[80:83]
v_accvgpr_read_b32 v24, a98
v_accvgpr_read_b32 v25, a99
v_mfma_f32_16x16x32_bf16 v[84:87], a[152:155], a[228:231], v[84:87]
v_lshlrev_b32 v28, 16, v24
v_and_b32 v29, s25, v24
v_mfma_f32_16x16x32_bf16 v[88:91], a[152:155], a[232:235], v[88:91]
v_lshlrev_b32 v30, 16, v20
v_and_b32 v31, s25, v20
v_mfma_f32_16x16x32_bf16 v[92:95], a[152:155], a[236:239], v[92:95]
s_waitcnt vmcnt(24)
global_load_dwordx4 a[152:155], v2, s[20:21] offset:-2048 sc1
v_fma_f32 v244, v28, v244, v30
v_mfma_f32_16x16x32_bf16 v[108:111], a[156:159], a[236:239], v[108:111]
v_fma_f32 v245, v29, v245, v31
v_cvt_pk_bf16_f32 v244, v244, v245
v_mfma_f32_16x16x32_bf16 v[104:107], a[156:159], a[232:235], v[104:107]
v_lshlrev_b32 v32, 16, v25
v_and_b32 v33, s25, v25
v_mfma_f32_16x16x32_bf16 v[100:103], a[156:159], a[228:231], v[100:103]
v_lshlrev_b32 v34, 16, v21
v_and_b32 v35, s25, v21
v_mfma_f32_16x16x32_bf16 v[96:99], a[156:159], a[224:227], v[96:99]
s_waitcnt vmcnt(24)
global_load_dwordx4 a[156:159], v2, s[20:21] offset:-1024 sc1
v_fma_f32 v246, v32, v246, v34
v_mfma_f32_16x16x32_bf16 v[112:115], a[160:163], a[224:227], v[112:115]
v_fma_f32 v247, v33, v247, v35
v_cvt_pk_bf16_f32 v245, v246, v247
v_mfma_f32_16x16x32_bf16 v[116:119], a[160:163], a[228:231], v[116:119]
ds_write_b64 v8, v[244:245] offset:2048
v_mfma_f32_16x16x32_bf16 v[120:123], a[160:163], a[232:235], v[120:123]
v_mfma_f32_16x16x32_bf16 v[124:127], a[160:163], a[236:239], v[124:127]
s_waitcnt vmcnt(24)
global_load_dwordx4 a[160:163], v2, s[20:21] offset:0 sc1
v_mfma_f32_16x16x32_bf16 v[140:143], a[164:167], a[236:239], v[140:143]
v_mfma_f32_16x16x32_bf16 v[136:139], a[164:167], a[232:235], v[136:139]
v_mfma_f32_16x16x32_bf16 v[132:135], a[164:167], a[228:231], v[132:135]
v_mfma_f32_16x16x32_bf16 v[128:131], a[164:167], a[224:227], v[128:131]
s_waitcnt vmcnt(24)
global_load_dwordx4 a[164:167], v2, s[20:21] offset:1024 sc1
v_mfma_f32_16x16x32_bf16 v[144:147], a[168:171], a[224:227], v[144:147]
v_mfma_f32_16x16x32_bf16 v[148:151], a[168:171], a[228:231], v[148:151]
v_mfma_f32_16x16x32_bf16 v[152:155], a[168:171], a[232:235], v[152:155]
v_mfma_f32_16x16x32_bf16 v[156:159], a[168:171], a[236:239], v[156:159]
s_waitcnt vmcnt(24)
global_load_dwordx4 a[168:171], v2, s[20:21] offset:2048 sc1
v_mfma_f32_16x16x32_bf16 v[172:175], a[172:175], a[236:239], v[172:175]
v_mfma_f32_16x16x32_bf16 v[168:171], a[172:175], a[232:235], v[168:171]
v_mfma_f32_16x16x32_bf16 v[164:167], a[172:175], a[228:231], v[164:167]
v_mfma_f32_16x16x32_bf16 v[160:163], a[172:175], a[224:227], v[160:163]
s_waitcnt vmcnt(24) lgkmcnt(5)
global_load_dwordx4 a[172:175], v2, s[20:21] offset:3072 sc1
v_add_u32 v2, 8192, v2
v_mfma_f32_16x16x32_bf16 v[48:51], a[176:179], a[208:211], v[48:51]
s_waitcnt lgkmcnt(4)
ds_read_b128 a[224:227], v45 offset:8192
v_mfma_f32_16x16x32_bf16 v[52:55], a[176:179], a[212:215], v[52:55]
s_waitcnt lgkmcnt(4)
ds_read_b128 a[228:231], v45 offset:10240
v_mfma_f32_16x16x32_bf16 v[56:59], a[176:179], a[216:219], v[56:59]
s_waitcnt lgkmcnt(4)
ds_read_b128 a[232:235], v45 offset:12288
v_mfma_f32_16x16x32_bf16 v[60:63], a[176:179], a[220:223], v[60:63]
s_waitcnt vmcnt(24)
global_load_dwordx4 a[176:179], v2, s[20:21] offset:-4096 sc1
v_mfma_f32_16x16x32_bf16 v[76:79], a[180:183], a[220:223], v[76:79]
ds_read_b128 a[236:239], v45 offset:14336
v_mfma_f32_16x16x32_bf16 v[72:75], a[180:183], a[216:219], v[72:75]
v_mfma_f32_16x16x32_bf16 v[68:71], a[180:183], a[212:215], v[68:71]
v_mfma_f32_16x16x32_bf16 v[64:67], a[180:183], a[208:211], v[64:67]
s_waitcnt vmcnt(24)
global_load_dwordx4 a[180:183], v2, s[20:21] offset:-3072 sc1
v_mfma_f32_16x16x32_bf16 v[80:83], a[184:187], a[208:211], v[80:83]
v_mfma_f32_16x16x32_bf16 v[84:87], a[184:187], a[212:215], v[84:87]
v_mfma_f32_16x16x32_bf16 v[88:91], a[184:187], a[216:219], v[88:91]
v_mfma_f32_16x16x32_bf16 v[92:95], a[184:187], a[220:223], v[92:95]
s_waitcnt vmcnt(24)
global_load_dwordx4 a[184:187], v2, s[20:21] offset:-2048 sc1
v_mfma_f32_16x16x32_bf16 v[108:111], a[188:191], a[220:223], v[108:111]
v_mfma_f32_16x16x32_bf16 v[104:107], a[188:191], a[216:219], v[104:107]
v_mfma_f32_16x16x32_bf16 v[100:103], a[188:191], a[212:215], v[100:103]
v_mfma_f32_16x16x32_bf16 v[96:99], a[188:191], a[208:211], v[96:99]
s_waitcnt vmcnt(24)
global_load_dwordx4 a[188:191], v2, s[20:21] offset:-1024 sc1
ds_read_b64 v[20:21], v8 offset:6144
v_mfma_f32_16x16x32_bf16 v[112:115], a[192:195], a[208:211], v[112:115]
v_accvgpr_read_b32 v24, a100
v_accvgpr_read_b32 v25, a101
v_mfma_f32_16x16x32_bf16 v[116:119], a[192:195], a[212:215], v[116:119]
v_lshlrev_b32 v28, 16, v24
v_and_b32 v29, s25, v24
v_mfma_f32_16x16x32_bf16 v[120:123], a[192:195], a[216:219], v[120:123]
s_waitcnt lgkmcnt(6)
v_lshlrev_b32 v30, 16, v16
v_and_b32 v31, s25, v16
v_mfma_f32_16x16x32_bf16 v[124:127], a[192:195], a[220:223], v[124:127]
s_waitcnt vmcnt(24)
global_load_dwordx4 a[192:195], v2, s[20:21] offset:0 sc1
v_fma_f32 v248, v28, v248, v30
v_mfma_f32_16x16x32_bf16 v[140:143], a[196:199], a[220:223], v[140:143]
v_fma_f32 v249, v29, v249, v31
v_cvt_pk_bf16_f32 v248, v248, v249
v_mfma_f32_16x16x32_bf16 v[136:139], a[196:199], a[216:219], v[136:139]
v_lshlrev_b32 v32, 16, v25
v_and_b32 v33, s25, v25
v_mfma_f32_16x16x32_bf16 v[132:135], a[196:199], a[212:215], v[132:135]
v_lshlrev_b32 v34, 16, v17
v_and_b32 v35, s25, v17
v_mfma_f32_16x16x32_bf16 v[128:131], a[196:199], a[208:211], v[128:131]
s_waitcnt vmcnt(24)
global_load_dwordx4 a[196:199], v2, s[20:21] offset:1024 sc1
v_fma_f32 v250, v32, v250, v34
v_mfma_f32_16x16x32_bf16 v[144:147], a[200:203], a[208:211], v[144:147]
v_fma_f32 v251, v33, v251, v35
v_cvt_pk_bf16_f32 v249, v250, v251
v_mfma_f32_16x16x32_bf16 v[148:151], a[200:203], a[212:215], v[148:151]
ds_write_b64 v8, v[248:249] offset:4096
v_mfma_f32_16x16x32_bf16 v[152:155], a[200:203], a[216:219], v[152:155]
v_mfma_f32_16x16x32_bf16 v[156:159], a[200:203], a[220:223], v[156:159]
s_waitcnt vmcnt(24)
global_load_dwordx4 a[200:203], v2, s[20:21] offset:2048 sc1
v_mfma_f32_16x16x32_bf16 v[172:175], a[204:207], a[220:223], v[172:175]
v_mfma_f32_16x16x32_bf16 v[168:171], a[204:207], a[216:219], v[168:171]
v_mfma_f32_16x16x32_bf16 v[164:167], a[204:207], a[212:215], v[164:167]
v_mfma_f32_16x16x32_bf16 v[160:163], a[204:207], a[208:211], v[160:163]
s_waitcnt vmcnt(24) lgkmcnt(5)
global_load_dwordx4 a[204:207], v2, s[20:21] offset:3072 sc1
v_add_u32 v2, 8192, v2
v_mfma_f32_16x16x32_bf16 v[48:51], a[104:107], a[224:227], v[48:51]
s_waitcnt lgkmcnt(4)
ds_read_b128 a[208:211], v46 offset:8192
v_mfma_f32_16x16x32_bf16 v[52:55], a[104:107], a[228:231], v[52:55]
s_waitcnt lgkmcnt(4)
ds_read_b128 a[212:215], v46 offset:10240
v_mfma_f32_16x16x32_bf16 v[56:59], a[104:107], a[232:235], v[56:59]
s_waitcnt lgkmcnt(4)
ds_read_b128 a[216:219], v46 offset:12288
v_mfma_f32_16x16x32_bf16 v[60:63], a[104:107], a[236:239], v[60:63]
s_waitcnt vmcnt(24)
global_load_dwordx4 a[104:107], v2, s[20:21] offset:-4096 sc1
v_mfma_f32_16x16x32_bf16 v[76:79], a[108:111], a[236:239], v[76:79]
ds_read_b128 a[220:223], v46 offset:14336
v_mfma_f32_16x16x32_bf16 v[72:75], a[108:111], a[232:235], v[72:75]
v_mfma_f32_16x16x32_bf16 v[68:71], a[108:111], a[228:231], v[68:71]
v_mfma_f32_16x16x32_bf16 v[64:67], a[108:111], a[224:227], v[64:67]
s_waitcnt vmcnt(24)
global_load_dwordx4 a[108:111], v2, s[20:21] offset:-3072 sc1
v_mfma_f32_16x16x32_bf16 v[80:83], a[112:115], a[224:227], v[80:83]
v_mfma_f32_16x16x32_bf16 v[84:87], a[112:115], a[228:231], v[84:87]
v_mfma_f32_16x16x32_bf16 v[88:91], a[112:115], a[232:235], v[88:91]
v_mfma_f32_16x16x32_bf16 v[92:95], a[112:115], a[236:239], v[92:95]
s_waitcnt vmcnt(24)
global_load_dwordx4 a[112:115], v2, s[20:21] offset:-2048 sc1
v_mfma_f32_16x16x32_bf16 v[108:111], a[116:119], a[236:239], v[108:111]
v_mfma_f32_16x16x32_bf16 v[104:107], a[116:119], a[232:235], v[104:107]
v_mfma_f32_16x16x32_bf16 v[100:103], a[116:119], a[228:231], v[100:103]
v_mfma_f32_16x16x32_bf16 v[96:99], a[116:119], a[224:227], v[96:99]
s_waitcnt vmcnt(24)
global_load_dwordx4 a[116:119], v2, s[20:21] offset:-1024 sc1
v_mfma_f32_16x16x32_bf16 v[112:115], a[120:123], a[224:227], v[112:115]
v_mfma_f32_16x16x32_bf16 v[116:119], a[120:123], a[228:231], v[116:119]
v_mfma_f32_16x16x32_bf16 v[120:123], a[120:123], a[232:235], v[120:123]
v_mfma_f32_16x16x32_bf16 v[124:127], a[120:123], a[236:239], v[124:127]
s_waitcnt vmcnt(24)
global_load_dwordx4 a[120:123], v2, s[20:21] offset:0 sc1
v_mfma_f32_16x16x32_bf16 v[140:143], a[124:127], a[236:239], v[140:143]
v_mfma_f32_16x16x32_bf16 v[136:139], a[124:127], a[232:235], v[136:139]
v_mfma_f32_16x16x32_bf16 v[132:135], a[124:127], a[228:231], v[132:135]
v_mfma_f32_16x16x32_bf16 v[128:131], a[124:127], a[224:227], v[128:131]
s_waitcnt vmcnt(24)
global_load_dwordx4 a[124:127], v2, s[20:21] offset:1024 sc1
v_accvgpr_read_b32 v24, a102
v_mfma_f32_16x16x32_bf16 v[144:147], a[128:131], a[224:227], v[144:147]
v_accvgpr_read_b32 v25, a103
v_lshlrev_b32 v28, 16, v24
v_mfma_f32_16x16x32_bf16 v[148:151], a[128:131], a[228:231], v[148:151]
s_waitcnt lgkmcnt(5)
v_and_b32 v29, s25, v24
v_lshlrev_b32 v30, 16, v20
v_mfma_f32_16x16x32_bf16 v[152:155], a[128:131], a[232:235], v[152:155]
v_and_b32 v31, s25, v20
v_fma_f32 v252, v28, v252, v30
v_mfma_f32_16x16x32_bf16 v[156:159], a[128:131], a[236:239], v[156:159]
s_waitcnt vmcnt(24)
global_load_dwordx4 a[128:131], v2, s[20:21] offset:2048 sc1
v_fma_f32 v253, v29, v253, v31
v_mfma_f32_16x16x32_bf16 v[172:175], a[132:135], a[236:239], v[172:175]
v_cvt_pk_bf16_f32 v252, v252, v253
v_lshlrev_b32 v32, 16, v25
v_mfma_f32_16x16x32_bf16 v[168:171], a[132:135], a[232:235], v[168:171]
v_and_b32 v33, s25, v25
v_lshlrev_b32 v34, 16, v21
v_mfma_f32_16x16x32_bf16 v[164:167], a[132:135], a[228:231], v[164:167]
v_and_b32 v35, s25, v21
v_fma_f32 v254, v32, v254, v34
v_mfma_f32_16x16x32_bf16 v[160:163], a[132:135], a[224:227], v[160:163]
s_waitcnt vmcnt(24) lgkmcnt(3)
global_load_dwordx4 a[132:135], v2, s[20:21] offset:3072 sc1
v_add_u32 v2, 8192, v2
v_mfma_f32_16x16x32_bf16 v[48:51], a[136:139], a[208:211], v[48:51]
s_waitcnt lgkmcnt(2)
ds_read_b128 a[224:227], v47 offset:8192
v_fma_f32 v255, v33, v255, v35
v_mfma_f32_16x16x32_bf16 v[52:55], a[136:139], a[212:215], v[52:55]
s_waitcnt lgkmcnt(2)
ds_read_b128 a[228:231], v47 offset:10240
v_cvt_pk_bf16_f32 v253, v254, v255
v_mfma_f32_16x16x32_bf16 v[56:59], a[136:139], a[216:219], v[56:59]
s_waitcnt lgkmcnt(2)
ds_read_b128 a[232:235], v47 offset:12288
v_mfma_f32_16x16x32_bf16 v[60:63], a[136:139], a[220:223], v[60:63]
s_waitcnt vmcnt(24)
global_load_dwordx4 a[136:139], v2, s[20:21] offset:-4096 sc1
v_mfma_f32_16x16x32_bf16 v[76:79], a[140:143], a[220:223], v[76:79]
ds_read_b128 a[236:239], v47 offset:14336
v_mfma_f32_16x16x32_bf16 v[72:75], a[140:143], a[216:219], v[72:75]
ds_write_b64 v8, v[252:253] offset:6144
v_mfma_f32_16x16x32_bf16 v[68:71], a[140:143], a[212:215], v[68:71]
v_mfma_f32_16x16x32_bf16 v[64:67], a[140:143], a[208:211], v[64:67]
s_waitcnt vmcnt(24)
global_load_dwordx4 a[140:143], v2, s[20:21] offset:-3072 sc1
v_mfma_f32_16x16x32_bf16 v[80:83], a[144:147], a[208:211], v[80:83]
v_mfma_f32_16x16x32_bf16 v[84:87], a[144:147], a[212:215], v[84:87]
v_mfma_f32_16x16x32_bf16 v[88:91], a[144:147], a[216:219], v[88:91]
v_mfma_f32_16x16x32_bf16 v[92:95], a[144:147], a[220:223], v[92:95]
s_waitcnt vmcnt(24)
global_load_dwordx4 a[144:147], v2, s[20:21] offset:-2048 sc1
v_mfma_f32_16x16x32_bf16 v[108:111], a[148:151], a[220:223], v[108:111]
v_mfma_f32_16x16x32_bf16 v[104:107], a[148:151], a[216:219], v[104:107]
v_mfma_f32_16x16x32_bf16 v[100:103], a[148:151], a[212:215], v[100:103]
v_mfma_f32_16x16x32_bf16 v[96:99], a[148:151], a[208:211], v[96:99]
s_waitcnt vmcnt(24)
global_load_dwordx4 a[148:151], v2, s[20:21] offset:-1024 sc1
v_mfma_f32_16x16x32_bf16 v[112:115], a[152:155], a[208:211], v[112:115]
v_mfma_f32_16x16x32_bf16 v[116:119], a[152:155], a[212:215], v[116:119]
v_mfma_f32_16x16x32_bf16 v[120:123], a[152:155], a[216:219], v[120:123]
v_mfma_f32_16x16x32_bf16 v[124:127], a[152:155], a[220:223], v[124:127]
s_waitcnt vmcnt(24)
global_load_dwordx4 a[152:155], v2, s[20:21] offset:0 sc1
v_mfma_f32_16x16x32_bf16 v[140:143], a[156:159], a[220:223], v[140:143]
v_mfma_f32_16x16x32_bf16 v[136:139], a[156:159], a[216:219], v[136:139]
v_mfma_f32_16x16x32_bf16 v[132:135], a[156:159], a[212:215], v[132:135]
v_mfma_f32_16x16x32_bf16 v[128:131], a[156:159], a[208:211], v[128:131]
s_waitcnt vmcnt(24)
global_load_dwordx4 a[156:159], v2, s[20:21] offset:1024 sc1
v_mfma_f32_16x16x32_bf16 v[144:147], a[160:163], a[208:211], v[144:147]
v_mfma_f32_16x16x32_bf16 v[148:151], a[160:163], a[212:215], v[148:151]
v_mfma_f32_16x16x32_bf16 v[152:155], a[160:163], a[216:219], v[152:155]
v_mfma_f32_16x16x32_bf16 v[156:159], a[160:163], a[220:223], v[156:159]
s_waitcnt vmcnt(24)
global_load_dwordx4 a[160:163], v2, s[20:21] offset:2048 sc1
v_mfma_f32_16x16x32_bf16 v[172:175], a[164:167], a[220:223], v[172:175]
v_mfma_f32_16x16x32_bf16 v[168:171], a[164:167], a[216:219], v[168:171]
v_mfma_f32_16x16x32_bf16 v[164:167], a[164:167], a[212:215], v[164:167]
v_mfma_f32_16x16x32_bf16 v[160:163], a[164:167], a[208:211], v[160:163]
s_waitcnt vmcnt(24) lgkmcnt(4)
global_load_dwordx4 a[164:167], v2, s[20:21] offset:3072 sc1
v_add_u32 v2, 8192, v2
v_mfma_f32_16x16x32_bf16 v[48:51], a[168:171], a[224:227], v[48:51]
s_waitcnt lgkmcnt(3)
ds_read_b128 a[208:211], v3 offset:16384
v_mfma_f32_16x16x32_bf16 v[52:55], a[168:171], a[228:231], v[52:55]
s_waitcnt lgkmcnt(3)
ds_read_b128 a[212:215], v3 offset:18432
v_mfma_f32_16x16x32_bf16 v[56:59], a[168:171], a[232:235], v[56:59]
s_waitcnt lgkmcnt(3)
ds_read_b128 a[216:219], v3 offset:20480
v_mfma_f32_16x16x32_bf16 v[60:63], a[168:171], a[236:239], v[60:63]
s_waitcnt vmcnt(24)
global_load_dwordx4 a[168:171], v2, s[20:21] offset:-4096 sc1
v_mfma_f32_16x16x32_bf16 v[76:79], a[172:175], a[236:239], v[76:79]
ds_read_b128 a[220:223], v3 offset:22528
v_mfma_f32_16x16x32_bf16 v[72:75], a[172:175], a[232:235], v[72:75]
v_mfma_f32_16x16x32_bf16 v[68:71], a[172:175], a[228:231], v[68:71]
v_mfma_f32_16x16x32_bf16 v[64:67], a[172:175], a[224:227], v[64:67]
s_waitcnt vmcnt(24)
global_load_dwordx4 a[172:175], v2, s[20:21] offset:-3072 sc1
v_mfma_f32_16x16x32_bf16 v[80:83], a[176:179], a[224:227], v[80:83]
v_mfma_f32_16x16x32_bf16 v[84:87], a[176:179], a[228:231], v[84:87]
v_mfma_f32_16x16x32_bf16 v[88:91], a[176:179], a[232:235], v[88:91]
v_mfma_f32_16x16x32_bf16 v[92:95], a[176:179], a[236:239], v[92:95]
s_waitcnt vmcnt(24)
global_load_dwordx4 a[176:179], v2, s[20:21] offset:-2048 sc1
v_mfma_f32_16x16x32_bf16 v[108:111], a[180:183], a[236:239], v[108:111]
v_mfma_f32_16x16x32_bf16 v[104:107], a[180:183], a[232:235], v[104:107]
v_mfma_f32_16x16x32_bf16 v[100:103], a[180:183], a[228:231], v[100:103]
v_mfma_f32_16x16x32_bf16 v[96:99], a[180:183], a[224:227], v[96:99]
s_waitcnt vmcnt(24)
global_load_dwordx4 a[180:183], v2, s[20:21] offset:-1024 sc1
v_mfma_f32_16x16x32_bf16 v[112:115], a[184:187], a[224:227], v[112:115]
v_mfma_f32_16x16x32_bf16 v[116:119], a[184:187], a[228:231], v[116:119]
v_mfma_f32_16x16x32_bf16 v[120:123], a[184:187], a[232:235], v[120:123]
v_mfma_f32_16x16x32_bf16 v[124:127], a[184:187], a[236:239], v[124:127]
s_waitcnt vmcnt(24)
global_load_dwordx4 a[184:187], v2, s[20:21] offset:0 sc1
v_mfma_f32_16x16x32_bf16 v[140:143], a[188:191], a[236:239], v[140:143]
v_mfma_f32_16x16x32_bf16 v[136:139], a[188:191], a[232:235], v[136:139]
v_mfma_f32_16x16x32_bf16 v[132:135], a[188:191], a[228:231], v[132:135]
v_mfma_f32_16x16x32_bf16 v[128:131], a[188:191], a[224:227], v[128:131]
s_waitcnt vmcnt(24)
global_load_dwordx4 a[188:191], v2, s[20:21] offset:1024 sc1
v_mfma_f32_16x16x32_bf16 v[144:147], a[192:195], a[224:227], v[144:147]
v_mfma_f32_16x16x32_bf16 v[148:151], a[192:195], a[228:231], v[148:151]
v_mfma_f32_16x16x32_bf16 v[152:155], a[192:195], a[232:235], v[152:155]
v_mfma_f32_16x16x32_bf16 v[156:159], a[192:195], a[236:239], v[156:159]
s_waitcnt vmcnt(24)
global_load_dwordx4 a[192:195], v2, s[20:21] offset:2048 sc1
v_mfma_f32_16x16x32_bf16 v[172:175], a[196:199], a[236:239], v[172:175]
v_mfma_f32_16x16x32_bf16 v[168:171], a[196:199], a[232:235], v[168:171]
v_mfma_f32_16x16x32_bf16 v[164:167], a[196:199], a[228:231], v[164:167]
v_mfma_f32_16x16x32_bf16 v[160:163], a[196:199], a[224:227], v[160:163]
s_waitcnt vmcnt(24) lgkmcnt(3)
global_load_dwordx4 a[196:199], v2, s[20:21] offset:3072 sc1
v_add_u32 v2, 8192, v2
v_mfma_f32_16x16x32_bf16 v[48:51], a[200:203], a[208:211], v[48:51]
s_waitcnt lgkmcnt(2)
ds_read_b128 a[224:227], v44 offset:16384
v_mfma_f32_16x16x32_bf16 v[52:55], a[200:203], a[212:215], v[52:55]
s_waitcnt lgkmcnt(2)
ds_read_b128 a[228:231], v44 offset:18432
v_mfma_f32_16x16x32_bf16 v[56:59], a[200:203], a[216:219], v[56:59]
s_waitcnt lgkmcnt(2)
ds_read_b128 a[232:235], v44 offset:20480
v_mfma_f32_16x16x32_bf16 v[60:63], a[200:203], a[220:223], v[60:63]
s_waitcnt vmcnt(24)
global_load_dwordx4 a[200:203], v2, s[20:21] offset:-4096 sc1
v_mfma_f32_16x16x32_bf16 v[76:79], a[204:207], a[220:223], v[76:79]
ds_read_b128 a[236:239], v44 offset:22528
v_mfma_f32_16x16x32_bf16 v[72:75], a[204:207], a[216:219], v[72:75]
v_mfma_f32_16x16x32_bf16 v[68:71], a[204:207], a[212:215], v[68:71]
v_mfma_f32_16x16x32_bf16 v[64:67], a[204:207], a[208:211], v[64:67]
s_waitcnt vmcnt(24)
global_load_dwordx4 a[204:207], v2, s[20:21] offset:-3072 sc1
v_mfma_f32_16x16x32_bf16 v[80:83], a[104:107], a[208:211], v[80:83]
v_mfma_f32_16x16x32_bf16 v[84:87], a[104:107], a[212:215], v[84:87]
v_mfma_f32_16x16x32_bf16 v[88:91], a[104:107], a[216:219], v[88:91]
v_mfma_f32_16x16x32_bf16 v[92:95], a[104:107], a[220:223], v[92:95]
s_waitcnt vmcnt(24)
global_load_dwordx4 a[104:107], v2, s[20:21] offset:-2048 sc1
v_mfma_f32_16x16x32_bf16 v[108:111], a[108:111], a[220:223], v[108:111]
v_mfma_f32_16x16x32_bf16 v[104:107], a[108:111], a[216:219], v[104:107]
v_mfma_f32_16x16x32_bf16 v[100:103], a[108:111], a[212:215], v[100:103]
v_mfma_f32_16x16x32_bf16 v[96:99], a[108:111], a[208:211], v[96:99]
s_waitcnt vmcnt(24)
global_load_dwordx4 a[108:111], v2, s[20:21] offset:-1024 sc1
v_mfma_f32_16x16x32_bf16 v[112:115], a[112:115], a[208:211], v[112:115]
v_mfma_f32_16x16x32_bf16 v[116:119], a[112:115], a[212:215], v[116:119]
v_mfma_f32_16x16x32_bf16 v[120:123], a[112:115], a[216:219], v[120:123]
v_mfma_f32_16x16x32_bf16 v[124:127], a[112:115], a[220:223], v[124:127]
s_waitcnt vmcnt(24)
global_load_dwordx4 a[112:115], v2, s[20:21] offset:0 sc1
v_mfma_f32_16x16x32_bf16 v[140:143], a[116:119], a[220:223], v[140:143]
v_mfma_f32_16x16x32_bf16 v[136:139], a[116:119], a[216:219], v[136:139]
v_mfma_f32_16x16x32_bf16 v[132:135], a[116:119], a[212:215], v[132:135]
v_mfma_f32_16x16x32_bf16 v[128:131], a[116:119], a[208:211], v[128:131]
s_waitcnt vmcnt(24)
global_load_dwordx4 a[116:119], v2, s[20:21] offset:1024 sc1
v_mfma_f32_16x16x32_bf16 v[144:147], a[120:123], a[208:211], v[144:147]
v_mfma_f32_16x16x32_bf16 v[148:151], a[120:123], a[212:215], v[148:151]
v_mfma_f32_16x16x32_bf16 v[152:155], a[120:123], a[216:219], v[152:155]
v_mfma_f32_16x16x32_bf16 v[156:159], a[120:123], a[220:223], v[156:159]
s_waitcnt vmcnt(24)
global_load_dwordx4 a[120:123], v2, s[20:21] offset:2048 sc1
v_mfma_f32_16x16x32_bf16 v[172:175], a[124:127], a[220:223], v[172:175]
v_mfma_f32_16x16x32_bf16 v[168:171], a[124:127], a[216:219], v[168:171]
v_mfma_f32_16x16x32_bf16 v[164:167], a[124:127], a[212:215], v[164:167]
v_mfma_f32_16x16x32_bf16 v[160:163], a[124:127], a[208:211], v[160:163]
s_waitcnt vmcnt(24) lgkmcnt(3)
s_barrier
global_load_dwordx4 a[124:127], v2, s[20:21] offset:3072 sc1
v_add_u32 v2, 8192, v2
v_mfma_f32_16x16x32_bf16 v[48:51], a[128:131], a[224:227], v[48:51]
s_waitcnt lgkmcnt(2)
ds_read_b128 a[208:211], v7 offset:0
v_mfma_f32_16x16x32_bf16 v[52:55], a[128:131], a[228:231], v[52:55]
s_waitcnt lgkmcnt(2)
ds_read_b128 a[212:215], v7 offset:2048
v_mfma_f32_16x16x32_bf16 v[56:59], a[128:131], a[232:235], v[56:59]
s_waitcnt lgkmcnt(2)
ds_read_b128 a[216:219], v7 offset:4096
v_mfma_f32_16x16x32_bf16 v[60:63], a[128:131], a[236:239], v[60:63]
s_waitcnt vmcnt(24)
global_load_dwordx4 a[128:131], v2, s[20:21] offset:-4096 sc1
v_mfma_f32_16x16x32_bf16 v[76:79], a[132:135], a[236:239], v[76:79]
ds_read_b128 a[220:223], v7 offset:6144
v_mfma_f32_16x16x32_bf16 v[72:75], a[132:135], a[232:235], v[72:75]
v_mfma_f32_16x16x32_bf16 v[68:71], a[132:135], a[228:231], v[68:71]
v_mfma_f32_16x16x32_bf16 v[64:67], a[132:135], a[224:227], v[64:67]
s_waitcnt vmcnt(24)
global_load_dwordx4 a[132:135], v2, s[20:21] offset:-3072 sc1
v_mfma_f32_16x16x32_bf16 v[80:83], a[136:139], a[224:227], v[80:83]
v_mfma_f32_16x16x32_bf16 v[84:87], a[136:139], a[228:231], v[84:87]
v_mfma_f32_16x16x32_bf16 v[88:91], a[136:139], a[232:235], v[88:91]
v_mfma_f32_16x16x32_bf16 v[92:95], a[136:139], a[236:239], v[92:95]
s_waitcnt vmcnt(24)
global_load_dwordx4 a[136:139], v2, s[20:21] offset:-2048 sc1
v_mfma_f32_16x16x32_bf16 v[108:111], a[140:143], a[236:239], v[108:111]
v_mfma_f32_16x16x32_bf16 v[104:107], a[140:143], a[232:235], v[104:107]
v_mfma_f32_16x16x32_bf16 v[100:103], a[140:143], a[228:231], v[100:103]
v_mfma_f32_16x16x32_bf16 v[96:99], a[140:143], a[224:227], v[96:99]
s_waitcnt vmcnt(24)
global_load_dwordx4 a[140:143], v2, s[20:21] offset:-1024 sc1
v_mfma_f32_16x16x32_bf16 v[112:115], a[144:147], a[224:227], v[112:115]
v_mfma_f32_16x16x32_bf16 v[116:119], a[144:147], a[228:231], v[116:119]
v_mfma_f32_16x16x32_bf16 v[120:123], a[144:147], a[232:235], v[120:123]
v_mfma_f32_16x16x32_bf16 v[124:127], a[144:147], a[236:239], v[124:127]
s_waitcnt vmcnt(24)
global_load_dwordx4 a[144:147], v2, s[20:21] offset:0 sc1
v_mfma_f32_16x16x32_bf16 v[140:143], a[148:151], a[236:239], v[140:143]
v_mfma_f32_16x16x32_bf16 v[136:139], a[148:151], a[232:235], v[136:139]
v_mfma_f32_16x16x32_bf16 v[132:135], a[148:151], a[228:231], v[132:135]
v_mfma_f32_16x16x32_bf16 v[128:131], a[148:151], a[224:227], v[128:131]
s_waitcnt vmcnt(24)
global_load_dwordx4 a[148:151], v2, s[20:21] offset:1024 sc1
v_mfma_f32_16x16x32_bf16 v[144:147], a[152:155], a[224:227], v[144:147]
v_mfma_f32_16x16x32_bf16 v[148:151], a[152:155], a[228:231], v[148:151]
v_mfma_f32_16x16x32_bf16 v[152:155], a[152:155], a[232:235], v[152:155]
v_mfma_f32_16x16x32_bf16 v[156:159], a[152:155], a[236:239], v[156:159]
s_waitcnt vmcnt(24)
global_load_dwordx4 a[152:155], v2, s[20:21] offset:2048 sc1
v_mfma_f32_16x16x32_bf16 v[172:175], a[156:159], a[236:239], v[172:175]
v_mfma_f32_16x16x32_bf16 v[168:171], a[156:159], a[232:235], v[168:171]
v_mfma_f32_16x16x32_bf16 v[164:167], a[156:159], a[228:231], v[164:167]
v_mfma_f32_16x16x32_bf16 v[160:163], a[156:159], a[224:227], v[160:163]
s_waitcnt vmcnt(24) lgkmcnt(3)
global_load_dwordx4 a[156:159], v2, s[20:21] offset:3072 sc1
v_add_u32 v2, 8192, v2
v_mfma_f32_16x16x32_bf16 v[48:51], a[160:163], a[208:211], v[48:51]
s_waitcnt lgkmcnt(2)
ds_read_b128 a[224:227], v15 offset:0
ds_read_b128 v[188:191], v13 offset:512
v_mfma_f32_16x16x32_bf16 v[52:55], a[160:163], a[212:215], v[52:55]
s_waitcnt lgkmcnt(3)
ds_read_b128 a[228:231], v15 offset:2048
ds_read_b128 v[204:207], v13 offset:528
v_mfma_f32_16x16x32_bf16 v[56:59], a[160:163], a[216:219], v[56:59]
s_waitcnt lgkmcnt(4)
ds_read_b128 a[232:235], v15 offset:4096
ds_read_b128 v[220:223], v13 offset:640
v_mfma_f32_16x16x32_bf16 v[60:63], a[160:163], a[220:223], v[60:63]
s_waitcnt vmcnt(24)
global_load_dwordx4 a[160:163], v2, s[20:21] offset:-4096 sc1
ds_read_b128 v[236:239], v13 offset:656
v_mfma_f32_16x16x32_bf16 v[76:79], a[164:167], a[220:223], v[76:79]
ds_read_b128 a[236:239], v15 offset:6144
ds_read_b128 v[252:255], v14
v_mfma_f32_16x16x32_bf16 v[72:75], a[164:167], a[216:219], v[72:75]
v_mfma_f32_16x16x32_bf16 v[68:71], a[164:167], a[212:215], v[68:71]
v_mfma_f32_16x16x32_bf16 v[64:67], a[164:167], a[208:211], v[64:67]
s_waitcnt vmcnt(24)
global_load_dwordx4 a[164:167], v2, s[20:21] offset:-3072 sc1
v_mfma_f32_16x16x32_bf16 v[80:83], a[168:171], a[208:211], v[80:83]
v_mfma_f32_16x16x32_bf16 v[84:87], a[168:171], a[212:215], v[84:87]
v_mfma_f32_16x16x32_bf16 v[88:91], a[168:171], a[216:219], v[88:91]
v_mfma_f32_16x16x32_bf16 v[92:95], a[168:171], a[220:223], v[92:95]
s_waitcnt vmcnt(24)
global_load_dwordx4 a[168:171], v2, s[20:21] offset:-2048 sc1
v_mfma_f32_16x16x32_bf16 v[108:111], a[172:175], a[220:223], v[108:111]
v_mfma_f32_16x16x32_bf16 v[104:107], a[172:175], a[216:219], v[104:107]
v_mfma_f32_16x16x32_bf16 v[100:103], a[172:175], a[212:215], v[100:103]
v_mfma_f32_16x16x32_bf16 v[96:99], a[172:175], a[208:211], v[96:99]
s_waitcnt vmcnt(24)
global_load_dwordx4 a[172:175], v2, s[20:21] offset:-1024 sc1
v_mfma_f32_16x16x32_bf16 v[112:115], a[176:179], a[208:211], v[112:115]
v_mfma_f32_16x16x32_bf16 v[116:119], a[176:179], a[212:215], v[116:119]
v_mfma_f32_16x16x32_bf16 v[120:123], a[176:179], a[216:219], v[120:123]
v_mfma_f32_16x16x32_bf16 v[124:127], a[176:179], a[220:223], v[124:127]
s_waitcnt vmcnt(24)
global_load_dwordx4 a[176:179], v2, s[20:21] offset:0 sc1
v_mfma_f32_16x16x32_bf16 v[140:143], a[180:183], a[220:223], v[140:143]
v_mfma_f32_16x16x32_bf16 v[136:139], a[180:183], a[216:219], v[136:139]
v_mfma_f32_16x16x32_bf16 v[132:135], a[180:183], a[212:215], v[132:135]
v_mfma_f32_16x16x32_bf16 v[128:131], a[180:183], a[208:211], v[128:131]
s_waitcnt vmcnt(24)
global_load_dwordx4 a[180:183], v2, s[20:21] offset:1024 sc1
v_mfma_f32_16x16x32_bf16 v[144:147], a[184:187], a[208:211], v[144:147]
v_mfma_f32_16x16x32_bf16 v[148:151], a[184:187], a[212:215], v[148:151]
v_mfma_f32_16x16x32_bf16 v[152:155], a[184:187], a[216:219], v[152:155]
v_mfma_f32_16x16x32_bf16 v[156:159], a[184:187], a[220:223], v[156:159]
s_waitcnt vmcnt(24)
global_load_dwordx4 a[184:187], v2, s[20:21] offset:2048 sc1
v_mfma_f32_16x16x32_bf16 v[172:175], a[188:191], a[220:223], v[172:175]
v_mfma_f32_16x16x32_bf16 v[168:171], a[188:191], a[216:219], v[168:171]
v_mfma_f32_16x16x32_bf16 v[164:167], a[188:191], a[212:215], v[164:167]
v_mfma_f32_16x16x32_bf16 v[160:163], a[188:191], a[208:211], v[160:163]
s_waitcnt vmcnt(24) lgkmcnt(8)
global_load_dwordx4 a[188:191], v2, s[20:21] offset:3072 sc1
v_add_u32 v2, 8192, v2
v_mfma_f32_16x16x32_bf16 v[48:51], a[192:195], a[224:227], v[48:51]
s_waitcnt lgkmcnt(6)
ds_read_b128 a[208:211], v4 offset:16384
v_mfma_f32_16x16x32_bf16 v[52:55], a[192:195], a[228:231], v[52:55]
s_waitcnt lgkmcnt(5)
ds_read_b128 a[212:215], v4 offset:18432
v_mfma_f32_16x16x32_bf16 v[56:59], a[192:195], a[232:235], v[56:59]
s_waitcnt lgkmcnt(3)
ds_read_b128 a[216:219], v4 offset:20480
v_mfma_f32_16x16x32_bf16 v[60:63], a[192:195], a[236:239], v[60:63]
s_waitcnt vmcnt(24)
global_load_dwordx4 a[192:195], v2, s[20:21] offset:-4096 sc1
v_mfma_f32_16x16x32_bf16 v[76:79], a[196:199], a[236:239], v[76:79]
ds_read_b128 a[220:223], v4 offset:22528
v_mfma_f32_16x16x32_bf16 v[72:75], a[196:199], a[232:235], v[72:75]
v_mfma_f32_16x16x32_bf16 v[68:71], a[196:199], a[228:231], v[68:71]
v_mfma_f32_16x16x32_bf16 v[64:67], a[196:199], a[224:227], v[64:67]
s_waitcnt vmcnt(24)
global_load_dwordx4 a[196:199], v2, s[20:21] offset:-3072 sc1
v_mfma_f32_16x16x32_bf16 v[80:83], a[200:203], a[224:227], v[80:83]
v_mfma_f32_16x16x32_bf16 v[84:87], a[200:203], a[228:231], v[84:87]
v_mfma_f32_16x16x32_bf16 v[88:91], a[200:203], a[232:235], v[88:91]
v_mfma_f32_16x16x32_bf16 v[92:95], a[200:203], a[236:239], v[92:95]
s_waitcnt vmcnt(24)
global_load_dwordx4 a[200:203], v2, s[20:21] offset:-2048 sc1
v_mfma_f32_16x16x32_bf16 v[108:111], a[204:207], a[236:239], v[108:111]
v_mfma_f32_16x16x32_bf16 v[104:107], a[204:207], a[232:235], v[104:107]
v_mfma_f32_16x16x32_bf16 v[100:103], a[204:207], a[228:231], v[100:103]
v_mfma_f32_16x16x32_bf16 v[96:99], a[204:207], a[224:227], v[96:99]
s_waitcnt vmcnt(24)
global_load_dwordx4 a[204:207], v2, s[20:21] offset:-1024 sc1
v_mfma_f32_16x16x32_bf16 v[112:115], a[104:107], a[224:227], v[112:115]
v_mfma_f32_16x16x32_bf16 v[116:119], a[104:107], a[228:231], v[116:119]
v_mfma_f32_16x16x32_bf16 v[120:123], a[104:107], a[232:235], v[120:123]
v_mfma_f32_16x16x32_bf16 v[124:127], a[104:107], a[236:239], v[124:127]
s_waitcnt vmcnt(24)
global_load_dwordx4 a[104:107], v2, s[20:21] offset:0 sc1
v_mfma_f32_16x16x32_bf16 v[140:143], a[108:111], a[236:239], v[140:143]
v_mfma_f32_16x16x32_bf16 v[136:139], a[108:111], a[232:235], v[136:139]
v_mfma_f32_16x16x32_bf16 v[132:135], a[108:111], a[228:231], v[132:135]
v_mfma_f32_16x16x32_bf16 v[128:131], a[108:111], a[224:227], v[128:131]
s_waitcnt vmcnt(24)
global_load_dwordx4 a[108:111], v2, s[20:21] offset:1024 sc1
v_mfma_f32_16x16x32_bf16 v[144:147], a[112:115], a[224:227], v[144:147]
v_mfma_f32_16x16x32_bf16 v[148:151], a[112:115], a[228:231], v[148:151]
v_mfma_f32_16x16x32_bf16 v[152:155], a[112:115], a[232:235], v[152:155]
v_mfma_f32_16x16x32_bf16 v[156:159], a[112:115], a[236:239], v[156:159]
s_waitcnt vmcnt(24)
global_load_dwordx4 a[112:115], v2, s[20:21] offset:2048 sc1
v_mfma_f32_16x16x32_bf16 v[172:175], a[116:119], a[236:239], v[172:175]
v_mfma_f32_16x16x32_bf16 v[168:171], a[116:119], a[232:235], v[168:171]
v_mfma_f32_16x16x32_bf16 v[164:167], a[116:119], a[228:231], v[164:167]
v_mfma_f32_16x16x32_bf16 v[160:163], a[116:119], a[224:227], v[160:163]
s_waitcnt vmcnt(24) lgkmcnt(3)
global_load_dwordx4 a[116:119], v2, s[20:21] offset:3072 sc1
v_add_u32 v2, 8192, v2
v_mfma_f32_16x16x32_bf16 v[48:51], a[120:123], a[208:211], v[48:51]
s_waitcnt lgkmcnt(2)
ds_read_b128 a[224:227], v45 offset:16384
v_mfma_f32_16x16x32_bf16 v[52:55], a[120:123], a[212:215], v[52:55]
s_waitcnt lgkmcnt(2)
ds_read_b128 a[228:231], v45 offset:18432
v_mfma_f32_16x16x32_bf16 v[56:59], a[120:123], a[216:219], v[56:59]
s_waitcnt lgkmcnt(2)
ds_read_b128 a[232:235], v45 offset:20480
v_mfma_f32_16x16x32_bf16 v[60:63], a[120:123], a[220:223], v[60:63]
s_waitcnt vmcnt(24)
global_load_dwordx4 a[120:123], v2, s[20:21] offset:-4096 sc1
v_mfma_f32_16x16x32_bf16 v[76:79], a[124:127], a[220:223], v[76:79]
ds_read_b128 a[236:239], v45 offset:22528
v_mfma_f32_16x16x32_bf16 v[72:75], a[124:127], a[216:219], v[72:75]
v_mfma_f32_16x16x32_bf16 v[68:71], a[124:127], a[212:215], v[68:71]
v_mfma_f32_16x16x32_bf16 v[64:67], a[124:127], a[208:211], v[64:67]
s_waitcnt vmcnt(24)
global_load_dwordx4 a[124:127], v2, s[20:21] offset:-3072 sc1
v_mfma_f32_16x16x32_bf16 v[80:83], a[128:131], a[208:211], v[80:83]
v_mfma_f32_16x16x32_bf16 v[84:87], a[128:131], a[212:215], v[84:87]
v_mfma_f32_16x16x32_bf16 v[88:91], a[128:131], a[216:219], v[88:91]
v_mfma_f32_16x16x32_bf16 v[92:95], a[128:131], a[220:223], v[92:95]
s_waitcnt vmcnt(24)
global_load_dwordx4 a[128:131], v2, s[20:21] offset:-2048 sc1
v_mfma_f32_16x16x32_bf16 v[108:111], a[132:135], a[220:223], v[108:111]
v_mfma_f32_16x16x32_bf16 v[104:107], a[132:135], a[216:219], v[104:107]
v_mfma_f32_16x16x32_bf16 v[100:103], a[132:135], a[212:215], v[100:103]
v_mfma_f32_16x16x32_bf16 v[96:99], a[132:135], a[208:211], v[96:99]
s_waitcnt vmcnt(24)
global_load_dwordx4 a[132:135], v2, s[20:21] offset:-1024 sc1
v_mfma_f32_16x16x32_bf16 v[112:115], a[136:139], a[208:211], v[112:115]
v_mfma_f32_16x16x32_bf16 v[116:119], a[136:139], a[212:215], v[116:119]
v_mfma_f32_16x16x32_bf16 v[120:123], a[136:139], a[216:219], v[120:123]
v_mfma_f32_16x16x32_bf16 v[124:127], a[136:139], a[220:223], v[124:127]
s_waitcnt vmcnt(24)
global_load_dwordx4 a[136:139], v2, s[20:21] offset:0 sc1
v_mfma_f32_16x16x32_bf16 v[140:143], a[140:143], a[220:223], v[140:143]
v_mfma_f32_16x16x32_bf16 v[136:139], a[140:143], a[216:219], v[136:139]
v_mfma_f32_16x16x32_bf16 v[132:135], a[140:143], a[212:215], v[132:135]
v_mfma_f32_16x16x32_bf16 v[128:131], a[140:143], a[208:211], v[128:131]
s_waitcnt vmcnt(24)
global_load_dwordx4 a[140:143], v2, s[20:21] offset:1024 sc1
v_mfma_f32_16x16x32_bf16 v[144:147], a[144:147], a[208:211], v[144:147]
v_mfma_f32_16x16x32_bf16 v[148:151], a[144:147], a[212:215], v[148:151]
v_mfma_f32_16x16x32_bf16 v[152:155], a[144:147], a[216:219], v[152:155]
v_mfma_f32_16x16x32_bf16 v[156:159], a[144:147], a[220:223], v[156:159]
s_waitcnt vmcnt(24)
global_load_dwordx4 a[144:147], v2, s[20:21] offset:2048 sc1
v_mfma_f32_16x16x32_bf16 v[172:175], a[148:151], a[220:223], v[172:175]
v_mfma_f32_16x16x32_bf16 v[168:171], a[148:151], a[216:219], v[168:171]
v_mfma_f32_16x16x32_bf16 v[164:167], a[148:151], a[212:215], v[164:167]
v_mfma_f32_16x16x32_bf16 v[160:163], a[148:151], a[208:211], v[160:163]
s_waitcnt vmcnt(24) lgkmcnt(3)
global_load_dwordx4 a[148:151], v2, s[20:21] offset:3072 sc1
v_add_u32 v2, 8192, v2
v_mfma_f32_16x16x32_bf16 v[48:51], a[152:155], a[224:227], v[48:51]
s_waitcnt lgkmcnt(2)
ds_read_b128 a[208:211], v5 offset:16384
v_mfma_f32_16x16x32_bf16 v[52:55], a[152:155], a[228:231], v[52:55]
s_waitcnt lgkmcnt(2)
ds_read_b128 a[212:215], v5 offset:18432
v_mfma_f32_16x16x32_bf16 v[56:59], a[152:155], a[232:235], v[56:59]
s_waitcnt lgkmcnt(2)
ds_read_b128 a[216:219], v5 offset:20480
v_mfma_f32_16x16x32_bf16 v[60:63], a[152:155], a[236:239], v[60:63]
s_waitcnt vmcnt(24)
global_load_dwordx4 a[152:155], v2, s[20:21] offset:-4096 sc1
v_mfma_f32_16x16x32_bf16 v[76:79], a[156:159], a[236:239], v[76:79]
ds_read_b128 a[220:223], v5 offset:22528
v_mfma_f32_16x16x32_bf16 v[72:75], a[156:159], a[232:235], v[72:75]
v_mfma_f32_16x16x32_bf16 v[68:71], a[156:159], a[228:231], v[68:71]
v_mfma_f32_16x16x32_bf16 v[64:67], a[156:159], a[224:227], v[64:67]
s_waitcnt vmcnt(24)
global_load_dwordx4 a[156:159], v2, s[20:21] offset:-3072 sc1
v_mfma_f32_16x16x32_bf16 v[80:83], a[160:163], a[224:227], v[80:83]
v_mfma_f32_16x16x32_bf16 v[84:87], a[160:163], a[228:231], v[84:87]
v_mfma_f32_16x16x32_bf16 v[88:91], a[160:163], a[232:235], v[88:91]
v_mfma_f32_16x16x32_bf16 v[92:95], a[160:163], a[236:239], v[92:95]
s_waitcnt vmcnt(24)
global_load_dwordx4 a[160:163], v2, s[20:21] offset:-2048 sc1
v_mfma_f32_16x16x32_bf16 v[108:111], a[164:167], a[236:239], v[108:111]
v_mfma_f32_16x16x32_bf16 v[104:107], a[164:167], a[232:235], v[104:107]
v_mfma_f32_16x16x32_bf16 v[100:103], a[164:167], a[228:231], v[100:103]
v_mfma_f32_16x16x32_bf16 v[96:99], a[164:167], a[224:227], v[96:99]
s_waitcnt vmcnt(24)
global_load_dwordx4 a[164:167], v2, s[20:21] offset:-1024 sc1
v_mfma_f32_16x16x32_bf16 v[112:115], a[168:171], a[224:227], v[112:115]
v_mfma_f32_16x16x32_bf16 v[116:119], a[168:171], a[228:231], v[116:119]
v_mfma_f32_16x16x32_bf16 v[120:123], a[168:171], a[232:235], v[120:123]
v_mfma_f32_16x16x32_bf16 v[124:127], a[168:171], a[236:239], v[124:127]
s_waitcnt vmcnt(24)
global_load_dwordx4 a[168:171], v2, s[20:21] offset:0 sc1
v_mfma_f32_16x16x32_bf16 v[140:143], a[172:175], a[236:239], v[140:143]
v_mfma_f32_16x16x32_bf16 v[136:139], a[172:175], a[232:235], v[136:139]
v_mfma_f32_16x16x32_bf16 v[132:135], a[172:175], a[228:231], v[132:135]
v_mfma_f32_16x16x32_bf16 v[128:131], a[172:175], a[224:227], v[128:131]
s_waitcnt vmcnt(24)
global_load_dwordx4 a[172:175], v2, s[20:21] offset:1024 sc1
v_mfma_f32_16x16x32_bf16 v[144:147], a[176:179], a[224:227], v[144:147]
v_mfma_f32_16x16x32_bf16 v[148:151], a[176:179], a[228:231], v[148:151]
v_mfma_f32_16x16x32_bf16 v[152:155], a[176:179], a[232:235], v[152:155]
v_mfma_f32_16x16x32_bf16 v[156:159], a[176:179], a[236:239], v[156:159]
s_waitcnt vmcnt(24)
global_load_dwordx4 a[176:179], v2, s[20:21] offset:2048 sc1
v_mfma_f32_16x16x32_bf16 v[172:175], a[180:183], a[236:239], v[172:175]
v_mfma_f32_16x16x32_bf16 v[168:171], a[180:183], a[232:235], v[168:171]
v_mfma_f32_16x16x32_bf16 v[164:167], a[180:183], a[228:231], v[164:167]
v_mfma_f32_16x16x32_bf16 v[160:163], a[180:183], a[224:227], v[160:163]
s_waitcnt vmcnt(24) lgkmcnt(3)
global_load_dwordx4 a[180:183], v2, s[20:21] offset:3072 sc1
v_add_u32 v2, 8192, v2
v_mfma_f32_16x16x32_bf16 v[48:51], a[184:187], a[208:211], v[48:51]
s_waitcnt lgkmcnt(2)
ds_read_b128 a[224:227], v46 offset:16384
v_mfma_f32_16x16x32_bf16 v[52:55], a[184:187], a[212:215], v[52:55]
s_waitcnt lgkmcnt(2)
ds_read_b128 a[228:231], v46 offset:18432
v_mfma_f32_16x16x32_bf16 v[56:59], a[184:187], a[216:219], v[56:59]
s_waitcnt lgkmcnt(2)
ds_read_b128 a[232:235], v46 offset:20480
v_mfma_f32_16x16x32_bf16 v[60:63], a[184:187], a[220:223], v[60:63]
s_waitcnt vmcnt(24)
global_load_dwordx4 a[184:187], v2, s[20:21] offset:-4096 sc1
v_mfma_f32_16x16x32_bf16 v[76:79], a[188:191], a[220:223], v[76:79]
ds_read_b128 a[236:239], v46 offset:22528
v_mfma_f32_16x16x32_bf16 v[72:75], a[188:191], a[216:219], v[72:75]
v_mfma_f32_16x16x32_bf16 v[68:71], a[188:191], a[212:215], v[68:71]
v_mfma_f32_16x16x32_bf16 v[64:67], a[188:191], a[208:211], v[64:67]
s_waitcnt vmcnt(24)
global_load_dwordx4 a[188:191], v2, s[20:21] offset:-3072 sc1
v_mfma_f32_16x16x32_bf16 v[80:83], a[192:195], a[208:211], v[80:83]
v_mfma_f32_16x16x32_bf16 v[84:87], a[192:195], a[212:215], v[84:87]
v_mfma_f32_16x16x32_bf16 v[88:91], a[192:195], a[216:219], v[88:91]
v_mfma_f32_16x16x32_bf16 v[92:95], a[192:195], a[220:223], v[92:95]
s_waitcnt vmcnt(24)
global_load_dwordx4 a[192:195], v2, s[20:21] offset:-2048 sc1
v_mfma_f32_16x16x32_bf16 v[108:111], a[196:199], a[220:223], v[108:111]
v_mfma_f32_16x16x32_bf16 v[104:107], a[196:199], a[216:219], v[104:107]
v_mfma_f32_16x16x32_bf16 v[100:103], a[196:199], a[212:215], v[100:103]
v_mfma_f32_16x16x32_bf16 v[96:99], a[196:199], a[208:211], v[96:99]
s_waitcnt vmcnt(24)
global_load_dwordx4 a[196:199], v2, s[20:21] offset:-1024 sc1
v_mfma_f32_16x16x32_bf16 v[112:115], a[200:203], a[208:211], v[112:115]
v_mfma_f32_16x16x32_bf16 v[116:119], a[200:203], a[212:215], v[116:119]
v_mfma_f32_16x16x32_bf16 v[120:123], a[200:203], a[216:219], v[120:123]
v_mfma_f32_16x16x32_bf16 v[124:127], a[200:203], a[220:223], v[124:127]
s_waitcnt vmcnt(24)
global_load_dwordx4 a[200:203], v2, s[20:21] offset:0 sc1
v_mfma_f32_16x16x32_bf16 v[140:143], a[204:207], a[220:223], v[140:143]
v_mfma_f32_16x16x32_bf16 v[136:139], a[204:207], a[216:219], v[136:139]
v_mfma_f32_16x16x32_bf16 v[132:135], a[204:207], a[212:215], v[132:135]
v_mfma_f32_16x16x32_bf16 v[128:131], a[204:207], a[208:211], v[128:131]
s_waitcnt vmcnt(24)
global_load_dwordx4 a[204:207], v2, s[20:21] offset:1024 sc1
v_mfma_f32_16x16x32_bf16 v[144:147], a[104:107], a[208:211], v[144:147]
v_mfma_f32_16x16x32_bf16 v[148:151], a[104:107], a[212:215], v[148:151]
v_mfma_f32_16x16x32_bf16 v[152:155], a[104:107], a[216:219], v[152:155]
v_mfma_f32_16x16x32_bf16 v[156:159], a[104:107], a[220:223], v[156:159]
s_waitcnt vmcnt(24)
global_load_dwordx4 a[104:107], v2, s[20:21] offset:2048 sc1
v_mfma_f32_16x16x32_bf16 v[172:175], a[108:111], a[220:223], v[172:175]
v_mfma_f32_16x16x32_bf16 v[168:171], a[108:111], a[216:219], v[168:171]
v_mfma_f32_16x16x32_bf16 v[164:167], a[108:111], a[212:215], v[164:167]
v_mfma_f32_16x16x32_bf16 v[160:163], a[108:111], a[208:211], v[160:163]
s_waitcnt vmcnt(24) lgkmcnt(3)
global_load_dwordx4 a[108:111], v2, s[20:21] offset:3072 sc1
v_add_u32 v2, 8192, v2
v_mfma_f32_16x16x32_bf16 v[48:51], a[112:115], a[224:227], v[48:51]
s_waitcnt lgkmcnt(2)
ds_read_b128 a[208:211], v6 offset:16384
v_mfma_f32_16x16x32_bf16 v[52:55], a[112:115], a[228:231], v[52:55]
s_waitcnt lgkmcnt(2)
ds_read_b128 a[212:215], v6 offset:18432
v_mfma_f32_16x16x32_bf16 v[56:59], a[112:115], a[232:235], v[56:59]
s_waitcnt lgkmcnt(2)
ds_read_b128 a[216:219], v6 offset:20480
v_mfma_f32_16x16x32_bf16 v[60:63], a[112:115], a[236:239], v[60:63]
s_waitcnt vmcnt(24)
global_load_dwordx4 a[112:115], v2, s[20:21] offset:-4096 sc1
v_mfma_f32_16x16x32_bf16 v[76:79], a[116:119], a[236:239], v[76:79]
ds_read_b128 a[220:223], v6 offset:22528
v_mfma_f32_16x16x32_bf16 v[72:75], a[116:119], a[232:235], v[72:75]
v_mfma_f32_16x16x32_bf16 v[68:71], a[116:119], a[228:231], v[68:71]
v_mfma_f32_16x16x32_bf16 v[64:67], a[116:119], a[224:227], v[64:67]
s_waitcnt vmcnt(24)
global_load_dwordx4 a[116:119], v2, s[20:21] offset:-3072 sc1
v_mfma_f32_16x16x32_bf16 v[80:83], a[120:123], a[224:227], v[80:83]
v_mfma_f32_16x16x32_bf16 v[84:87], a[120:123], a[228:231], v[84:87]
v_mfma_f32_16x16x32_bf16 v[88:91], a[120:123], a[232:235], v[88:91]
v_mfma_f32_16x16x32_bf16 v[92:95], a[120:123], a[236:239], v[92:95]
s_waitcnt vmcnt(24)
global_load_dwordx4 a[120:123], v2, s[20:21] offset:-2048 sc1
v_mfma_f32_16x16x32_bf16 v[108:111], a[124:127], a[236:239], v[108:111]
v_mfma_f32_16x16x32_bf16 v[104:107], a[124:127], a[232:235], v[104:107]
v_mfma_f32_16x16x32_bf16 v[100:103], a[124:127], a[228:231], v[100:103]
v_mfma_f32_16x16x32_bf16 v[96:99], a[124:127], a[224:227], v[96:99]
s_waitcnt vmcnt(24)
global_load_dwordx4 a[124:127], v2, s[20:21] offset:-1024 sc1
v_mfma_f32_16x16x32_bf16 v[112:115], a[128:131], a[224:227], v[112:115]
v_mfma_f32_16x16x32_bf16 v[116:119], a[128:131], a[228:231], v[116:119]
v_mfma_f32_16x16x32_bf16 v[120:123], a[128:131], a[232:235], v[120:123]
v_mfma_f32_16x16x32_bf16 v[124:127], a[128:131], a[236:239], v[124:127]
s_waitcnt vmcnt(24)
global_load_dwordx4 a[128:131], v2, s[20:21] offset:0 sc1
v_mfma_f32_16x16x32_bf16 v[140:143], a[132:135], a[236:239], v[140:143]
v_mfma_f32_16x16x32_bf16 v[136:139], a[132:135], a[232:235], v[136:139]
v_mfma_f32_16x16x32_bf16 v[132:135], a[132:135], a[228:231], v[132:135]
v_mfma_f32_16x16x32_bf16 v[128:131], a[132:135], a[224:227], v[128:131]
s_waitcnt vmcnt(24)
global_load_dwordx4 a[132:135], v2, s[20:21] offset:1024 sc1
v_mfma_f32_16x16x32_bf16 v[144:147], a[136:139], a[224:227], v[144:147]
v_mfma_f32_16x16x32_bf16 v[148:151], a[136:139], a[228:231], v[148:151]
v_mfma_f32_16x16x32_bf16 v[152:155], a[136:139], a[232:235], v[152:155]
v_mfma_f32_16x16x32_bf16 v[156:159], a[136:139], a[236:239], v[156:159]
s_waitcnt vmcnt(24)
global_load_dwordx4 a[136:139], v2, s[20:21] offset:2048 sc1
v_mfma_f32_16x16x32_bf16 v[172:175], a[140:143], a[236:239], v[172:175]
v_mfma_f32_16x16x32_bf16 v[168:171], a[140:143], a[232:235], v[168:171]
v_mfma_f32_16x16x32_bf16 v[164:167], a[140:143], a[228:231], v[164:167]
v_mfma_f32_16x16x32_bf16 v[160:163], a[140:143], a[224:227], v[160:163]
s_waitcnt vmcnt(24) lgkmcnt(3)
global_load_dwordx4 a[140:143], v2, s[20:21] offset:3072 sc1
v_add_u32 v2, 8192, v2
v_mfma_f32_16x16x32_bf16 v[48:51], a[144:147], a[208:211], v[48:51]
s_waitcnt lgkmcnt(2)
ds_read_b128 a[224:227], v47 offset:16384
v_mfma_f32_16x16x32_bf16 v[52:55], a[144:147], a[212:215], v[52:55]
s_waitcnt lgkmcnt(2)
ds_read_b128 a[228:231], v47 offset:18432
v_mfma_f32_16x16x32_bf16 v[56:59], a[144:147], a[216:219], v[56:59]
s_waitcnt lgkmcnt(2)
ds_read_b128 a[232:235], v47 offset:20480
v_mfma_f32_16x16x32_bf16 v[60:63], a[144:147], a[220:223], v[60:63]
s_waitcnt vmcnt(24)
global_load_dwordx4 a[144:147], v2, s[20:21] offset:-4096 sc1
v_mfma_f32_16x16x32_bf16 v[76:79], a[148:151], a[220:223], v[76:79]
ds_read_b128 a[236:239], v47 offset:22528
v_mfma_f32_16x16x32_bf16 v[72:75], a[148:151], a[216:219], v[72:75]
v_mfma_f32_16x16x32_bf16 v[68:71], a[148:151], a[212:215], v[68:71]
v_mfma_f32_16x16x32_bf16 v[64:67], a[148:151], a[208:211], v[64:67]
s_waitcnt vmcnt(24)
global_load_dwordx4 a[148:151], v2, s[20:21] offset:-3072 sc1
v_mfma_f32_16x16x32_bf16 v[80:83], a[152:155], a[208:211], v[80:83]
v_mfma_f32_16x16x32_bf16 v[84:87], a[152:155], a[212:215], v[84:87]
v_mfma_f32_16x16x32_bf16 v[88:91], a[152:155], a[216:219], v[88:91]
v_mfma_f32_16x16x32_bf16 v[92:95], a[152:155], a[220:223], v[92:95]
s_waitcnt vmcnt(24)
global_load_dwordx4 a[152:155], v2, s[20:21] offset:-2048 sc1
v_mfma_f32_16x16x32_bf16 v[108:111], a[156:159], a[220:223], v[108:111]
v_mfma_f32_16x16x32_bf16 v[104:107], a[156:159], a[216:219], v[104:107]
v_mfma_f32_16x16x32_bf16 v[100:103], a[156:159], a[212:215], v[100:103]
v_mfma_f32_16x16x32_bf16 v[96:99], a[156:159], a[208:211], v[96:99]
s_waitcnt vmcnt(24)
global_load_dwordx4 a[156:159], v2, s[20:21] offset:-1024 sc1
v_mfma_f32_16x16x32_bf16 v[112:115], a[160:163], a[208:211], v[112:115]
v_mfma_f32_16x16x32_bf16 v[116:119], a[160:163], a[212:215], v[116:119]
v_mfma_f32_16x16x32_bf16 v[120:123], a[160:163], a[216:219], v[120:123]
v_mfma_f32_16x16x32_bf16 v[124:127], a[160:163], a[220:223], v[124:127]
s_waitcnt vmcnt(24)
global_load_dwordx4 a[160:163], v2, s[20:21] offset:0 sc1
v_mfma_f32_16x16x32_bf16 v[140:143], a[164:167], a[220:223], v[140:143]
v_mfma_f32_16x16x32_bf16 v[136:139], a[164:167], a[216:219], v[136:139]
v_mfma_f32_16x16x32_bf16 v[132:135], a[164:167], a[212:215], v[132:135]
v_mfma_f32_16x16x32_bf16 v[128:131], a[164:167], a[208:211], v[128:131]
s_waitcnt vmcnt(24)
global_load_dwordx4 a[164:167], v2, s[20:21] offset:1024 sc1
v_mfma_f32_16x16x32_bf16 v[144:147], a[168:171], a[208:211], v[144:147]
v_mfma_f32_16x16x32_bf16 v[148:151], a[168:171], a[212:215], v[148:151]
v_mfma_f32_16x16x32_bf16 v[152:155], a[168:171], a[216:219], v[152:155]
v_mfma_f32_16x16x32_bf16 v[156:159], a[168:171], a[220:223], v[156:159]
s_waitcnt vmcnt(24)
global_load_dwordx4 a[168:171], v2, s[20:21] offset:2048 sc1
v_mfma_f32_16x16x32_bf16 v[172:175], a[172:175], a[220:223], v[172:175]
v_mfma_f32_16x16x32_bf16 v[168:171], a[172:175], a[216:219], v[168:171]
v_mfma_f32_16x16x32_bf16 v[164:167], a[172:175], a[212:215], v[164:167]
v_mfma_f32_16x16x32_bf16 v[160:163], a[172:175], a[208:211], v[160:163]
s_waitcnt vmcnt(24) lgkmcnt(3)
global_load_dwordx4 a[172:175], v2, s[20:21] offset:3072 sc1
v_add_u32 v2, 8192, v2
v_mfma_f32_16x16x32_bf16 v[48:51], a[176:179], a[224:227], v[48:51]
s_waitcnt lgkmcnt(2)
ds_read_b128 a[208:211], v3 offset:0
v_mfma_f32_16x16x32_bf16 v[52:55], a[176:179], a[228:231], v[52:55]
s_waitcnt lgkmcnt(2)
ds_read_b128 a[212:215], v3 offset:2048
v_mfma_f32_16x16x32_bf16 v[56:59], a[176:179], a[232:235], v[56:59]
s_waitcnt lgkmcnt(2)
ds_read_b128 a[216:219], v3 offset:4096
v_mfma_f32_16x16x32_bf16 v[60:63], a[176:179], a[236:239], v[60:63]
s_waitcnt vmcnt(24)
global_load_dwordx4 a[176:179], v2, s[20:21] offset:-4096 sc1
v_mfma_f32_16x16x32_bf16 v[76:79], a[180:183], a[236:239], v[76:79]
ds_read_b128 a[220:223], v3 offset:6144
v_mfma_f32_16x16x32_bf16 v[72:75], a[180:183], a[232:235], v[72:75]
v_mfma_f32_16x16x32_bf16 v[68:71], a[180:183], a[228:231], v[68:71]
v_mfma_f32_16x16x32_bf16 v[64:67], a[180:183], a[224:227], v[64:67]
s_waitcnt vmcnt(24)
global_load_dwordx4 a[180:183], v2, s[20:21] offset:-3072 sc1
v_mfma_f32_16x16x32_bf16 v[80:83], a[184:187], a[224:227], v[80:83]
v_mfma_f32_16x16x32_bf16 v[84:87], a[184:187], a[228:231], v[84:87]
v_mfma_f32_16x16x32_bf16 v[88:91], a[184:187], a[232:235], v[88:91]
v_mfma_f32_16x16x32_bf16 v[92:95], a[184:187], a[236:239], v[92:95]
s_waitcnt vmcnt(24)
global_load_dwordx4 a[184:187], v2, s[20:21] offset:-2048 sc1
v_mfma_f32_16x16x32_bf16 v[108:111], a[188:191], a[236:239], v[108:111]
v_mfma_f32_16x16x32_bf16 v[104:107], a[188:191], a[232:235], v[104:107]
v_mfma_f32_16x16x32_bf16 v[100:103], a[188:191], a[228:231], v[100:103]
v_mfma_f32_16x16x32_bf16 v[96:99], a[188:191], a[224:227], v[96:99]
s_waitcnt vmcnt(24)
global_load_dwordx4 a[188:191], v2, s[20:21] offset:-1024 sc1
v_mfma_f32_16x16x32_bf16 v[112:115], a[192:195], a[224:227], v[112:115]
v_mfma_f32_16x16x32_bf16 v[116:119], a[192:195], a[228:231], v[116:119]
v_mfma_f32_16x16x32_bf16 v[120:123], a[192:195], a[232:235], v[120:123]
v_mfma_f32_16x16x32_bf16 v[124:127], a[192:195], a[236:239], v[124:127]
s_waitcnt vmcnt(24)
global_load_dwordx4 a[192:195], v2, s[20:21] offset:0 sc1
v_mfma_f32_16x16x32_bf16 v[140:143], a[196:199], a[236:239], v[140:143]
v_mfma_f32_16x16x32_bf16 v[136:139], a[196:199], a[232:235], v[136:139]
v_mfma_f32_16x16x32_bf16 v[132:135], a[196:199], a[228:231], v[132:135]
v_mfma_f32_16x16x32_bf16 v[128:131], a[196:199], a[224:227], v[128:131]
s_waitcnt vmcnt(24)
global_load_dwordx4 a[196:199], v2, s[20:21] offset:1024 sc1
v_mfma_f32_16x16x32_bf16 v[144:147], a[200:203], a[224:227], v[144:147]
v_mfma_f32_16x16x32_bf16 v[148:151], a[200:203], a[228:231], v[148:151]
v_mfma_f32_16x16x32_bf16 v[152:155], a[200:203], a[232:235], v[152:155]
v_mfma_f32_16x16x32_bf16 v[156:159], a[200:203], a[236:239], v[156:159]
s_waitcnt vmcnt(24)
global_load_dwordx4 a[200:203], v2, s[20:21] offset:2048 sc1
v_mfma_f32_16x16x32_bf16 v[172:175], a[204:207], a[236:239], v[172:175]
v_mfma_f32_16x16x32_bf16 v[168:171], a[204:207], a[232:235], v[168:171]
v_mfma_f32_16x16x32_bf16 v[164:167], a[204:207], a[228:231], v[164:167]
v_mfma_f32_16x16x32_bf16 v[160:163], a[204:207], a[224:227], v[160:163]
global_load_dwordx4 a[204:207], v2, s[20:21] offset:3072 sc1
v_add_u32 v2, 8192, v2
s_cmp_lt_u32 s26, 2
s_cbranch_scc1 Lloop
Lpbl:
s_waitcnt vmcnt(25) lgkmcnt(3)
v_mfma_f32_16x16x32_bf16 v[176:179], a[104:107], a[208:211], v[188:191]
s_waitcnt lgkmcnt(2)
ds_read_b128 a[224:227], v4 offset:0
v_add_u32 v0, s86, v40
v_mfma_f32_16x16x32_bf16 v[180:183], a[104:107], a[212:215], v[188:191]
s_waitcnt lgkmcnt(2)
ds_read_b128 a[228:231], v4 offset:2048
v_add_u32 v13, s86, v41
v_mfma_f32_16x16x32_bf16 v[184:187], a[104:107], a[216:219], v[188:191]
s_waitcnt lgkmcnt(2)
ds_read_b128 a[232:235], v4 offset:4096
v_add_u32 v14, s86, v42
v_mfma_f32_16x16x32_bf16 v[188:191], a[104:107], a[220:223], v[188:191]
s_waitcnt vmcnt(24)
global_load_dwordx4 a[104:107], v2, s[20:21] offset:-4096 sc1
v_add_u32 v11, s86, v43
v_mfma_f32_16x16x32_bf16 v[192:195], a[108:111], a[208:211], v[204:207]
ds_read_b128 a[236:239], v4 offset:6144
s_add_u32 s16, s86, s27
v_mfma_f32_16x16x32_bf16 v[196:199], a[108:111], a[212:215], v[204:207]
v_add_u32 v36, s16, v1
v_add_u32 v37, 16384, v36
v_mfma_f32_16x16x32_bf16 v[200:203], a[108:111], a[216:219], v[204:207]
ds_read_b128 v[16:19], v40 offset:0
ds_read_b128 v[20:23], v41 offset:0
v_mfma_f32_16x16x32_bf16 v[204:207], a[108:111], a[220:223], v[204:207]
s_waitcnt vmcnt(24)
global_load_dwordx4 a[108:111], v2, s[20:21] offset:-3072 sc1
v_accvgpr_read_b32 v24, a0
v_mfma_f32_16x16x32_bf16 v[208:211], a[112:115], a[208:211], v[220:223]
v_accvgpr_read_b32 v25, a1
v_accvgpr_read_b32 v26, a2
v_mfma_f32_16x16x32_bf16 v[212:215], a[112:115], a[212:215], v[220:223]
v_accvgpr_read_b32 v27, a3
v_lshlrev_b32 v28, 16, v24
v_mfma_f32_16x16x32_bf16 v[216:219], a[112:115], a[216:219], v[220:223]
s_waitcnt lgkmcnt(1)
v_and_b32 v29, s25, v24
v_lshlrev_b32 v30, 16, v16
v_mfma_f32_16x16x32_bf16 v[220:223], a[112:115], a[220:223], v[220:223]
s_waitcnt vmcnt(24)
global_load_dwordx4 a[112:115], v2, s[20:21] offset:-2048 sc1
v_and_b32 v31, s25, v16
v_mfma_f32_16x16x32_bf16 v[224:227], a[116:119], a[208:211], v[236:239]
v_fma_f32 v48, v28, v48, v30
v_fma_f32 v64, v29, v64, v31
v_mfma_f32_16x16x32_bf16 v[228:231], a[116:119], a[212:215], v[236:239]
v_cvt_pk_bf16_f32 v48, v48, v64
v_accvgpr_write_b32 a240, v48
v_mfma_f32_16x16x32_bf16 v[232:235], a[116:119], a[216:219], v[236:239]
v_lshlrev_b32 v32, 16, v25
v_and_b32 v33, s25, v25
v_mfma_f32_16x16x32_bf16 v[236:239], a[116:119], a[220:223], v[236:239]
s_waitcnt vmcnt(24)
global_load_dwordx4 a[116:119], v2, s[20:21] offset:-1024 sc1
v_lshlrev_b32 v34, 16, v17
v_mfma_f32_16x16x32_bf16 v[240:243], a[120:123], a[208:211], v[252:255]
v_and_b32 v35, s25, v17
v_fma_f32 v80, v32, v80, v34
v_mfma_f32_16x16x32_bf16 v[244:247], a[120:123], a[212:215], v[252:255]
v_fma_f32 v96, v33, v96, v35
v_cvt_pk_bf16_f32 v80, v80, v96
v_mfma_f32_16x16x32_bf16 v[248:251], a[120:123], a[216:219], v[252:255]
v_accvgpr_write_b32 a241, v80
v_lshlrev_b32 v28, 16, v26
v_mfma_f32_16x16x32_bf16 v[252:255], a[120:123], a[220:223], v[252:255]
s_waitcnt vmcnt(24)
global_load_dwordx4 a[120:123], v2, s[20:21] offset:0 sc1
v_and_b32 v29, s25, v26
v_mfma_f32_16x16x32_bf16 v[176:179], a[124:127], a[224:227], v[176:179]
ds_read_b128 a[208:211], v5 offset:0
v_lshlrev_b32 v30, 16, v18
v_mfma_f32_16x16x32_bf16 v[180:183], a[124:127], a[228:231], v[180:183]
ds_read_b128 a[212:215], v5 offset:2048
v_and_b32 v31, s25, v18
v_mfma_f32_16x16x32_bf16 v[184:187], a[124:127], a[232:235], v[184:187]
ds_read_b128 a[216:219], v5 offset:4096
v_fma_f32 v112, v28, v112, v30
v_mfma_f32_16x16x32_bf16 v[188:191], a[124:127], a[236:239], v[188:191]
s_waitcnt vmcnt(24)
global_load_dwordx4 a[124:127], v2, s[20:21] offset:1024 sc1
v_fma_f32 v128, v29, v128, v31
v_mfma_f32_16x16x32_bf16 v[204:207], a[128:131], a[236:239], v[204:207]
ds_read_b128 a[220:223], v5 offset:6144
v_cvt_pk_bf16_f32 v112, v112, v128
v_mfma_f32_16x16x32_bf16 v[200:203], a[128:131], a[232:235], v[200:203]
v_accvgpr_write_b32 a242, v112
v_lshlrev_b32 v32, 16, v27
v_mfma_f32_16x16x32_bf16 v[196:199], a[128:131], a[228:231], v[196:199]
v_and_b32 v33, s25, v27
v_lshlrev_b32 v34, 16, v19
v_mfma_f32_16x16x32_bf16 v[192:195], a[128:131], a[224:227], v[192:195]
s_waitcnt vmcnt(24)
global_load_dwordx4 a[128:131], v2, s[20:21] offset:2048 sc1
v_and_b32 v35, s25, v19
v_mfma_f32_16x16x32_bf16 v[208:211], a[132:135], a[224:227], v[208:211]
v_fma_f32 v144, v32, v144, v34
v_fma_f32 v160, v33, v160, v35
v_mfma_f32_16x16x32_bf16 v[212:215], a[132:135], a[228:231], v[212:215]
v_cvt_pk_bf16_f32 v144, v144, v160
v_accvgpr_write_b32 a243, v144
v_mfma_f32_16x16x32_bf16 v[216:219], a[132:135], a[232:235], v[216:219]
v_mfma_f32_16x16x32_bf16 v[220:223], a[132:135], a[236:239], v[220:223]
s_waitcnt vmcnt(24)
global_load_dwordx4 a[132:135], v2, s[20:21] offset:3072 sc1
v_add_u32 v2, 8192, v2
v_mfma_f32_16x16x32_bf16 v[236:239], a[136:139], a[236:239], v[236:239]
ds_read_b128 v[16:19], v42 offset:0
v_accvgpr_read_b32 v24, a16
v_mfma_f32_16x16x32_bf16 v[232:235], a[136:139], a[232:235], v[232:235]
v_accvgpr_read_b32 v25, a17
v_accvgpr_read_b32 v26, a18
v_mfma_f32_16x16x32_bf16 v[228:231], a[136:139], a[228:231], v[228:231]
v_accvgpr_read_b32 v27, a19
v_lshlrev_b32 v28, 16, v24
v_mfma_f32_16x16x32_bf16 v[224:227], a[136:139], a[224:227], v[224:227]
s_waitcnt vmcnt(24)
global_load_dwordx4 a[136:139], v2, s[20:21] offset:-4096 sc1
v_and_b32 v29, s25, v24
v_mfma_f32_16x16x32_bf16 v[240:243], a[140:143], a[224:227], v[240:243]
s_waitcnt lgkmcnt(5)
v_lshlrev_b32 v30, 16, v20
v_and_b32 v31, s25, v20
v_mfma_f32_16x16x32_bf16 v[244:247], a[140:143], a[228:231], v[244:247]
v_fma_f32 v49, v28, v49, v30
v_fma_f32 v65, v29, v65, v31
v_mfma_f32_16x16x32_bf16 v[248:251], a[140:143], a[232:235], v[248:251]
v_cvt_pk_bf16_f32 v49, v49, v65
v_accvgpr_write_b32 a244, v49
v_mfma_f32_16x16x32_bf16 v[252:255], a[140:143], a[236:239], v[252:255]
s_waitcnt vmcnt(24) lgkmcnt(4)
global_load_dwordx4 a[140:143], v2, s[20:21] offset:-3072 sc1
v_lshlrev_b32 v32, 16, v25
v_mfma_f32_16x16x32_bf16 v[176:179], a[144:147], a[208:211], v[176:179]
s_waitcnt lgkmcnt(3)
ds_read_b128 a[224:227], v6 offset:0
v_and_b32 v33, s25, v25
v_mfma_f32_16x16x32_bf16 v[180:183], a[144:147], a[212:215], v[180:183]
s_waitcnt lgkmcnt(3)
ds_read_b128 a[228:231], v6 offset:2048
v_lshlrev_b32 v34, 16, v21
v_mfma_f32_16x16x32_bf16 v[184:187], a[144:147], a[216:219], v[184:187]
s_waitcnt lgkmcnt(3)
ds_read_b128 a[232:235], v6 offset:4096
v_and_b32 v35, s25, v21
v_mfma_f32_16x16x32_bf16 v[188:191], a[144:147], a[220:223], v[188:191]
s_waitcnt vmcnt(24)
global_load_dwordx4 a[144:147], v2, s[20:21] offset:-2048 sc1
v_fma_f32 v81, v32, v81, v34
v_mfma_f32_16x16x32_bf16 v[204:207], a[148:151], a[220:223], v[204:207]
ds_read_b128 a[236:239], v6 offset:6144
v_fma_f32 v97, v33, v97, v35
v_mfma_f32_16x16x32_bf16 v[200:203], a[148:151], a[216:219], v[200:203]
v_cvt_pk_bf16_f32 v81, v81, v97
v_accvgpr_write_b32 a245, v81
v_mfma_f32_16x16x32_bf16 v[196:199], a[148:151], a[212:215], v[196:199]
v_lshlrev_b32 v28, 16, v26
v_and_b32 v29, s25, v26
v_mfma_f32_16x16x32_bf16 v[192:195], a[148:151], a[208:211], v[192:195]
s_waitcnt vmcnt(24)
global_load_dwordx4 a[148:151], v2, s[20:21] offset:-1024 sc1
v_lshlrev_b32 v30, 16, v22
v_mfma_f32_16x16x32_bf16 v[208:211], a[152:155], a[208:211], v[208:211]
v_and_b32 v31, s25, v22
v_fma_f32 v113, v28, v113, v30
v_mfma_f32_16x16x32_bf16 v[212:215], a[152:155], a[212:215], v[212:215]
v_fma_f32 v129, v29, v129, v31
v_cvt_pk_bf16_f32 v113, v113, v129
v_mfma_f32_16x16x32_bf16 v[216:219], a[152:155], a[216:219], v[216:219]
v_accvgpr_write_b32 a246, v113
v_lshlrev_b32 v32, 16, v27
v_mfma_f32_16x16x32_bf16 v[220:223], a[152:155], a[220:223], v[220:223]
s_waitcnt vmcnt(24)
global_load_dwordx4 a[152:155], v2, s[20:21] offset:0 sc1
v_and_b32 v33, s25, v27
v_mfma_f32_16x16x32_bf16 v[236:239], a[156:159], a[220:223], v[236:239]
v_lshlrev_b32 v34, 16, v23
v_and_b32 v35, s25, v23
v_mfma_f32_16x16x32_bf16 v[232:235], a[156:159], a[216:219], v[232:235]
v_fma_f32 v145, v32, v145, v34
v_fma_f32 v161, v33, v161, v35
v_mfma_f32_16x16x32_bf16 v[228:231], a[156:159], a[212:215], v[228:231]
v_cvt_pk_bf16_f32 v145, v145, v161
v_accvgpr_write_b32 a247, v145
v_mfma_f32_16x16x32_bf16 v[224:227], a[156:159], a[208:211], v[224:227]
s_waitcnt vmcnt(24)
global_load_dwordx4 a[156:159], v2, s[20:21] offset:1024 sc1
v_mfma_f32_16x16x32_bf16 v[240:243], a[160:163], a[208:211], v[240:243]
v_mfma_f32_16x16x32_bf16 v[244:247], a[160:163], a[212:215], v[244:247]
v_mfma_f32_16x16x32_bf16 v[248:251], a[160:163], a[216:219], v[248:251]
v_mfma_f32_16x16x32_bf16 v[252:255], a[160:163], a[220:223], v[252:255]
s_waitcnt vmcnt(24) lgkmcnt(3)
global_load_dwordx4 a[160:163], v2, s[20:21] offset:2048 sc1
v_mfma_f32_16x16x32_bf16 v[176:179], a[164:167], a[224:227], v[176:179]
s_waitcnt lgkmcnt(2)
ds_read_b128 a[208:211], v44 offset:0
v_mfma_f32_16x16x32_bf16 v[180:183], a[164:167], a[228:231], v[180:183]
s_waitcnt lgkmcnt(2)
ds_read_b128 a[212:215], v44 offset:2048
v_mfma_f32_16x16x32_bf16 v[184:187], a[164:167], a[232:235], v[184:187]
s_waitcnt lgkmcnt(2)
ds_read_b128 a[216:219], v44 offset:4096
ds_read_b128 v[20:23], v43 offset:0
v_mfma_f32_16x16x32_bf16 v[188:191], a[164:167], a[236:239], v[188:191]
s_waitcnt vmcnt(24)
global_load_dwordx4 a[164:167], v2, s[20:21] offset:3072 sc1
v_add_u32 v2, 8192, v2
v_mfma_f32_16x16x32_bf16 v[204:207], a[168:171], a[236:239], v[204:207]
ds_read_b128 a[220:223], v44 offset:6144
v_accvgpr_read_b32 v24, a32
v_mfma_f32_16x16x32_bf16 v[200:203], a[168:171], a[232:235], v[200:203]
v_accvgpr_read_b32 v25, a33
v_accvgpr_read_b32 v26, a34
v_mfma_f32_16x16x32_bf16 v[196:199], a[168:171], a[228:231], v[196:199]
v_accvgpr_read_b32 v27, a35
v_lshlrev_b32 v28, 16, v24
v_mfma_f32_16x16x32_bf16 v[192:195], a[168:171], a[224:227], v[192:195]
s_waitcnt vmcnt(24)
global_load_dwordx4 a[168:171], v2, s[20:21] offset:-4096 sc1
v_and_b32 v29, s25, v24
v_mfma_f32_16x16x32_bf16 v[208:211], a[172:175], a[224:227], v[208:211]
v_lshlrev_b32 v30, 16, v16
v_and_b32 v31, s25, v16
v_mfma_f32_16x16x32_bf16 v[212:215], a[172:175], a[228:231], v[212:215]
v_fma_f32 v50, v28, v50, v30
v_fma_f32 v66, v29, v66, v31
v_mfma_f32_16x16x32_bf16 v[216:219], a[172:175], a[232:235], v[216:219]
v_cvt_pk_bf16_f32 v50, v50, v66
v_accvgpr_write_b32 a248, v50
v_mfma_f32_16x16x32_bf16 v[220:223], a[172:175], a[236:239], v[220:223]
s_waitcnt vmcnt(24)
global_load_dwordx4 a[172:175], v2, s[20:21] offset:-3072 sc1
v_lshlrev_b32 v32, 16, v25
v_mfma_f32_16x16x32_bf16 v[236:239], a[176:179], a[236:239], v[236:239]
v_and_b32 v33, s25, v25
v_lshlrev_b32 v34, 16, v17
v_mfma_f32_16x16x32_bf16 v[232:235], a[176:179], a[232:235], v[232:235]
v_and_b32 v35, s25, v17
v_fma_f32 v82, v32, v82, v34
v_mfma_f32_16x16x32_bf16 v[228:231], a[176:179], a[228:231], v[228:231]
v_fma_f32 v98, v33, v98, v35
v_cvt_pk_bf16_f32 v82, v82, v98
v_mfma_f32_16x16x32_bf16 v[224:227], a[176:179], a[224:227], v[224:227]
s_waitcnt vmcnt(24)
global_load_dwordx4 a[176:179], v2, s[20:21] offset:-2048 sc1
v_accvgpr_write_b32 a249, v82
v_mfma_f32_16x16x32_bf16 v[240:243], a[180:183], a[224:227], v[240:243]
v_lshlrev_b32 v28, 16, v26
v_and_b32 v29, s25, v26
v_mfma_f32_16x16x32_bf16 v[244:247], a[180:183], a[228:231], v[244:247]
v_lshlrev_b32 v30, 16, v18
v_and_b32 v31, s25, v18
v_mfma_f32_16x16x32_bf16 v[248:251], a[180:183], a[232:235], v[248:251]
v_fma_f32 v114, v28, v114, v30
v_fma_f32 v130, v29, v130, v31
v_mfma_f32_16x16x32_bf16 v[252:255], a[180:183], a[236:239], v[252:255]
s_waitcnt vmcnt(24) lgkmcnt(4)
global_load_dwordx4 a[180:183], v2, s[20:21] offset:-1024 sc1
v_cvt_pk_bf16_f32 v114, v114, v130
v_mfma_f32_16x16x32_bf16 v[176:179], a[184:187], a[208:211], v[176:179]
s_waitcnt lgkmcnt(3)
ds_read_b128 a[224:227], v45 offset:0
v_accvgpr_write_b32 a250, v114
v_mfma_f32_16x16x32_bf16 v[180:183], a[184:187], a[212:215], v[180:183]
s_waitcnt lgkmcnt(3)
ds_read_b128 a[228:231], v45 offset:2048
v_lshlrev_b32 v32, 16, v27
v_mfma_f32_16x16x32_bf16 v[184:187], a[184:187], a[216:219], v[184:187]
s_waitcnt lgkmcnt(2)
ds_read_b128 a[232:235], v45 offset:4096
v_and_b32 v33, s25, v27
v_mfma_f32_16x16x32_bf16 v[188:191], a[184:187], a[220:223], v[188:191]
s_waitcnt vmcnt(24)
global_load_dwordx4 a[184:187], v2, s[20:21] offset:0 sc1
v_lshlrev_b32 v34, 16, v19
v_mfma_f32_16x16x32_bf16 v[204:207], a[188:191], a[220:223], v[204:207]
ds_read_b128 a[236:239], v45 offset:6144
v_and_b32 v35, s25, v19
v_mfma_f32_16x16x32_bf16 v[200:203], a[188:191], a[216:219], v[200:203]
v_fma_f32 v146, v32, v146, v34
v_fma_f32 v162, v33, v162, v35
v_mfma_f32_16x16x32_bf16 v[196:199], a[188:191], a[212:215], v[196:199]
v_cvt_pk_bf16_f32 v146, v146, v162
v_accvgpr_write_b32 a251, v146
v_mfma_f32_16x16x32_bf16 v[192:195], a[188:191], a[208:211], v[192:195]
s_waitcnt vmcnt(24)
global_load_dwordx4 a[188:191], v2, s[20:21] offset:1024 sc1
v_mfma_f32_16x16x32_bf16 v[208:211], a[192:195], a[208:211], v[208:211]
v_mfma_f32_16x16x32_bf16 v[212:215], a[192:195], a[212:215], v[212:215]
v_mfma_f32_16x16x32_bf16 v[216:219], a[192:195], a[216:219], v[216:219]
v_mfma_f32_16x16x32_bf16 v[220:223], a[192:195], a[220:223], v[220:223]
s_waitcnt vmcnt(24)
global_load_dwordx4 a[192:195], v2, s[20:21] offset:2048 sc1
v_mfma_f32_16x16x32_bf16 v[236:239], a[196:199], a[220:223], v[236:239]
v_mfma_f32_16x16x32_bf16 v[232:235], a[196:199], a[216:219], v[232:235]
ds_read_b128 v[16:19], v40 offset:2048
v_accvgpr_read_b32 v24, a48
v_mfma_f32_16x16x32_bf16 v[228:231], a[196:199], a[212:215], v[228:231]
v_accvgpr_read_b32 v25, a49
v_accvgpr_read_b32 v26, a50
v_mfma_f32_16x16x32_bf16 v[224:227], a[196:199], a[208:211], v[224:227]
s_waitcnt vmcnt(24)
global_load_dwordx4 a[196:199], v2, s[20:21] offset:3072 sc1
v_add_u32 v2, 8192, v2
v_mfma_f32_16x16x32_bf16 v[240:243], a[200:203], a[208:211], v[240:243]
v_accvgpr_read_b32 v27, a51
v_lshlrev_b32 v28, 16, v24
v_mfma_f32_16x16x32_bf16 v[244:247], a[200:203], a[212:215], v[244:247]
v_and_b32 v29, s25, v24
v_lshlrev_b32 v30, 16, v20
v_mfma_f32_16x16x32_bf16 v[248:251], a[200:203], a[216:219], v[248:251]
v_and_b32 v31, s25, v20
v_fma_f32 v51, v28, v51, v30
v_mfma_f32_16x16x32_bf16 v[252:255], a[200:203], a[220:223], v[252:255]
s_waitcnt vmcnt(24) lgkmcnt(4)
global_load_dwordx4 a[200:203], v2, s[20:21] offset:-4096 sc1
v_fma_f32 v67, v29, v67, v31
v_mfma_f32_16x16x32_bf16 v[176:179], a[204:207], a[224:227], v[176:179]
s_waitcnt lgkmcnt(3)
ds_read_b128 a[208:211], v46 offset:0
v_cvt_pk_bf16_f32 v51, v51, v67
v_mfma_f32_16x16x32_bf16 v[180:183], a[204:207], a[228:231], v[180:183]
s_waitcnt lgkmcnt(3)
ds_read_b128 a[212:215], v46 offset:2048
v_accvgpr_write_b32 a252, v51
v_mfma_f32_16x16x32_bf16 v[184:187], a[204:207], a[232:235], v[184:187]
s_waitcnt lgkmcnt(3)
ds_read_b128 a[216:219], v46 offset:4096
v_lshlrev_b32 v32, 16, v25
v_mfma_f32_16x16x32_bf16 v[188:191], a[204:207], a[236:239], v[188:191]
s_waitcnt vmcnt(24)
global_load_dwordx4 a[204:207], v2, s[20:21] offset:-3072 sc1
v_and_b32 v33, s25, v25
v_mfma_f32_16x16x32_bf16 v[204:207], a[104:107], a[236:239], v[204:207]
ds_read_b128 a[220:223], v46 offset:6144
v_lshlrev_b32 v34, 16, v21
v_mfma_f32_16x16x32_bf16 v[200:203], a[104:107], a[232:235], v[200:203]
v_and_b32 v35, s25, v21
v_fma_f32 v83, v32, v83, v34
v_mfma_f32_16x16x32_bf16 v[196:199], a[104:107], a[228:231], v[196:199]
v_fma_f32 v99, v33, v99, v35
v_cvt_pk_bf16_f32 v83, v83, v99
v_mfma_f32_16x16x32_bf16 v[192:195], a[104:107], a[224:227], v[192:195]
s_waitcnt vmcnt(24)
global_load_dwordx4 a[104:107], v2, s[20:21] offset:-2048 sc1
v_accvgpr_write_b32 a253, v83
v_mfma_f32_16x16x32_bf16 v[208:211], a[108:111], a[224:227], v[208:211]
v_lshlrev_b32 v28, 16, v26
v_and_b32 v29, s25, v26
v_mfma_f32_16x16x32_bf16 v[212:215], a[108:111], a[228:231], v[212:215]
v_lshlrev_b32 v30, 16, v22
v_and_b32 v31, s25, v22
v_mfma_f32_16x16x32_bf16 v[216:219], a[108:111], a[232:235], v[216:219]
v_fma_f32 v115, v28, v115, v30
v_fma_f32 v131, v29, v131, v31
v_mfma_f32_16x16x32_bf16 v[220:223], a[108:111], a[236:239], v[220:223]
s_waitcnt vmcnt(24)
global_load_dwordx4 a[108:111], v2, s[20:21] offset:-1024 sc1
v_cvt_pk_bf16_f32 v115, v115, v131
v_mfma_f32_16x16x32_bf16 v[236:239], a[112:115], a[236:239], v[236:239]
v_accvgpr_write_b32 a254, v115
v_lshlrev_b32 v32, 16, v27
v_mfma_f32_16x16x32_bf16 v[232:235], a[112:115], a[232:235], v[232:235]
v_and_b32 v33, s25, v27
v_lshlrev_b32 v34, 16, v23
v_mfma_f32_16x16x32_bf16 v[228:231], a[112:115], a[228:231], v[228:231]
v_and_b32 v35, s25, v23
v_fma_f32 v147, v32, v147, v34
v_mfma_f32_16x16x32_bf16 v[224:227], a[112:115], a[224:227], v[224:227]
s_waitcnt vmcnt(24)
global_load_dwordx4 a[112:115], v2, s[20:21] offset:0 sc1
v_fma_f32 v163, v33, v163, v35
v_mfma_f32_16x16x32_bf16 v[240:243], a[116:119], a[224:227], v[240:243]
v_cvt_pk_bf16_f32 v147, v147, v163
v_accvgpr_write_b32 a255, v147
v_mfma_f32_16x16x32_bf16 v[244:247], a[116:119], a[228:231], v[244:247]
ds_write_b128 v0, a[240:243]
v_mfma_f32_16x16x32_bf16 v[248:251], a[116:119], a[232:235], v[248:251]
ds_write_b128 v13, a[244:247]
v_mfma_f32_16x16x32_bf16 v[252:255], a[116:119], a[236:239], v[252:255]
s_waitcnt vmcnt(24) lgkmcnt(5)
global_load_dwordx4 a[116:119], v2, s[20:21] offset:1024 sc1
v_mfma_f32_16x16x32_bf16 v[176:179], a[120:123], a[208:211], v[176:179]
s_waitcnt lgkmcnt(4)
ds_read_b128 a[224:227], v47 offset:0
v_mfma_f32_16x16x32_bf16 v[180:183], a[120:123], a[212:215], v[180:183]
s_waitcnt lgkmcnt(4)
ds_read_b128 a[228:231], v47 offset:2048
v_mfma_f32_16x16x32_bf16 v[184:187], a[120:123], a[216:219], v[184:187]
s_waitcnt lgkmcnt(4)
ds_read_b128 a[232:235], v47 offset:4096
v_mfma_f32_16x16x32_bf16 v[188:191], a[120:123], a[220:223], v[188:191]
s_waitcnt vmcnt(24)
global_load_dwordx4 a[120:123], v2, s[20:21] offset:2048 sc1
v_mfma_f32_16x16x32_bf16 v[204:207], a[124:127], a[220:223], v[204:207]
ds_read_b128 a[236:239], v47 offset:6144
v_mfma_f32_16x16x32_bf16 v[200:203], a[124:127], a[216:219], v[200:203]
ds_write_b128 v14, a[248:251]
v_mfma_f32_16x16x32_bf16 v[196:199], a[124:127], a[212:215], v[196:199]
ds_write_b128 v11, a[252:255]
v_mfma_f32_16x16x32_bf16 v[192:195], a[124:127], a[208:211], v[192:195]
s_waitcnt vmcnt(24)
global_load_dwordx4 a[124:127], v2, s[20:21] offset:3072 sc1
v_add_u32 v2, 8192, v2
v_mfma_f32_16x16x32_bf16 v[208:211], a[128:131], a[208:211], v[208:211]
ds_read_b128 a[240:243], v36 offset:0
ds_read_b128 a[244:247], v36 offset:1024
v_mfma_f32_16x16x32_bf16 v[212:215], a[128:131], a[212:215], v[212:215]
ds_read_b128 a[248:251], v36 offset:8192
ds_read_b128 a[252:255], v36 offset:9216
v_mfma_f32_16x16x32_bf16 v[216:219], a[128:131], a[216:219], v[216:219]
ds_read_b128 v[20:23], v41 offset:2048
v_accvgpr_read_b32 v24, a4
v_mfma_f32_16x16x32_bf16 v[220:223], a[128:131], a[220:223], v[220:223]
s_waitcnt vmcnt(24)
global_load_dwordx4 a[128:131], v2, s[20:21] offset:-4096 sc1
v_accvgpr_read_b32 v25, a5
v_mfma_f32_16x16x32_bf16 v[236:239], a[132:135], a[220:223], v[236:239]
v_accvgpr_read_b32 v26, a6
v_accvgpr_read_b32 v27, a7
v_mfma_f32_16x16x32_bf16 v[232:235], a[132:135], a[216:219], v[232:235]
v_lshlrev_b32 v28, 16, v24
v_and_b32 v29, s25, v24
v_mfma_f32_16x16x32_bf16 v[228:231], a[132:135], a[212:215], v[228:231]
v_lshlrev_b32 v30, 16, v16
v_and_b32 v31, s25, v16
v_mfma_f32_16x16x32_bf16 v[224:227], a[132:135], a[208:211], v[224:227]
s_waitcnt vmcnt(24)
global_load_dwordx4 a[132:135], v2, s[20:21] offset:-3072 sc1
v_fma_f32 v52, v28, v52, v30
v_mfma_f32_16x16x32_bf16 v[240:243], a[136:139], a[208:211], v[240:243]
v_fma_f32 v68, v29, v68, v31
v_cvt_pk_bf16_f32 v48, v52, v68
v_mfma_f32_16x16x32_bf16 v[244:247], a[136:139], a[212:215], v[244:247]
v_lshlrev_b32 v32, 16, v25
v_and_b32 v33, s25, v25
v_mfma_f32_16x16x32_bf16 v[248:251], a[136:139], a[216:219], v[248:251]
v_lshlrev_b32 v34, 16, v17
v_and_b32 v35, s25, v17
v_mfma_f32_16x16x32_bf16 v[252:255], a[136:139], a[220:223], v[252:255]
s_waitcnt vmcnt(24) lgkmcnt(10)
global_load_dwordx4 a[136:139], v2, s[20:21] offset:-2048 sc1
v_fma_f32 v84, v32, v84, v34
v_mfma_f32_16x16x32_bf16 v[176:179], a[140:143], a[224:227], v[176:179]
s_waitcnt lgkmcnt(9)
ds_read_b128 a[208:211], v3 offset:8192
v_fma_f32 v100, v33, v100, v35
v_mfma_f32_16x16x32_bf16 v[180:183], a[140:143], a[228:231], v[180:183]
s_waitcnt lgkmcnt(9)
ds_read_b128 a[212:215], v3 offset:10240
v_cvt_pk_bf16_f32 v49, v84, v100
v_mfma_f32_16x16x32_bf16 v[184:187], a[140:143], a[232:235], v[184:187]
s_waitcnt lgkmcnt(9)
ds_read_b128 a[216:219], v3 offset:12288
v_lshlrev_b32 v28, 16, v26
v_mfma_f32_16x16x32_bf16 v[188:191], a[140:143], a[236:239], v[188:191]
s_waitcnt vmcnt(24)
global_load_dwordx4 a[140:143], v2, s[20:21] offset:-1024 sc1
v_and_b32 v29, s25, v26
v_mfma_f32_16x16x32_bf16 v[204:207], a[144:147], a[236:239], v[204:207]
ds_read_b128 a[220:223], v3 offset:14336
v_lshlrev_b32 v30, 16, v18
v_mfma_f32_16x16x32_bf16 v[200:203], a[144:147], a[232:235], v[200:203]
v_and_b32 v31, s25, v18
v_fma_f32 v116, v28, v116, v30
v_mfma_f32_16x16x32_bf16 v[196:199], a[144:147], a[228:231], v[196:199]
v_fma_f32 v132, v29, v132, v31
v_cvt_pk_bf16_f32 v50, v116, v132
v_mfma_f32_16x16x32_bf16 v[192:195], a[144:147], a[224:227], v[192:195]
s_waitcnt vmcnt(24)
global_load_dwordx4 a[144:147], v2, s[20:21] offset:0 sc1
v_lshlrev_b32 v32, 16, v27
v_mfma_f32_16x16x32_bf16 v[208:211], a[148:151], a[224:227], v[208:211]
v_and_b32 v33, s25, v27
v_lshlrev_b32 v34, 16, v19
v_mfma_f32_16x16x32_bf16 v[212:215], a[148:151], a[228:231], v[212:215]
v_and_b32 v35, s25, v19
v_fma_f32 v148, v32, v148, v34
v_mfma_f32_16x16x32_bf16 v[216:219], a[148:151], a[232:235], v[216:219]
v_fma_f32 v164, v33, v164, v35
v_cvt_pk_bf16_f32 v51, v148, v164
v_mfma_f32_16x16x32_bf16 v[220:223], a[148:151], a[236:239], v[220:223]
s_waitcnt vmcnt(24)
global_load_dwordx4 a[148:151], v2, s[20:21] offset:1024 sc1
v_mfma_f32_16x16x32_bf16 v[236:239], a[152:155], a[236:239], v[236:239]
s_waitcnt lgkmcnt(8)
global_store_dwordx4 v9, a[240:243], s[48:49] offset:0 nt
v_mfma_f32_16x16x32_bf16 v[232:235], a[152:155], a[232:235], v[232:235]
s_waitcnt lgkmcnt(7)
global_store_dwordx4 v10, a[244:247], s[48:49] offset:0 nt
v_mfma_f32_16x16x32_bf16 v[228:231], a[152:155], a[228:231], v[228:231]
s_waitcnt lgkmcnt(6)
global_store_dwordx4 v9, a[248:251], s[48:49] offset:128 nt
v_mfma_f32_16x16x32_bf16 v[224:227], a[152:155], a[224:227], v[224:227]
s_waitcnt vmcnt(27)
global_load_dwordx4 a[152:155], v2, s[20:21] offset:2048 sc1
v_mfma_f32_16x16x32_bf16 v[240:243], a[156:159], a[224:227], v[240:243]
s_waitcnt lgkmcnt(5)
global_store_dwordx4 v10, a[252:255], s[48:49] offset:128 nt
v_mfma_f32_16x16x32_bf16 v[244:247], a[156:159], a[228:231], v[244:247]
ds_read_b128 v[16:19], v42 offset:2048
v_accvgpr_read_b32 v24, a20
v_mfma_f32_16x16x32_bf16 v[248:251], a[156:159], a[232:235], v[248:251]
v_accvgpr_read_b32 v25, a21
v_accvgpr_read_b32 v26, a22
v_mfma_f32_16x16x32_bf16 v[252:255], a[156:159], a[236:239], v[252:255]
s_waitcnt vmcnt(28) lgkmcnt(4)
global_load_dwordx4 a[156:159], v2, s[20:21] offset:3072 sc1
v_add_u32 v2, 8192, v2
v_mfma_f32_16x16x32_bf16 v[176:179], a[160:163], a[208:211], v[176:179]
s_waitcnt lgkmcnt(3)
ds_read_b128 a[224:227], v4 offset:8192
v_accvgpr_read_b32 v27, a23
v_mfma_f32_16x16x32_bf16 v[180:183], a[160:163], a[212:215], v[180:183]
s_waitcnt lgkmcnt(3)
ds_read_b128 a[228:231], v4 offset:10240
v_lshlrev_b32 v28, 16, v24
v_mfma_f32_16x16x32_bf16 v[184:187], a[160:163], a[216:219], v[184:187]
s_waitcnt lgkmcnt(3)
ds_read_b128 a[232:235], v4 offset:12288
v_and_b32 v29, s25, v24
v_mfma_f32_16x16x32_bf16 v[188:191], a[160:163], a[220:223], v[188:191]
s_waitcnt vmcnt(28)
global_load_dwordx4 a[160:163], v2, s[20:21] offset:-4096 sc1
v_lshlrev_b32 v30, 16, v20
v_mfma_f32_16x16x32_bf16 v[204:207], a[164:167], a[220:223], v[204:207]
ds_read_b128 a[236:239], v4 offset:14336
v_and_b32 v31, s25, v20
v_mfma_f32_16x16x32_bf16 v[200:203], a[164:167], a[216:219], v[200:203]
v_fma_f32 v53, v28, v53, v30
v_fma_f32 v69, v29, v69, v31
v_mfma_f32_16x16x32_bf16 v[196:199], a[164:167], a[212:215], v[196:199]
v_cvt_pk_bf16_f32 v64, v53, v69
v_lshlrev_b32 v32, 16, v25
v_mfma_f32_16x16x32_bf16 v[192:195], a[164:167], a[208:211], v[192:195]
s_waitcnt vmcnt(28)
global_load_dwordx4 a[164:167], v2, s[20:21] offset:-3072 sc1
v_and_b32 v33, s25, v25
v_mfma_f32_16x16x32_bf16 v[208:211], a[168:171], a[208:211], v[208:211]
v_lshlrev_b32 v34, 16, v21
v_and_b32 v35, s25, v21
v_mfma_f32_16x16x32_bf16 v[212:215], a[168:171], a[212:215], v[212:215]
v_fma_f32 v85, v32, v85, v34
v_fma_f32 v101, v33, v101, v35
v_mfma_f32_16x16x32_bf16 v[216:219], a[168:171], a[216:219], v[216:219]
v_cvt_pk_bf16_f32 v65, v85, v101
v_lshlrev_b32 v28, 16, v26
v_mfma_f32_16x16x32_bf16 v[220:223], a[168:171], a[220:223], v[220:223]
s_waitcnt vmcnt(28)
global_load_dwordx4 a[168:171], v2, s[20:21] offset:-2048 sc1
v_and_b32 v29, s25, v26
v_mfma_f32_16x16x32_bf16 v[236:239], a[172:175], a[220:223], v[236:239]
v_lshlrev_b32 v30, 16, v22
v_and_b32 v31, s25, v22
v_mfma_f32_16x16x32_bf16 v[232:235], a[172:175], a[216:219], v[232:235]
v_fma_f32 v117, v28, v117, v30
v_fma_f32 v133, v29, v133, v31
v_mfma_f32_16x16x32_bf16 v[228:231], a[172:175], a[212:215], v[228:231]
v_cvt_pk_bf16_f32 v66, v117, v133
v_lshlrev_b32 v32, 16, v27
v_mfma_f32_16x16x32_bf16 v[224:227], a[172:175], a[208:211], v[224:227]
s_waitcnt vmcnt(28)
global_load_dwordx4 a[172:175], v2, s[20:21] offset:-1024 sc1
v_and_b32 v33, s25, v27
v_mfma_f32_16x16x32_bf16 v[240:243], a[176:179], a[208:211], v[240:243]
v_lshlrev_b32 v34, 16, v23
v_and_b32 v35, s25, v23
v_mfma_f32_16x16x32_bf16 v[244:247], a[176:179], a[212:215], v[244:247]
v_fma_f32 v149, v32, v149, v34
v_fma_f32 v165, v33, v165, v35
v_mfma_f32_16x16x32_bf16 v[248:251], a[176:179], a[216:219], v[248:251]
v_cvt_pk_bf16_f32 v67, v149, v165
v_mfma_f32_16x16x32_bf16 v[252:255], a[176:179], a[220:223], v[252:255]
s_waitcnt vmcnt(28) lgkmcnt(3)
global_load_dwordx4 a[176:179], v2, s[20:21] offset:0 sc1
v_mfma_f32_16x16x32_bf16 v[176:179], a[180:183], a[224:227], v[176:179]
s_waitcnt lgkmcnt(2)
ds_read_b128 a[208:211], v5 offset:8192
v_mfma_f32_16x16x32_bf16 v[180:183], a[180:183], a[228:231], v[180:183]
s_waitcnt lgkmcnt(2)
ds_read_b128 a[212:215], v5 offset:10240
v_mfma_f32_16x16x32_bf16 v[184:187], a[180:183], a[232:235], v[184:187]
s_waitcnt lgkmcnt(2)
ds_read_b128 a[216:219], v5 offset:12288
v_mfma_f32_16x16x32_bf16 v[188:191], a[180:183], a[236:239], v[188:191]
s_waitcnt vmcnt(28)
global_load_dwordx4 a[180:183], v2, s[20:21] offset:1024 sc1
v_mfma_f32_16x16x32_bf16 v[204:207], a[184:187], a[236:239], v[204:207]
ds_read_b128 a[220:223], v5 offset:14336
v_mfma_f32_16x16x32_bf16 v[200:203], a[184:187], a[232:235], v[200:203]
v_mfma_f32_16x16x32_bf16 v[196:199], a[184:187], a[228:231], v[196:199]
v_mfma_f32_16x16x32_bf16 v[192:195], a[184:187], a[224:227], v[192:195]
s_waitcnt vmcnt(28)
global_load_dwordx4 a[184:187], v2, s[20:21] offset:2048 sc1
ds_read_b128 v[20:23], v43 offset:2048
v_mfma_f32_16x16x32_bf16 v[208:211], a[188:191], a[224:227], v[208:211]
v_accvgpr_read_b32 v24, a36
v_accvgpr_read_b32 v25, a37
v_mfma_f32_16x16x32_bf16 v[212:215], a[188:191], a[228:231], v[212:215]
v_accvgpr_read_b32 v26, a38
v_accvgpr_read_b32 v27, a39
v_mfma_f32_16x16x32_bf16 v[216:219], a[188:191], a[232:235], v[216:219]
v_lshlrev_b32 v28, 16, v24
v_and_b32 v29, s25, v24
v_mfma_f32_16x16x32_bf16 v[220:223], a[188:191], a[236:239], v[220:223]
s_waitcnt vmcnt(28)
global_load_dwordx4 a[188:191], v2, s[20:21] offset:3072 sc1
v_add_u32 v2, 8192, v2
v_mfma_f32_16x16x32_bf16 v[236:239], a[192:195], a[236:239], v[236:239]
v_lshlrev_b32 v30, 16, v16
v_and_b32 v31, s25, v16
v_mfma_f32_16x16x32_bf16 v[232:235], a[192:195], a[232:235], v[232:235]
v_fma_f32 v54, v28, v54, v30
v_fma_f32 v70, v29, v70, v31
v_mfma_f32_16x16x32_bf16 v[228:231], a[192:195], a[228:231], v[228:231]
v_cvt_pk_bf16_f32 v80, v54, v70
v_lshlrev_b32 v32, 16, v25
v_mfma_f32_16x16x32_bf16 v[224:227], a[192:195], a[224:227], v[224:227]
s_waitcnt vmcnt(28)
global_load_dwordx4 a[192:195], v2, s[20:21] offset:-4096 sc1
v_and_b32 v33, s25, v25
v_mfma_f32_16x16x32_bf16 v[240:243], a[196:199], a[224:227], v[240:243]
v_lshlrev_b32 v34, 16, v17
v_and_b32 v35, s25, v17
v_mfma_f32_16x16x32_bf16 v[244:247], a[196:199], a[228:231], v[244:247]
v_fma_f32 v86, v32, v86, v34
v_fma_f32 v102, v33, v102, v35
v_mfma_f32_16x16x32_bf16 v[248:251], a[196:199], a[232:235], v[248:251]
v_cvt_pk_bf16_f32 v81, v86, v102
v_lshlrev_b32 v28, 16, v26
v_mfma_f32_16x16x32_bf16 v[252:255], a[196:199], a[236:239], v[252:255]
s_waitcnt vmcnt(28) lgkmcnt(4)
global_load_dwordx4 a[196:199], v2, s[20:21] offset:-3072 sc1
v_and_b32 v29, s25, v26
v_mfma_f32_16x16x32_bf16 v[176:179], a[200:203], a[208:211], v[176:179]
s_waitcnt lgkmcnt(3)
ds_read_b128 a[224:227], v6 offset:8192
v_lshlrev_b32 v30, 16, v18
v_mfma_f32_16x16x32_bf16 v[180:183], a[200:203], a[212:215], v[180:183]
s_waitcnt lgkmcnt(3)
ds_read_b128 a[228:231], v6 offset:10240
v_and_b32 v31, s25, v18
v_mfma_f32_16x16x32_bf16 v[184:187], a[200:203], a[216:219], v[184:187]
s_waitcnt lgkmcnt(3)
ds_read_b128 a[232:235], v6 offset:12288
v_fma_f32 v118, v28, v118, v30
v_mfma_f32_16x16x32_bf16 v[188:191], a[200:203], a[220:223], v[188:191]
s_waitcnt vmcnt(28)
global_load_dwordx4 a[200:203], v2, s[20:21] offset:-2048 sc1
v_fma_f32 v134, v29, v134, v31
v_mfma_f32_16x16x32_bf16 v[204:207], a[204:207], a[220:223], v[204:207]
ds_read_b128 a[236:239], v6 offset:14336
v_cvt_pk_bf16_f32 v82, v118, v134
v_mfma_f32_16x16x32_bf16 v[200:203], a[204:207], a[216:219], v[200:203]
v_lshlrev_b32 v32, 16, v27
v_and_b32 v33, s25, v27
v_mfma_f32_16x16x32_bf16 v[196:199], a[204:207], a[212:215], v[196:199]
v_lshlrev_b32 v34, 16, v19
v_and_b32 v35, s25, v19
v_mfma_f32_16x16x32_bf16 v[192:195], a[204:207], a[208:211], v[192:195]
s_waitcnt vmcnt(28)
global_load_dwordx4 a[204:207], v2, s[20:21] offset:-1024 sc1
v_fma_f32 v150, v32, v150, v34
v_mfma_f32_16x16x32_bf16 v[208:211], a[104:107], a[208:211], v[208:211]
v_fma_f32 v166, v33, v166, v35
v_cvt_pk_bf16_f32 v83, v150, v166
v_mfma_f32_16x16x32_bf16 v[212:215], a[104:107], a[212:215], v[212:215]
v_mfma_f32_16x16x32_bf16 v[216:219], a[104:107], a[216:219], v[216:219]
v_mfma_f32_16x16x32_bf16 v[220:223], a[104:107], a[220:223], v[220:223]
s_waitcnt vmcnt(28)
global_load_dwordx4 a[104:107], v2, s[20:21] offset:0 sc1
v_mfma_f32_16x16x32_bf16 v[236:239], a[108:111], a[220:223], v[236:239]
v_mfma_f32_16x16x32_bf16 v[232:235], a[108:111], a[216:219], v[232:235]
v_mfma_f32_16x16x32_bf16 v[228:231], a[108:111], a[212:215], v[228:231]
v_mfma_f32_16x16x32_bf16 v[224:227], a[108:111], a[208:211], v[224:227]
s_waitcnt vmcnt(28)
global_load_dwordx4 a[108:111], v2, s[20:21] offset:1024 sc1
v_mfma_f32_16x16x32_bf16 v[240:243], a[112:115], a[208:211], v[240:243]
v_mfma_f32_16x16x32_bf16 v[244:247], a[112:115], a[212:215], v[244:247]
v_mfma_f32_16x16x32_bf16 v[248:251], a[112:115], a[216:219], v[248:251]
ds_read_b128 v[16:19], v40 offset:4096
v_accvgpr_read_b32 v24, a52
v_mfma_f32_16x16x32_bf16 v[252:255], a[112:115], a[220:223], v[252:255]
s_waitcnt vmcnt(28) lgkmcnt(4)
global_load_dwordx4 a[112:115], v2, s[20:21] offset:2048 sc1
v_accvgpr_read_b32 v25, a53
v_mfma_f32_16x16x32_bf16 v[176:179], a[116:119], a[224:227], v[176:179]
s_waitcnt lgkmcnt(3)
ds_read_b128 a[208:211], v44 offset:8192
v_accvgpr_read_b32 v26, a54
v_mfma_f32_16x16x32_bf16 v[180:183], a[116:119], a[228:231], v[180:183]
s_waitcnt lgkmcnt(3)
ds_read_b128 a[212:215], v44 offset:10240
v_accvgpr_read_b32 v27, a55
v_mfma_f32_16x16x32_bf16 v[184:187], a[116:119], a[232:235], v[184:187]
s_waitcnt lgkmcnt(3)
ds_read_b128 a[216:219], v44 offset:12288
v_lshlrev_b32 v28, 16, v24
v_mfma_f32_16x16x32_bf16 v[188:191], a[116:119], a[236:239], v[188:191]
s_waitcnt vmcnt(28)
global_load_dwordx4 a[116:119], v2, s[20:21] offset:3072 sc1
v_add_u32 v2, 8192, v2
v_mfma_f32_16x16x32_bf16 v[204:207], a[120:123], a[236:239], v[204:207]
ds_read_b128 a[220:223], v44 offset:14336
v_and_b32 v29, s25, v24
v_mfma_f32_16x16x32_bf16 v[200:203], a[120:123], a[232:235], v[200:203]
v_lshlrev_b32 v30, 16, v20
v_and_b32 v31, s25, v20
v_mfma_f32_16x16x32_bf16 v[196:199], a[120:123], a[228:231], v[196:199]
v_fma_f32 v55, v28, v55, v30
v_fma_f32 v71, v29, v71, v31
v_mfma_f32_16x16x32_bf16 v[192:195], a[120:123], a[224:227], v[192:195]
s_waitcnt vmcnt(28)
global_load_dwordx4 a[120:123], v2, s[20:21] offset:-4096 sc1
v_cvt_pk_bf16_f32 v96, v55, v71
v_mfma_f32_16x16x32_bf16 v[208:211], a[124:127], a[224:227], v[208:211]
v_lshlrev_b32 v32, 16, v25
v_and_b32 v33, s25, v25
v_mfma_f32_16x16x32_bf16 v[212:215], a[124:127], a[228:231], v[212:215]
v_lshlrev_b32 v34, 16, v21
v_and_b32 v35, s25, v21
v_mfma_f32_16x16x32_bf16 v[216:219], a[124:127], a[232:235], v[216:219]
v_fma_f32 v87, v32, v87, v34
v_fma_f32 v103, v33, v103, v35
v_mfma_f32_16x16x32_bf16 v[220:223], a[124:127], a[236:239], v[220:223]
s_waitcnt vmcnt(28)
global_load_dwordx4 a[124:127], v2, s[20:21] offset:-3072 sc1
v_cvt_pk_bf16_f32 v97, v87, v103
v_mfma_f32_16x16x32_bf16 v[236:239], a[128:131], a[236:239], v[236:239]
v_lshlrev_b32 v28, 16, v26
v_and_b32 v29, s25, v26
v_mfma_f32_16x16x32_bf16 v[232:235], a[128:131], a[232:235], v[232:235]
v_lshlrev_b32 v30, 16, v22
v_and_b32 v31, s25, v22
v_mfma_f32_16x16x32_bf16 v[228:231], a[128:131], a[228:231], v[228:231]
v_fma_f32 v119, v28, v119, v30
v_fma_f32 v135, v29, v135, v31
v_mfma_f32_16x16x32_bf16 v[224:227], a[128:131], a[224:227], v[224:227]
s_waitcnt vmcnt(28)
global_load_dwordx4 a[128:131], v2, s[20:21] offset:-2048 sc1
v_cvt_pk_bf16_f32 v98, v119, v135
v_mfma_f32_16x16x32_bf16 v[240:243], a[132:135], a[224:227], v[240:243]
v_lshlrev_b32 v32, 16, v27
v_and_b32 v33, s25, v27
v_mfma_f32_16x16x32_bf16 v[244:247], a[132:135], a[228:231], v[244:247]
v_lshlrev_b32 v34, 16, v23
v_and_b32 v35, s25, v23
v_mfma_f32_16x16x32_bf16 v[248:251], a[132:135], a[232:235], v[248:251]
v_fma_f32 v151, v32, v151, v34
v_fma_f32 v167, v33, v167, v35
v_mfma_f32_16x16x32_bf16 v[252:255], a[132:135], a[236:239], v[252:255]
s_waitcnt vmcnt(28) lgkmcnt(3)
global_load_dwordx4 a[132:135], v2, s[20:21] offset:-1024 sc1
v_cvt_pk_bf16_f32 v99, v151, v167
v_mfma_f32_16x16x32_bf16 v[176:179], a[136:139], a[208:211], v[176:179]
s_waitcnt lgkmcnt(2)
ds_read_b128 a[224:227], v45 offset:8192
v_mfma_f32_16x16x32_bf16 v[180:183], a[136:139], a[212:215], v[180:183]
s_waitcnt lgkmcnt(2)
ds_read_b128 a[228:231], v45 offset:10240
v_mfma_f32_16x16x32_bf16 v[184:187], a[136:139], a[216:219], v[184:187]
s_waitcnt lgkmcnt(2)
ds_read_b128 a[232:235], v45 offset:12288
v_mfma_f32_16x16x32_bf16 v[188:191], a[136:139], a[220:223], v[188:191]
s_waitcnt vmcnt(28)
global_load_dwordx4 a[136:139], v2, s[20:21] offset:0 sc1
v_mfma_f32_16x16x32_bf16 v[204:207], a[140:143], a[220:223], v[204:207]
ds_read_b128 a[236:239], v45 offset:14336
v_mfma_f32_16x16x32_bf16 v[200:203], a[140:143], a[216:219], v[200:203]
ds_write_b128 v0, v[48:51]
v_mfma_f32_16x16x32_bf16 v[196:199], a[140:143], a[212:215], v[196:199]
ds_write_b128 v13, v[64:67]
v_mfma_f32_16x16x32_bf16 v[192:195], a[140:143], a[208:211], v[192:195]
s_waitcnt vmcnt(28)
global_load_dwordx4 a[140:143], v2, s[20:21] offset:1024 sc1
v_mfma_f32_16x16x32_bf16 v[208:211], a[144:147], a[208:211], v[208:211]
ds_write_b128 v14, v[80:83]
v_mfma_f32_16x16x32_bf16 v[212:215], a[144:147], a[212:215], v[212:215]
ds_write_b128 v11, v[96:99]
v_mfma_f32_16x16x32_bf16 v[216:219], a[144:147], a[216:219], v[216:219]
ds_read_b128 v[48:51], v36 offset:0
ds_read_b128 v[64:67], v36 offset:1024
v_mfma_f32_16x16x32_bf16 v[220:223], a[144:147], a[220:223], v[220:223]
s_waitcnt vmcnt(28)
global_load_dwordx4 a[144:147], v2, s[20:21] offset:2048 sc1
ds_read_b128 v[80:83], v36 offset:8192
v_mfma_f32_16x16x32_bf16 v[236:239], a[148:151], a[220:223], v[236:239]
ds_read_b128 v[96:99], v36 offset:9216
ds_read_b128 v[20:23], v41 offset:4096
v_mfma_f32_16x16x32_bf16 v[232:235], a[148:151], a[216:219], v[232:235]
v_accvgpr_read_b32 v24, a8
v_accvgpr_read_b32 v25, a9
v_mfma_f32_16x16x32_bf16 v[228:231], a[148:151], a[212:215], v[228:231]
v_accvgpr_read_b32 v26, a10
v_accvgpr_read_b32 v27, a11
v_mfma_f32_16x16x32_bf16 v[224:227], a[148:151], a[208:211], v[224:227]
s_waitcnt vmcnt(25)
global_load_dwordx4 a[148:151], v2, s[20:21] offset:3072 sc1
v_add_u32 v2, 8192, v2
v_mfma_f32_16x16x32_bf16 v[240:243], a[152:155], a[208:211], v[240:243]
v_lshlrev_b32 v28, 16, v24
v_and_b32 v29, s25, v24
v_mfma_f32_16x16x32_bf16 v[244:247], a[152:155], a[212:215], v[244:247]
v_lshlrev_b32 v30, 16, v16
v_and_b32 v31, s25, v16
v_mfma_f32_16x16x32_bf16 v[248:251], a[152:155], a[216:219], v[248:251]
v_fma_f32 v56, v28, v56, v30
v_fma_f32 v72, v29, v72, v31
v_mfma_f32_16x16x32_bf16 v[252:255], a[152:155], a[220:223], v[252:255]
s_waitcnt vmcnt(24) lgkmcnt(12)
global_load_dwordx4 a[152:155], v2, s[20:21] offset:-4096 sc1
v_cvt_pk_bf16_f32 v52, v56, v72
v_mfma_f32_16x16x32_bf16 v[176:179], a[156:159], a[224:227], v[176:179]
s_waitcnt lgkmcnt(11)
ds_read_b128 a[208:211], v46 offset:8192
v_lshlrev_b32 v32, 16, v25
v_mfma_f32_16x16x32_bf16 v[180:183], a[156:159], a[228:231], v[180:183]
s_waitcnt lgkmcnt(11)
ds_read_b128 a[212:215], v46 offset:10240
v_and_b32 v33, s25, v25
v_mfma_f32_16x16x32_bf16 v[184:187], a[156:159], a[232:235], v[184:187]
s_waitcnt lgkmcnt(11)
ds_read_b128 a[216:219], v46 offset:12288
v_lshlrev_b32 v34, 16, v17
v_mfma_f32_16x16x32_bf16 v[188:191], a[156:159], a[236:239], v[188:191]
s_waitcnt vmcnt(24)
global_load_dwordx4 a[156:159], v2, s[20:21] offset:-3072 sc1
v_and_b32 v35, s25, v17
v_mfma_f32_16x16x32_bf16 v[204:207], a[160:163], a[236:239], v[204:207]
ds_read_b128 a[220:223], v46 offset:14336
v_fma_f32 v88, v32, v88, v34
v_mfma_f32_16x16x32_bf16 v[200:203], a[160:163], a[232:235], v[200:203]
v_fma_f32 v104, v33, v104, v35
v_cvt_pk_bf16_f32 v53, v88, v104
v_mfma_f32_16x16x32_bf16 v[196:199], a[160:163], a[228:231], v[196:199]
v_lshlrev_b32 v28, 16, v26
v_and_b32 v29, s25, v26
v_mfma_f32_16x16x32_bf16 v[192:195], a[160:163], a[224:227], v[192:195]
s_waitcnt vmcnt(24)
global_load_dwordx4 a[160:163], v2, s[20:21] offset:-2048 sc1
v_lshlrev_b32 v30, 16, v18
v_mfma_f32_16x16x32_bf16 v[208:211], a[164:167], a[224:227], v[208:211]
v_and_b32 v31, s25, v18
v_fma_f32 v120, v28, v120, v30
v_mfma_f32_16x16x32_bf16 v[212:215], a[164:167], a[228:231], v[212:215]
v_fma_f32 v136, v29, v136, v31
v_cvt_pk_bf16_f32 v54, v120, v136
v_mfma_f32_16x16x32_bf16 v[216:219], a[164:167], a[232:235], v[216:219]
v_lshlrev_b32 v32, 16, v27
v_and_b32 v33, s25, v27
v_mfma_f32_16x16x32_bf16 v[220:223], a[164:167], a[236:239], v[220:223]
s_waitcnt vmcnt(24)
global_load_dwordx4 a[164:167], v2, s[20:21] offset:-1024 sc1
v_lshlrev_b32 v34, 16, v19
v_mfma_f32_16x16x32_bf16 v[236:239], a[168:171], a[236:239], v[236:239]
v_and_b32 v35, s25, v19
v_fma_f32 v152, v32, v152, v34
v_mfma_f32_16x16x32_bf16 v[232:235], a[168:171], a[232:235], v[232:235]
v_fma_f32 v168, v33, v168, v35
v_cvt_pk_bf16_f32 v55, v152, v168
v_mfma_f32_16x16x32_bf16 v[228:231], a[168:171], a[228:231], v[228:231]
s_waitcnt lgkmcnt(8)
global_store_dwordx4 v9, v[48:51], s[50:51] offset:0 nt
v_mfma_f32_16x16x32_bf16 v[224:227], a[168:171], a[224:227], v[224:227]
s_waitcnt vmcnt(25)
global_load_dwordx4 a[168:171], v2, s[20:21] offset:0 sc1
v_mfma_f32_16x16x32_bf16 v[240:243], a[172:175], a[224:227], v[240:243]
s_waitcnt lgkmcnt(7)
global_store_dwordx4 v10, v[64:67], s[50:51] offset:0 nt
v_mfma_f32_16x16x32_bf16 v[244:247], a[172:175], a[228:231], v[244:247]
s_waitcnt lgkmcnt(6)
global_store_dwordx4 v9, v[80:83], s[50:51] offset:128 nt
v_mfma_f32_16x16x32_bf16 v[248:251], a[172:175], a[232:235], v[248:251]
s_waitcnt lgkmcnt(5)
global_store_dwordx4 v10, v[96:99], s[50:51] offset:128 nt
v_mfma_f32_16x16x32_bf16 v[252:255], a[172:175], a[236:239], v[252:255]
s_waitcnt vmcnt(28) lgkmcnt(3)
global_load_dwordx4 a[172:175], v2, s[20:21] offset:1024 sc1
v_mfma_f32_16x16x32_bf16 v[176:179], a[176:179], a[208:211], v[176:179]
s_waitcnt lgkmcnt(2)
ds_read_b128 a[224:227], v47 offset:8192
ds_read_b128 v[16:19], v42 offset:4096
v_mfma_f32_16x16x32_bf16 v[180:183], a[176:179], a[212:215], v[180:183]
s_waitcnt lgkmcnt(3)
ds_read_b128 a[228:231], v47 offset:10240
v_accvgpr_read_b32 v24, a24
v_mfma_f32_16x16x32_bf16 v[184:187], a[176:179], a[216:219], v[184:187]
s_waitcnt lgkmcnt(3)
ds_read_b128 a[232:235], v47 offset:12288
v_accvgpr_read_b32 v25, a25
v_mfma_f32_16x16x32_bf16 v[188:191], a[176:179], a[220:223], v[188:191]
s_waitcnt vmcnt(28)
global_load_dwordx4 a[176:179], v2, s[20:21] offset:2048 sc1
v_accvgpr_read_b32 v26, a26
v_mfma_f32_16x16x32_bf16 v[204:207], a[180:183], a[220:223], v[204:207]
ds_read_b128 a[236:239], v47 offset:14336
v_accvgpr_read_b32 v27, a27
v_mfma_f32_16x16x32_bf16 v[200:203], a[180:183], a[216:219], v[200:203]
v_lshlrev_b32 v28, 16, v24
v_and_b32 v29, s25, v24
v_mfma_f32_16x16x32_bf16 v[196:199], a[180:183], a[212:215], v[196:199]
v_lshlrev_b32 v30, 16, v20
v_and_b32 v31, s25, v20
v_mfma_f32_16x16x32_bf16 v[192:195], a[180:183], a[208:211], v[192:195]
s_waitcnt vmcnt(28)
global_load_dwordx4 a[180:183], v2, s[20:21] offset:3072 sc1
v_add_u32 v2, 8192, v2
v_mfma_f32_16x16x32_bf16 v[208:211], a[184:187], a[208:211], v[208:211]
v_fma_f32 v57, v28, v57, v30
v_fma_f32 v73, v29, v73, v31
v_mfma_f32_16x16x32_bf16 v[212:215], a[184:187], a[212:215], v[212:215]
v_cvt_pk_bf16_f32 v68, v57, v73
v_lshlrev_b32 v32, 16, v25
v_mfma_f32_16x16x32_bf16 v[216:219], a[184:187], a[216:219], v[216:219]
v_and_b32 v33, s25, v25
v_lshlrev_b32 v34, 16, v21
v_mfma_f32_16x16x32_bf16 v[220:223], a[184:187], a[220:223], v[220:223]
s_waitcnt vmcnt(28)
global_load_dwordx4 a[184:187], v2, s[20:21] offset:-4096 sc1
v_and_b32 v35, s25, v21
v_mfma_f32_16x16x32_bf16 v[236:239], a[188:191], a[220:223], v[236:239]
v_fma_f32 v89, v32, v89, v34
v_fma_f32 v105, v33, v105, v35
v_mfma_f32_16x16x32_bf16 v[232:235], a[188:191], a[216:219], v[232:235]
v_cvt_pk_bf16_f32 v69, v89, v105
v_lshlrev_b32 v28, 16, v26
v_mfma_f32_16x16x32_bf16 v[228:231], a[188:191], a[212:215], v[228:231]
v_and_b32 v29, s25, v26
v_lshlrev_b32 v30, 16, v22
v_mfma_f32_16x16x32_bf16 v[224:227], a[188:191], a[208:211], v[224:227]
s_waitcnt vmcnt(28)
global_load_dwordx4 a[188:191], v2, s[20:21] offset:-3072 sc1
v_and_b32 v31, s25, v22
v_mfma_f32_16x16x32_bf16 v[240:243], a[192:195], a[208:211], v[240:243]
v_fma_f32 v121, v28, v121, v30
v_fma_f32 v137, v29, v137, v31
v_mfma_f32_16x16x32_bf16 v[244:247], a[192:195], a[212:215], v[244:247]
v_cvt_pk_bf16_f32 v70, v121, v137
v_lshlrev_b32 v32, 16, v27
v_mfma_f32_16x16x32_bf16 v[248:251], a[192:195], a[216:219], v[248:251]
v_and_b32 v33, s25, v27
v_lshlrev_b32 v34, 16, v23
v_mfma_f32_16x16x32_bf16 v[252:255], a[192:195], a[220:223], v[252:255]
s_waitcnt vmcnt(28) lgkmcnt(4)
global_load_dwordx4 a[192:195], v2, s[20:21] offset:-2048 sc1
v_and_b32 v35, s25, v23
v_mfma_f32_16x16x32_bf16 v[176:179], a[196:199], a[224:227], v[176:179]
s_waitcnt lgkmcnt(2)
ds_read_b128 a[208:211], v3 offset:16384
v_fma_f32 v153, v32, v153, v34
v_mfma_f32_16x16x32_bf16 v[180:183], a[196:199], a[228:231], v[180:183]
s_waitcnt lgkmcnt(2)
ds_read_b128 a[212:215], v3 offset:18432
v_fma_f32 v169, v33, v169, v35
v_mfma_f32_16x16x32_bf16 v[184:187], a[196:199], a[232:235], v[184:187]
s_waitcnt lgkmcnt(2)
ds_read_b128 a[216:219], v3 offset:20480
v_cvt_pk_bf16_f32 v71, v153, v169
v_mfma_f32_16x16x32_bf16 v[188:191], a[196:199], a[236:239], v[188:191]
s_waitcnt vmcnt(28)
global_load_dwordx4 a[196:199], v2, s[20:21] offset:-1024 sc1
v_mfma_f32_16x16x32_bf16 v[204:207], a[200:203], a[236:239], v[204:207]
ds_read_b128 a[220:223], v3 offset:22528
v_mfma_f32_16x16x32_bf16 v[200:203], a[200:203], a[232:235], v[200:203]
v_mfma_f32_16x16x32_bf16 v[196:199], a[200:203], a[228:231], v[196:199]
v_mfma_f32_16x16x32_bf16 v[192:195], a[200:203], a[224:227], v[192:195]
s_waitcnt vmcnt(28)
global_load_dwordx4 a[200:203], v2, s[20:21] offset:0 sc1
v_mfma_f32_16x16x32_bf16 v[208:211], a[204:207], a[224:227], v[208:211]
v_mfma_f32_16x16x32_bf16 v[212:215], a[204:207], a[228:231], v[212:215]
v_mfma_f32_16x16x32_bf16 v[216:219], a[204:207], a[232:235], v[216:219]
v_mfma_f32_16x16x32_bf16 v[220:223], a[204:207], a[236:239], v[220:223]
s_waitcnt vmcnt(28)
global_load_dwordx4 a[204:207], v2, s[20:21] offset:1024 sc1
ds_read_b128 v[20:23], v43 offset:4096
v_mfma_f32_16x16x32_bf16 v[236:239], a[104:107], a[236:239], v[236:239]
v_accvgpr_read_b32 v24, a40
v_accvgpr_read_b32 v25, a41
v_mfma_f32_16x16x32_bf16 v[232:235], a[104:107], a[232:235], v[232:235]
v_accvgpr_read_b32 v26, a42
v_accvgpr_read_b32 v27, a43
v_mfma_f32_16x16x32_bf16 v[228:231], a[104:107], a[228:231], v[228:231]
v_lshlrev_b32 v28, 16, v24
v_and_b32 v29, s25, v24
v_mfma_f32_16x16x32_bf16 v[224:227], a[104:107], a[224:227], v[224:227]
s_waitcnt vmcnt(28)
global_load_dwordx4 a[104:107], v2, s[20:21] offset:2048 sc1
v_lshlrev_b32 v30, 16, v16
v_mfma_f32_16x16x32_bf16 v[240:243], a[108:111], a[224:227], v[240:243]
v_and_b32 v31, s25, v16
v_fma_f32 v58, v28, v58, v30
v_mfma_f32_16x16x32_bf16 v[244:247], a[108:111], a[228:231], v[244:247]
v_fma_f32 v74, v29, v74, v31
v_cvt_pk_bf16_f32 v84, v58, v74
v_mfma_f32_16x16x32_bf16 v[248:251], a[108:111], a[232:235], v[248:251]
v_lshlrev_b32 v32, 16, v25
v_and_b32 v33, s25, v25
v_mfma_f32_16x16x32_bf16 v[252:255], a[108:111], a[236:239], v[252:255]
s_waitcnt vmcnt(28) lgkmcnt(4)
global_load_dwordx4 a[108:111], v2, s[20:21] offset:3072 sc1
v_add_u32 v2, 8192, v2
v_mfma_f32_16x16x32_bf16 v[176:179], a[112:115], a[208:211], v[176:179]
s_waitcnt lgkmcnt(3)
ds_read_b128 a[224:227], v44 offset:16384
v_lshlrev_b32 v34, 16, v17
v_mfma_f32_16x16x32_bf16 v[180:183], a[112:115], a[212:215], v[180:183]
s_waitcnt lgkmcnt(3)
ds_read_b128 a[228:231], v44 offset:18432
v_and_b32 v35, s25, v17
v_mfma_f32_16x16x32_bf16 v[184:187], a[112:115], a[216:219], v[184:187]
s_waitcnt lgkmcnt(3)
ds_read_b128 a[232:235], v44 offset:20480
v_fma_f32 v90, v32, v90, v34
v_mfma_f32_16x16x32_bf16 v[188:191], a[112:115], a[220:223], v[188:191]
s_waitcnt vmcnt(28)
global_load_dwordx4 a[112:115], v2, s[20:21] offset:-4096 sc1
v_fma_f32 v106, v33, v106, v35
v_mfma_f32_16x16x32_bf16 v[204:207], a[116:119], a[220:223], v[204:207]
ds_read_b128 a[236:239], v44 offset:22528
v_cvt_pk_bf16_f32 v85, v90, v106
v_mfma_f32_16x16x32_bf16 v[200:203], a[116:119], a[216:219], v[200:203]
v_lshlrev_b32 v28, 16, v26
v_and_b32 v29, s25, v26
v_mfma_f32_16x16x32_bf16 v[196:199], a[116:119], a[212:215], v[196:199]
v_lshlrev_b32 v30, 16, v18
v_and_b32 v31, s25, v18
v_mfma_f32_16x16x32_bf16 v[192:195], a[116:119], a[208:211], v[192:195]
s_waitcnt vmcnt(28)
global_load_dwordx4 a[116:119], v2, s[20:21] offset:-3072 sc1
v_fma_f32 v122, v28, v122, v30
v_mfma_f32_16x16x32_bf16 v[208:211], a[120:123], a[208:211], v[208:211]
v_fma_f32 v138, v29, v138, v31
v_cvt_pk_bf16_f32 v86, v122, v138
v_mfma_f32_16x16x32_bf16 v[212:215], a[120:123], a[212:215], v[212:215]
v_lshlrev_b32 v32, 16, v27
v_and_b32 v33, s25, v27
v_mfma_f32_16x16x32_bf16 v[216:219], a[120:123], a[216:219], v[216:219]
v_lshlrev_b32 v34, 16, v19
v_and_b32 v35, s25, v19
v_mfma_f32_16x16x32_bf16 v[220:223], a[120:123], a[220:223], v[220:223]
s_waitcnt vmcnt(28)
global_load_dwordx4 a[120:123], v2, s[20:21] offset:-2048 sc1
v_fma_f32 v154, v32, v154, v34
v_mfma_f32_16x16x32_bf16 v[236:239], a[124:127], a[220:223], v[236:239]
v_fma_f32 v170, v33, v170, v35
v_cvt_pk_bf16_f32 v87, v154, v170
v_mfma_f32_16x16x32_bf16 v[232:235], a[124:127], a[216:219], v[232:235]
v_mfma_f32_16x16x32_bf16 v[228:231], a[124:127], a[212:215], v[228:231]
v_mfma_f32_16x16x32_bf16 v[224:227], a[124:127], a[208:211], v[224:227]
s_waitcnt vmcnt(28)
global_load_dwordx4 a[124:127], v2, s[20:21] offset:-1024 sc1
v_mfma_f32_16x16x32_bf16 v[240:243], a[128:131], a[208:211], v[240:243]
v_mfma_f32_16x16x32_bf16 v[244:247], a[128:131], a[212:215], v[244:247]
v_mfma_f32_16x16x32_bf16 v[248:251], a[128:131], a[216:219], v[248:251]
v_mfma_f32_16x16x32_bf16 v[252:255], a[128:131], a[220:223], v[252:255]
s_waitcnt vmcnt(28) lgkmcnt(3)
global_load_dwordx4 a[128:131], v2, s[20:21] offset:0 sc1
v_mfma_f32_16x16x32_bf16 v[176:179], a[132:135], a[224:227], v[176:179]
s_waitcnt lgkmcnt(2)
ds_read_b128 a[208:211], v7 offset:0
v_mfma_f32_16x16x32_bf16 v[180:183], a[132:135], a[228:231], v[180:183]
s_waitcnt lgkmcnt(2)
ds_read_b128 a[212:215], v7 offset:2048
v_mfma_f32_16x16x32_bf16 v[184:187], a[132:135], a[232:235], v[184:187]
s_waitcnt lgkmcnt(2)
ds_read_b128 a[216:219], v7 offset:4096
v_mfma_f32_16x16x32_bf16 v[188:191], a[132:135], a[236:239], v[188:191]
s_waitcnt vmcnt(28)
global_load_dwordx4 a[132:135], v2, s[20:21] offset:1024 sc1
ds_read_b128 v[16:19], v40 offset:6144
v_mfma_f32_16x16x32_bf16 v[204:207], a[136:139], a[236:239], v[204:207]
ds_read_b128 a[220:223], v7 offset:6144
v_accvgpr_read_b32 v24, a56
v_mfma_f32_16x16x32_bf16 v[200:203], a[136:139], a[232:235], v[200:203]
v_accvgpr_read_b32 v25, a57
v_accvgpr_read_b32 v26, a58
v_mfma_f32_16x16x32_bf16 v[196:199], a[136:139], a[228:231], v[196:199]
v_accvgpr_read_b32 v27, a59
v_lshlrev_b32 v28, 16, v24
v_mfma_f32_16x16x32_bf16 v[192:195], a[136:139], a[224:227], v[192:195]
s_waitcnt vmcnt(28)
global_load_dwordx4 a[136:139], v2, s[20:21] offset:2048 sc1
v_and_b32 v29, s25, v24
v_mfma_f32_16x16x32_bf16 v[208:211], a[140:143], a[224:227], v[208:211]
v_lshlrev_b32 v30, 16, v20
v_and_b32 v31, s25, v20
v_mfma_f32_16x16x32_bf16 v[212:215], a[140:143], a[228:231], v[212:215]
v_fma_f32 v59, v28, v59, v30
v_fma_f32 v75, v29, v75, v31
v_mfma_f32_16x16x32_bf16 v[216:219], a[140:143], a[232:235], v[216:219]
v_cvt_pk_bf16_f32 v100, v59, v75
v_lshlrev_b32 v32, 16, v25
v_mfma_f32_16x16x32_bf16 v[220:223], a[140:143], a[236:239], v[220:223]
s_waitcnt vmcnt(28)
global_load_dwordx4 a[140:143], v2, s[20:21] offset:3072 sc1
v_add_u32 v2, 8192, v2
v_mfma_f32_16x16x32_bf16 v[236:239], a[144:147], a[236:239], v[236:239]
v_and_b32 v33, s25, v25
v_lshlrev_b32 v34, 16, v21
v_mfma_f32_16x16x32_bf16 v[232:235], a[144:147], a[232:235], v[232:235]
v_and_b32 v35, s25, v21
v_fma_f32 v91, v32, v91, v34
v_mfma_f32_16x16x32_bf16 v[228:231], a[144:147], a[228:231], v[228:231]
v_fma_f32 v107, v33, v107, v35
v_cvt_pk_bf16_f32 v101, v91, v107
v_mfma_f32_16x16x32_bf16 v[224:227], a[144:147], a[224:227], v[224:227]
s_waitcnt vmcnt(28)
global_load_dwordx4 a[144:147], v2, s[20:21] offset:-4096 sc1
v_lshlrev_b32 v28, 16, v26
v_mfma_f32_16x16x32_bf16 v[240:243], a[148:151], a[224:227], v[240:243]
v_and_b32 v29, s25, v26
v_lshlrev_b32 v30, 16, v22
v_mfma_f32_16x16x32_bf16 v[244:247], a[148:151], a[228:231], v[244:247]
v_and_b32 v31, s25, v22
v_fma_f32 v123, v28, v123, v30
v_mfma_f32_16x16x32_bf16 v[248:251], a[148:151], a[232:235], v[248:251]
v_fma_f32 v139, v29, v139, v31
v_cvt_pk_bf16_f32 v102, v123, v139
v_mfma_f32_16x16x32_bf16 v[252:255], a[148:151], a[236:239], v[252:255]
s_waitcnt vmcnt(28) lgkmcnt(4)
global_load_dwordx4 a[148:151], v2, s[20:21] offset:-3072 sc1
v_lshlrev_b32 v32, 16, v27
v_mfma_f32_16x16x32_bf16 v[176:179], a[152:155], a[208:211], v[176:179]
s_waitcnt lgkmcnt(3)
ds_read_b128 a[224:227], v15 offset:0
v_and_b32 v33, s25, v27
v_mfma_f32_16x16x32_bf16 v[180:183], a[152:155], a[212:215], v[180:183]
s_waitcnt lgkmcnt(3)
ds_read_b128 a[228:231], v15 offset:2048
v_lshlrev_b32 v34, 16, v23
v_mfma_f32_16x16x32_bf16 v[184:187], a[152:155], a[216:219], v[184:187]
s_waitcnt lgkmcnt(2)
ds_read_b128 a[232:235], v15 offset:4096
v_and_b32 v35, s25, v23
v_mfma_f32_16x16x32_bf16 v[188:191], a[152:155], a[220:223], v[188:191]
s_waitcnt vmcnt(28)
global_load_dwordx4 a[152:155], v2, s[20:21] offset:-2048 sc1
v_fma_f32 v155, v32, v155, v34
v_mfma_f32_16x16x32_bf16 v[204:207], a[156:159], a[220:223], v[204:207]
ds_read_b128 a[236:239], v15 offset:6144
v_fma_f32 v171, v33, v171, v35
v_mfma_f32_16x16x32_bf16 v[200:203], a[156:159], a[216:219], v[200:203]
v_cvt_pk_bf16_f32 v103, v155, v171
v_mfma_f32_16x16x32_bf16 v[196:199], a[156:159], a[212:215], v[196:199]
ds_write_b128 v0, v[52:55]
v_mfma_f32_16x16x32_bf16 v[192:195], a[156:159], a[208:211], v[192:195]
s_waitcnt vmcnt(28)
global_load_dwordx4 a[156:159], v2, s[20:21] offset:-1024 sc1
v_mfma_f32_16x16x32_bf16 v[208:211], a[160:163], a[208:211], v[208:211]
ds_write_b128 v13, v[68:71]
v_mfma_f32_16x16x32_bf16 v[212:215], a[160:163], a[212:215], v[212:215]
ds_write_b128 v14, v[84:87]
v_mfma_f32_16x16x32_bf16 v[216:219], a[160:163], a[216:219], v[216:219]
ds_write_b128 v11, v[100:103]
v_mfma_f32_16x16x32_bf16 v[220:223], a[160:163], a[220:223], v[220:223]
s_waitcnt vmcnt(28)
global_load_dwordx4 a[160:163], v2, s[20:21] offset:0 sc1
ds_read_b128 v[52:55], v36 offset:0
v_mfma_f32_16x16x32_bf16 v[236:239], a[164:167], a[220:223], v[236:239]
ds_read_b128 v[68:71], v36 offset:1024
ds_read_b128 v[84:87], v36 offset:8192
v_mfma_f32_16x16x32_bf16 v[232:235], a[164:167], a[216:219], v[232:235]
ds_read_b128 v[100:103], v36 offset:9216
v_mfma_f32_16x16x32_bf16 v[228:231], a[164:167], a[212:215], v[228:231]
ds_read_b128 v[20:23], v41 offset:6144
v_accvgpr_read_b32 v24, a12
v_mfma_f32_16x16x32_bf16 v[224:227], a[164:167], a[208:211], v[224:227]
s_waitcnt vmcnt(27)
global_load_dwordx4 a[164:167], v2, s[20:21] offset:1024 sc1
v_accvgpr_read_b32 v25, a13
v_mfma_f32_16x16x32_bf16 v[240:243], a[168:171], a[208:211], v[240:243]
v_accvgpr_read_b32 v26, a14
v_accvgpr_read_b32 v27, a15
v_mfma_f32_16x16x32_bf16 v[244:247], a[168:171], a[212:215], v[244:247]
v_lshlrev_b32 v28, 16, v24
v_and_b32 v29, s25, v24
v_mfma_f32_16x16x32_bf16 v[248:251], a[168:171], a[216:219], v[248:251]
v_lshlrev_b32 v30, 16, v16
v_and_b32 v31, s25, v16
v_mfma_f32_16x16x32_bf16 v[252:255], a[168:171], a[220:223], v[252:255]
s_waitcnt vmcnt(24) lgkmcnt(12)
global_load_dwordx4 a[168:171], v2, s[20:21] offset:2048 sc1
v_fma_f32 v60, v28, v60, v30
v_mfma_f32_16x16x32_bf16 v[176:179], a[172:175], a[224:227], v[176:179]
s_waitcnt lgkmcnt(11)
ds_read_b128 a[208:211], v4 offset:16384
v_fma_f32 v76, v29, v76, v31
v_mfma_f32_16x16x32_bf16 v[180:183], a[172:175], a[228:231], v[180:183]
s_waitcnt lgkmcnt(11)
ds_read_b128 a[212:215], v4 offset:18432
v_cvt_pk_bf16_f32 v56, v60, v76
v_mfma_f32_16x16x32_bf16 v[184:187], a[172:175], a[232:235], v[184:187]
s_waitcnt lgkmcnt(11)
ds_read_b128 a[216:219], v4 offset:20480
v_lshlrev_b32 v32, 16, v25
v_mfma_f32_16x16x32_bf16 v[188:191], a[172:175], a[236:239], v[188:191]
s_waitcnt vmcnt(24)
global_load_dwordx4 a[172:175], v2, s[20:21] offset:3072 sc1
v_add_u32 v2, 8192, v2
v_mfma_f32_16x16x32_bf16 v[204:207], a[176:179], a[236:239], v[204:207]
ds_read_b128 a[220:223], v4 offset:22528
v_and_b32 v33, s25, v25
v_mfma_f32_16x16x32_bf16 v[200:203], a[176:179], a[232:235], v[200:203]
v_lshlrev_b32 v34, 16, v17
v_and_b32 v35, s25, v17
v_mfma_f32_16x16x32_bf16 v[196:199], a[176:179], a[228:231], v[196:199]
v_fma_f32 v92, v32, v92, v34
v_fma_f32 v108, v33, v108, v35
v_mfma_f32_16x16x32_bf16 v[192:195], a[176:179], a[224:227], v[192:195]
s_waitcnt vmcnt(24)
global_load_dwordx4 a[176:179], v2, s[20:21] offset:-4096 sc1
v_cvt_pk_bf16_f32 v57, v92, v108
v_mfma_f32_16x16x32_bf16 v[208:211], a[180:183], a[224:227], v[208:211]
v_lshlrev_b32 v28, 16, v26
v_and_b32 v29, s25, v26
v_mfma_f32_16x16x32_bf16 v[212:215], a[180:183], a[228:231], v[212:215]
v_lshlrev_b32 v30, 16, v18
v_and_b32 v31, s25, v18
v_mfma_f32_16x16x32_bf16 v[216:219], a[180:183], a[232:235], v[216:219]
v_fma_f32 v124, v28, v124, v30
v_fma_f32 v140, v29, v140, v31
v_mfma_f32_16x16x32_bf16 v[220:223], a[180:183], a[236:239], v[220:223]
s_waitcnt vmcnt(24)
global_load_dwordx4 a[180:183], v2, s[20:21] offset:-3072 sc1
v_cvt_pk_bf16_f32 v58, v124, v140
v_mfma_f32_16x16x32_bf16 v[236:239], a[184:187], a[236:239], v[236:239]
v_lshlrev_b32 v32, 16, v27
v_and_b32 v33, s25, v27
v_mfma_f32_16x16x32_bf16 v[232:235], a[184:187], a[232:235], v[232:235]
v_lshlrev_b32 v34, 16, v19
v_and_b32 v35, s25, v19
v_mfma_f32_16x16x32_bf16 v[228:231], a[184:187], a[228:231], v[228:231]
v_fma_f32 v156, v32, v156, v34
v_fma_f32 v172, v33, v172, v35
v_mfma_f32_16x16x32_bf16 v[224:227], a[184:187], a[224:227], v[224:227]
s_waitcnt vmcnt(24)
global_load_dwordx4 a[184:187], v2, s[20:21] offset:-2048 sc1
v_cvt_pk_bf16_f32 v59, v156, v172
v_mfma_f32_16x16x32_bf16 v[240:243], a[188:191], a[224:227], v[240:243]
s_waitcnt lgkmcnt(8)
global_store_dwordx4 v9, v[52:55], s[52:53] offset:0 nt
v_mfma_f32_16x16x32_bf16 v[244:247], a[188:191], a[228:231], v[244:247]
s_waitcnt lgkmcnt(7)
global_store_dwordx4 v10, v[68:71], s[52:53] offset:0 nt
v_mfma_f32_16x16x32_bf16 v[248:251], a[188:191], a[232:235], v[248:251]
s_waitcnt lgkmcnt(6)
global_store_dwordx4 v9, v[84:87], s[52:53] offset:128 nt
v_mfma_f32_16x16x32_bf16 v[252:255], a[188:191], a[236:239], v[252:255]
s_waitcnt vmcnt(27) lgkmcnt(3)
global_load_dwordx4 a[188:191], v2, s[20:21] offset:-1024 sc1
v_mfma_f32_16x16x32_bf16 v[176:179], a[192:195], a[208:211], v[176:179]
s_waitcnt lgkmcnt(2)
ds_read_b128 a[224:227], v45 offset:16384
v_mfma_f32_16x16x32_bf16 v[180:183], a[192:195], a[212:215], v[180:183]
s_waitcnt lgkmcnt(2)
ds_read_b128 a[228:231], v45 offset:18432
v_mfma_f32_16x16x32_bf16 v[184:187], a[192:195], a[216:219], v[184:187]
s_waitcnt lgkmcnt(2)
ds_read_b128 a[232:235], v45 offset:20480
v_mfma_f32_16x16x32_bf16 v[188:191], a[192:195], a[220:223], v[188:191]
s_waitcnt vmcnt(27)
global_load_dwordx4 a[192:195], v2, s[20:21] offset:0 sc1
v_mfma_f32_16x16x32_bf16 v[204:207], a[196:199], a[220:223], v[204:207]
ds_read_b128 a[236:239], v45 offset:22528
v_mfma_f32_16x16x32_bf16 v[200:203], a[196:199], a[216:219], v[200:203]
global_store_dwordx4 v10, v[100:103], s[52:53] offset:128 nt
v_mfma_f32_16x16x32_bf16 v[196:199], a[196:199], a[212:215], v[196:199]
ds_read_b128 v[16:19], v42 offset:6144
v_accvgpr_read_b32 v24, a28
v_mfma_f32_16x16x32_bf16 v[192:195], a[196:199], a[208:211], v[192:195]
s_waitcnt vmcnt(28)
global_load_dwordx4 a[196:199], v2, s[20:21] offset:1024 sc1
v_accvgpr_read_b32 v25, a29
v_mfma_f32_16x16x32_bf16 v[208:211], a[200:203], a[208:211], v[208:211]
v_accvgpr_read_b32 v26, a30
v_accvgpr_read_b32 v27, a31
v_mfma_f32_16x16x32_bf16 v[212:215], a[200:203], a[212:215], v[212:215]
v_lshlrev_b32 v28, 16, v24
v_and_b32 v29, s25, v24
v_mfma_f32_16x16x32_bf16 v[216:219], a[200:203], a[216:219], v[216:219]
v_lshlrev_b32 v30, 16, v20
v_and_b32 v31, s25, v20
v_mfma_f32_16x16x32_bf16 v[220:223], a[200:203], a[220:223], v[220:223]
s_waitcnt vmcnt(28)
global_load_dwordx4 a[200:203], v2, s[20:21] offset:2048 sc1
v_fma_f32 v61, v28, v61, v30
v_mfma_f32_16x16x32_bf16 v[236:239], a[204:207], a[220:223], v[236:239]
v_fma_f32 v77, v29, v77, v31
v_cvt_pk_bf16_f32 v72, v61, v77
v_mfma_f32_16x16x32_bf16 v[232:235], a[204:207], a[216:219], v[232:235]
v_lshlrev_b32 v32, 16, v25
v_and_b32 v33, s25, v25
v_mfma_f32_16x16x32_bf16 v[228:231], a[204:207], a[212:215], v[228:231]
v_lshlrev_b32 v34, 16, v21
v_and_b32 v35, s25, v21
v_mfma_f32_16x16x32_bf16 v[224:227], a[204:207], a[208:211], v[224:227]
s_waitcnt vmcnt(28)
global_load_dwordx4 a[204:207], v2, s[20:21] offset:3072 sc1
v_add_u32 v2, 8192, v2
v_mfma_f32_16x16x32_bf16 v[240:243], a[104:107], a[208:211], v[240:243]
v_fma_f32 v93, v32, v93, v34
v_fma_f32 v109, v33, v109, v35
v_mfma_f32_16x16x32_bf16 v[244:247], a[104:107], a[212:215], v[244:247]
v_cvt_pk_bf16_f32 v73, v93, v109
v_lshlrev_b32 v28, 16, v26
v_mfma_f32_16x16x32_bf16 v[248:251], a[104:107], a[216:219], v[248:251]
v_and_b32 v29, s25, v26
v_lshlrev_b32 v30, 16, v22
v_mfma_f32_16x16x32_bf16 v[252:255], a[104:107], a[220:223], v[252:255]
s_waitcnt vmcnt(28) lgkmcnt(4)
v_and_b32 v31, s25, v22
v_fma_f32 v125, v28, v125, v30
v_mfma_f32_16x16x32_bf16 v[176:179], a[108:111], a[224:227], v[176:179]
s_waitcnt lgkmcnt(3)
ds_read_b128 a[208:211], v5 offset:16384
v_fma_f32 v141, v29, v141, v31
v_mfma_f32_16x16x32_bf16 v[180:183], a[108:111], a[228:231], v[180:183]
s_waitcnt lgkmcnt(3)
ds_read_b128 a[212:215], v5 offset:18432
v_cvt_pk_bf16_f32 v74, v125, v141
v_mfma_f32_16x16x32_bf16 v[184:187], a[108:111], a[232:235], v[184:187]
s_waitcnt lgkmcnt(3)
ds_read_b128 a[216:219], v5 offset:20480
v_lshlrev_b32 v32, 16, v27
v_mfma_f32_16x16x32_bf16 v[188:191], a[108:111], a[236:239], v[188:191]
s_waitcnt vmcnt(27)
v_and_b32 v33, s25, v27
v_lshlrev_b32 v34, 16, v23
v_mfma_f32_16x16x32_bf16 v[204:207], a[112:115], a[236:239], v[204:207]
ds_read_b128 a[220:223], v5 offset:22528
v_and_b32 v35, s25, v23
v_mfma_f32_16x16x32_bf16 v[200:203], a[112:115], a[232:235], v[200:203]
v_fma_f32 v157, v32, v157, v34
v_fma_f32 v173, v33, v173, v35
v_mfma_f32_16x16x32_bf16 v[196:199], a[112:115], a[228:231], v[196:199]
v_cvt_pk_bf16_f32 v75, v157, v173
v_mfma_f32_16x16x32_bf16 v[192:195], a[112:115], a[224:227], v[192:195]
s_waitcnt vmcnt(26)
v_mfma_f32_16x16x32_bf16 v[208:211], a[116:119], a[224:227], v[208:211]
v_mfma_f32_16x16x32_bf16 v[212:215], a[116:119], a[228:231], v[212:215]
v_mfma_f32_16x16x32_bf16 v[216:219], a[116:119], a[232:235], v[216:219]
v_mfma_f32_16x16x32_bf16 v[220:223], a[116:119], a[236:239], v[220:223]
s_waitcnt vmcnt(25)
v_mfma_f32_16x16x32_bf16 v[236:239], a[120:123], a[236:239], v[236:239]
v_mfma_f32_16x16x32_bf16 v[232:235], a[120:123], a[232:235], v[232:235]
v_mfma_f32_16x16x32_bf16 v[228:231], a[120:123], a[228:231], v[228:231]
v_mfma_f32_16x16x32_bf16 v[224:227], a[120:123], a[224:227], v[224:227]
s_waitcnt vmcnt(24)
v_mfma_f32_16x16x32_bf16 v[240:243], a[124:127], a[224:227], v[240:243]
ds_read_b128 v[20:23], v43 offset:6144
v_accvgpr_read_b32 v24, a44
v_mfma_f32_16x16x32_bf16 v[244:247], a[124:127], a[228:231], v[244:247]
v_accvgpr_read_b32 v25, a45
v_accvgpr_read_b32 v26, a46
v_mfma_f32_16x16x32_bf16 v[248:251], a[124:127], a[232:235], v[248:251]
v_accvgpr_read_b32 v27, a47
v_lshlrev_b32 v28, 16, v24
v_mfma_f32_16x16x32_bf16 v[252:255], a[124:127], a[236:239], v[252:255]
s_waitcnt vmcnt(23) lgkmcnt(4)
v_and_b32 v29, s25, v24
v_lshlrev_b32 v30, 16, v16
v_mfma_f32_16x16x32_bf16 v[176:179], a[128:131], a[208:211], v[176:179]
s_waitcnt lgkmcnt(3)
ds_read_b128 a[224:227], v46 offset:16384
v_and_b32 v31, s25, v16
v_mfma_f32_16x16x32_bf16 v[180:183], a[128:131], a[212:215], v[180:183]
s_waitcnt lgkmcnt(3)
ds_read_b128 a[228:231], v46 offset:18432
v_fma_f32 v62, v28, v62, v30
v_mfma_f32_16x16x32_bf16 v[184:187], a[128:131], a[216:219], v[184:187]
s_waitcnt lgkmcnt(3)
ds_read_b128 a[232:235], v46 offset:20480
v_fma_f32 v78, v29, v78, v31
v_mfma_f32_16x16x32_bf16 v[188:191], a[128:131], a[220:223], v[188:191]
s_waitcnt vmcnt(22)
v_cvt_pk_bf16_f32 v88, v62, v78
v_lshlrev_b32 v32, 16, v25
v_mfma_f32_16x16x32_bf16 v[204:207], a[132:135], a[220:223], v[204:207]
ds_read_b128 a[236:239], v46 offset:22528
v_and_b32 v33, s25, v25
v_mfma_f32_16x16x32_bf16 v[200:203], a[132:135], a[216:219], v[200:203]
v_lshlrev_b32 v34, 16, v17
v_and_b32 v35, s25, v17
v_mfma_f32_16x16x32_bf16 v[196:199], a[132:135], a[212:215], v[196:199]
v_fma_f32 v94, v32, v94, v34
v_fma_f32 v110, v33, v110, v35
v_mfma_f32_16x16x32_bf16 v[192:195], a[132:135], a[208:211], v[192:195]
s_waitcnt vmcnt(21)
v_cvt_pk_bf16_f32 v89, v94, v110
v_lshlrev_b32 v28, 16, v26
v_mfma_f32_16x16x32_bf16 v[208:211], a[136:139], a[208:211], v[208:211]
v_and_b32 v29, s25, v26
v_lshlrev_b32 v30, 16, v18
v_mfma_f32_16x16x32_bf16 v[212:215], a[136:139], a[212:215], v[212:215]
v_and_b32 v31, s25, v18
v_fma_f32 v126, v28, v126, v30
v_mfma_f32_16x16x32_bf16 v[216:219], a[136:139], a[216:219], v[216:219]
v_fma_f32 v142, v29, v142, v31
v_cvt_pk_bf16_f32 v90, v126, v142
v_mfma_f32_16x16x32_bf16 v[220:223], a[136:139], a[220:223], v[220:223]
s_waitcnt vmcnt(20)
v_lshlrev_b32 v32, 16, v27
v_and_b32 v33, s25, v27
v_mfma_f32_16x16x32_bf16 v[236:239], a[140:143], a[220:223], v[236:239]
v_lshlrev_b32 v34, 16, v19
v_and_b32 v35, s25, v19
v_mfma_f32_16x16x32_bf16 v[232:235], a[140:143], a[216:219], v[232:235]
v_fma_f32 v158, v32, v158, v34
v_fma_f32 v174, v33, v174, v35
v_mfma_f32_16x16x32_bf16 v[228:231], a[140:143], a[212:215], v[228:231]
v_cvt_pk_bf16_f32 v91, v158, v174
v_mfma_f32_16x16x32_bf16 v[224:227], a[140:143], a[208:211], v[224:227]
s_waitcnt vmcnt(19)
v_mfma_f32_16x16x32_bf16 v[240:243], a[144:147], a[208:211], v[240:243]
v_mfma_f32_16x16x32_bf16 v[244:247], a[144:147], a[212:215], v[244:247]
v_mfma_f32_16x16x32_bf16 v[248:251], a[144:147], a[216:219], v[248:251]
v_mfma_f32_16x16x32_bf16 v[252:255], a[144:147], a[220:223], v[252:255]
s_waitcnt vmcnt(18) lgkmcnt(3)
v_mfma_f32_16x16x32_bf16 v[176:179], a[148:151], a[224:227], v[176:179]
s_waitcnt lgkmcnt(2)
ds_read_b128 a[208:211], v6 offset:16384
v_mfma_f32_16x16x32_bf16 v[180:183], a[148:151], a[228:231], v[180:183]
s_waitcnt lgkmcnt(2)
ds_read_b128 a[212:215], v6 offset:18432
v_mfma_f32_16x16x32_bf16 v[184:187], a[148:151], a[232:235], v[184:187]
s_waitcnt lgkmcnt(2)
ds_read_b128 a[216:219], v6 offset:20480
v_mfma_f32_16x16x32_bf16 v[188:191], a[148:151], a[236:239], v[188:191]
s_waitcnt vmcnt(17)
v_mfma_f32_16x16x32_bf16 v[204:207], a[152:155], a[236:239], v[204:207]
ds_read_b128 a[220:223], v6 offset:22528
v_mfma_f32_16x16x32_bf16 v[200:203], a[152:155], a[232:235], v[200:203]
v_mfma_f32_16x16x32_bf16 v[196:199], a[152:155], a[228:231], v[196:199]
v_mfma_f32_16x16x32_bf16 v[192:195], a[152:155], a[224:227], v[192:195]
s_waitcnt vmcnt(16)
v_accvgpr_read_b32 v24, a60
v_accvgpr_read_b32 v25, a61
v_mfma_f32_16x16x32_bf16 v[208:211], a[156:159], a[224:227], v[208:211]
v_accvgpr_read_b32 v26, a62
v_accvgpr_read_b32 v27, a63
v_mfma_f32_16x16x32_bf16 v[212:215], a[156:159], a[228:231], v[212:215]
v_lshlrev_b32 v28, 16, v24
v_and_b32 v29, s25, v24
v_mfma_f32_16x16x32_bf16 v[216:219], a[156:159], a[232:235], v[216:219]
v_lshlrev_b32 v30, 16, v20
v_and_b32 v31, s25, v20
v_mfma_f32_16x16x32_bf16 v[220:223], a[156:159], a[236:239], v[220:223]
s_waitcnt vmcnt(15)
v_fma_f32 v63, v28, v63, v30
v_fma_f32 v79, v29, v79, v31
v_mfma_f32_16x16x32_bf16 v[236:239], a[160:163], a[236:239], v[236:239]
v_cvt_pk_bf16_f32 v104, v63, v79
v_lshlrev_b32 v32, 16, v25
v_mfma_f32_16x16x32_bf16 v[232:235], a[160:163], a[232:235], v[232:235]
v_and_b32 v33, s25, v25
v_lshlrev_b32 v34, 16, v21
v_mfma_f32_16x16x32_bf16 v[228:231], a[160:163], a[228:231], v[228:231]
v_and_b32 v35, s25, v21
v_fma_f32 v95, v32, v95, v34
v_mfma_f32_16x16x32_bf16 v[224:227], a[160:163], a[224:227], v[224:227]
s_waitcnt vmcnt(14)
v_fma_f32 v111, v33, v111, v35
v_cvt_pk_bf16_f32 v105, v95, v111
v_mfma_f32_16x16x32_bf16 v[240:243], a[164:167], a[224:227], v[240:243]
v_lshlrev_b32 v28, 16, v26
v_and_b32 v29, s25, v26
v_mfma_f32_16x16x32_bf16 v[244:247], a[164:167], a[228:231], v[244:247]
v_lshlrev_b32 v30, 16, v22
v_and_b32 v31, s25, v22
v_mfma_f32_16x16x32_bf16 v[248:251], a[164:167], a[232:235], v[248:251]
v_fma_f32 v127, v28, v127, v30
v_fma_f32 v143, v29, v143, v31
v_mfma_f32_16x16x32_bf16 v[252:255], a[164:167], a[236:239], v[252:255]
s_waitcnt vmcnt(13) lgkmcnt(3)
v_cvt_pk_bf16_f32 v106, v127, v143
v_lshlrev_b32 v32, 16, v27
v_mfma_f32_16x16x32_bf16 v[176:179], a[168:171], a[208:211], v[176:179]
s_waitcnt lgkmcnt(2)
ds_read_b128 a[224:227], v47 offset:16384
v_and_b32 v33, s25, v27
v_mfma_f32_16x16x32_bf16 v[180:183], a[168:171], a[212:215], v[180:183]
s_waitcnt lgkmcnt(2)
ds_read_b128 a[228:231], v47 offset:18432
v_lshlrev_b32 v34, 16, v23
v_mfma_f32_16x16x32_bf16 v[184:187], a[168:171], a[216:219], v[184:187]
s_waitcnt lgkmcnt(2)
ds_read_b128 a[232:235], v47 offset:20480
v_and_b32 v35, s25, v23
v_mfma_f32_16x16x32_bf16 v[188:191], a[168:171], a[220:223], v[188:191]
s_waitcnt vmcnt(12)
v_fma_f32 v159, v32, v159, v34
v_fma_f32 v175, v33, v175, v35
v_mfma_f32_16x16x32_bf16 v[204:207], a[172:175], a[220:223], v[204:207]
ds_read_b128 a[236:239], v47 offset:22528
v_cvt_pk_bf16_f32 v107, v159, v175
v_mfma_f32_16x16x32_bf16 v[200:203], a[172:175], a[216:219], v[200:203]
ds_write_b128 v0, v[56:59]
v_mfma_f32_16x16x32_bf16 v[196:199], a[172:175], a[212:215], v[196:199]
ds_write_b128 v13, v[72:75]
v_mfma_f32_16x16x32_bf16 v[192:195], a[172:175], a[208:211], v[192:195]
s_waitcnt vmcnt(11)
ds_write_b128 v14, v[88:91]
v_mfma_f32_16x16x32_bf16 v[208:211], a[176:179], a[208:211], v[208:211]
ds_write_b128 v11, v[104:107]
v_mfma_f32_16x16x32_bf16 v[212:215], a[176:179], a[212:215], v[212:215]
ds_read_b128 v[56:59], v36 offset:0
ds_read_b128 v[72:75], v36 offset:1024
v_mfma_f32_16x16x32_bf16 v[216:219], a[176:179], a[216:219], v[216:219]
ds_read_b128 v[88:91], v36 offset:8192
ds_read_b128 v[104:107], v36 offset:9216
v_mfma_f32_16x16x32_bf16 v[220:223], a[176:179], a[220:223], v[220:223]
s_waitcnt vmcnt(10) lgkmcnt(3)
global_store_dwordx4 v9, v[56:59], s[54:55] offset:0 nt
v_mfma_f32_16x16x32_bf16 v[236:239], a[180:183], a[220:223], v[236:239]
s_waitcnt lgkmcnt(2)
global_store_dwordx4 v10, v[72:75], s[54:55] offset:0 nt
v_mfma_f32_16x16x32_bf16 v[232:235], a[180:183], a[216:219], v[232:235]
s_waitcnt lgkmcnt(1)
global_store_dwordx4 v9, v[88:91], s[54:55] offset:128 nt
v_mfma_f32_16x16x32_bf16 v[228:231], a[180:183], a[212:215], v[228:231]
s_waitcnt lgkmcnt(0)
global_store_dwordx4 v10, v[104:107], s[54:55] offset:128 nt
v_mfma_f32_16x16x32_bf16 v[224:227], a[180:183], a[208:211], v[224:227]
s_waitcnt vmcnt(13)
v_mfma_f32_16x16x32_bf16 v[240:243], a[184:187], a[208:211], v[240:243]
v_mfma_f32_16x16x32_bf16 v[244:247], a[184:187], a[212:215], v[244:247]
v_mfma_f32_16x16x32_bf16 v[248:251], a[184:187], a[216:219], v[248:251]
v_mfma_f32_16x16x32_bf16 v[252:255], a[184:187], a[220:223], v[252:255]
s_waitcnt vmcnt(9)
v_mfma_f32_16x16x32_bf16 v[176:179], a[188:191], a[224:227], v[176:179]
v_mfma_f32_16x16x32_bf16 v[180:183], a[188:191], a[228:231], v[180:183]
v_mfma_f32_16x16x32_bf16 v[184:187], a[188:191], a[232:235], v[184:187]
v_mfma_f32_16x16x32_bf16 v[188:191], a[188:191], a[236:239], v[188:191]
s_waitcnt vmcnt(8)
v_mfma_f32_16x16x32_bf16 v[204:207], a[192:195], a[236:239], v[204:207]
v_mfma_f32_16x16x32_bf16 v[200:203], a[192:195], a[232:235], v[200:203]
v_mfma_f32_16x16x32_bf16 v[196:199], a[192:195], a[228:231], v[196:199]
v_mfma_f32_16x16x32_bf16 v[192:195], a[192:195], a[224:227], v[192:195]
s_waitcnt vmcnt(6)
v_mfma_f32_16x16x32_bf16 v[208:211], a[196:199], a[224:227], v[208:211]
v_mfma_f32_16x16x32_bf16 v[212:215], a[196:199], a[228:231], v[212:215]
v_mfma_f32_16x16x32_bf16 v[216:219], a[196:199], a[232:235], v[216:219]
v_mfma_f32_16x16x32_bf16 v[220:223], a[196:199], a[236:239], v[220:223]
s_waitcnt vmcnt(5)
v_mfma_f32_16x16x32_bf16 v[236:239], a[200:203], a[236:239], v[236:239]
v_mfma_f32_16x16x32_bf16 v[232:235], a[200:203], a[232:235], v[232:235]
v_mfma_f32_16x16x32_bf16 v[228:231], a[200:203], a[228:231], v[228:231]
v_mfma_f32_16x16x32_bf16 v[224:227], a[200:203], a[224:227], v[224:227]
s_waitcnt vmcnt(4)
v_mfma_f32_16x16x32_bf16 v[240:243], a[204:207], a[224:227], v[240:243]
v_mfma_f32_16x16x32_bf16 v[244:247], a[204:207], a[228:231], v[244:247]
v_mfma_f32_16x16x32_bf16 v[248:251], a[204:207], a[232:235], v[248:251]
v_mfma_f32_16x16x32_bf16 v[252:255], a[204:207], a[236:239], v[252:255]
v_add_u32 v11, s86, v3
v_add_u32 v12, s86, v44
s_nop 7
ds_read_b64 v[16:17], v8 offset:0
ds_read_b64 v[20:21], v8 offset:2048
v_accvgpr_read_b32 v24, a96
v_accvgpr_read_b32 v25, a97
v_lshlrev_b32 v28, 16, v24
v_and_b32 v29, s25, v24
s_waitcnt lgkmcnt(1)
v_lshlrev_b32 v30, 16, v16
v_and_b32 v31, s25, v16
v_fma_f32 v240, v28, v240, v30
v_fma_f32 v241, v29, v241, v31
v_cvt_pk_bf16_f32 v240, v240, v241
v_lshlrev_b32 v32, 16, v25
v_and_b32 v33, s25, v25
v_lshlrev_b32 v34, 16, v17
v_and_b32 v35, s25, v17
v_fma_f32 v242, v32, v242, v34
v_fma_f32 v243, v33, v243, v35
v_cvt_pk_bf16_f32 v241, v242, v243
ds_write_b64 v8, v[240:241] offset:35840
ds_read_b64 v[16:17], v8 offset:4096
v_accvgpr_read_b32 v24, a98
v_accvgpr_read_b32 v25, a99
v_lshlrev_b32 v28, 16, v24
v_and_b32 v29, s25, v24
s_waitcnt lgkmcnt(2)
v_lshlrev_b32 v30, 16, v20
v_and_b32 v31, s25, v20
v_fma_f32 v244, v28, v244, v30
v_fma_f32 v245, v29, v245, v31
v_cvt_pk_bf16_f32 v244, v244, v245
v_lshlrev_b32 v32, 16, v25
v_and_b32 v33, s25, v25
v_lshlrev_b32 v34, 16, v21
v_and_b32 v35, s25, v21
v_fma_f32 v246, v32, v246, v34
v_fma_f32 v247, v33, v247, v35
v_cvt_pk_bf16_f32 v245, v246, v247
ds_write_b64 v8, v[244:245] offset:37888
ds_read_b64 v[20:21], v8 offset:6144
v_accvgpr_read_b32 v24, a100
v_accvgpr_read_b32 v25, a101
v_lshlrev_b32 v28, 16, v24
v_and_b32 v29, s25, v24
s_waitcnt lgkmcnt(2)
v_lshlrev_b32 v30, 16, v16
v_and_b32 v31, s25, v16
v_fma_f32 v248, v28, v248, v30
v_fma_f32 v249, v29, v249, v31
v_cvt_pk_bf16_f32 v248, v248, v249
v_lshlrev_b32 v32, 16, v25
v_and_b32 v33, s25, v25
v_lshlrev_b32 v34, 16, v17
v_and_b32 v35, s25, v17
v_fma_f32 v250, v32, v250, v34
v_fma_f32 v251, v33, v251, v35
v_cvt_pk_bf16_f32 v249, v250, v251
ds_write_b64 v8, v[248:249] offset:39936
ds_read_b128 v[16:19], v3 offset:16384
v_accvgpr_read_b32 v24, a102
v_accvgpr_read_b32 v25, a103
v_lshlrev_b32 v28, 16, v24
v_and_b32 v29, s25, v24
s_waitcnt lgkmcnt(2)
v_lshlrev_b32 v30, 16, v20
v_and_b32 v31, s25, v20
v_fma_f32 v252, v28, v252, v30
v_fma_f32 v253, v29, v253, v31
v_cvt_pk_bf16_f32 v252, v252, v253
v_lshlrev_b32 v32, 16, v25
v_and_b32 v33, s25, v25
v_lshlrev_b32 v34, 16, v21
v_and_b32 v35, s25, v21
v_fma_f32 v254, v32, v254, v34
v_fma_f32 v255, v33, v255, v35
v_cvt_pk_bf16_f32 v253, v254, v255
ds_write_b64 v8, v[252:253] offset:41984
ds_read_b128 v[20:23], v44 offset:16384
v_accvgpr_read_b32 v24, a64
v_accvgpr_read_b32 v25, a65
v_accvgpr_read_b32 v26, a66
v_accvgpr_read_b32 v27, a67
v_lshlrev_b32 v28, 16, v24
v_and_b32 v29, s25, v24
s_waitcnt lgkmcnt(2)
v_lshlrev_b32 v30, 16, v16
v_and_b32 v31, s25, v16
v_fma_f32 v176, v28, v176, v30
v_fma_f32 v177, v29, v177, v31
v_cvt_pk_bf16_f32 v176, v176, v177
v_lshlrev_b32 v32, 16, v25
v_and_b32 v33, s25, v25
v_lshlrev_b32 v34, 16, v17
v_and_b32 v35, s25, v17
v_fma_f32 v178, v32, v178, v34
v_fma_f32 v179, v33, v179, v35
v_cvt_pk_bf16_f32 v177, v178, v179
v_lshlrev_b32 v28, 16, v26
v_and_b32 v29, s25, v26
v_lshlrev_b32 v30, 16, v18
v_and_b32 v31, s25, v18
v_fma_f32 v192, v28, v192, v30
v_fma_f32 v193, v29, v193, v31
v_cvt_pk_bf16_f32 v178, v192, v193
v_lshlrev_b32 v32, 16, v27
v_and_b32 v33, s25, v27
v_lshlrev_b32 v34, 16, v19
v_and_b32 v35, s25, v19
v_fma_f32 v194, v32, v194, v34
v_fma_f32 v195, v33, v195, v35
v_cvt_pk_bf16_f32 v179, v194, v195
ds_read_b128 v[16:19], v3 offset:18432
v_accvgpr_read_b32 v24, a80
v_accvgpr_read_b32 v25, a81
v_accvgpr_read_b32 v26, a82
v_accvgpr_read_b32 v27, a83
v_lshlrev_b32 v28, 16, v24
v_and_b32 v29, s25, v24
s_waitcnt lgkmcnt(1)
v_lshlrev_b32 v30, 16, v20
v_and_b32 v31, s25, v20
v_fma_f32 v208, v28, v208, v30
v_fma_f32 v209, v29, v209, v31
v_cvt_pk_bf16_f32 v208, v208, v209
v_lshlrev_b32 v32, 16, v25
v_and_b32 v33, s25, v25
v_lshlrev_b32 v34, 16, v21
v_and_b32 v35, s25, v21
v_fma_f32 v210, v32, v210, v34
v_fma_f32 v211, v33, v211, v35
v_cvt_pk_bf16_f32 v209, v210, v211
v_lshlrev_b32 v28, 16, v26
v_and_b32 v29, s25, v26
v_lshlrev_b32 v30, 16, v22
v_and_b32 v31, s25, v22
v_fma_f32 v224, v28, v224, v30
v_fma_f32 v225, v29, v225, v31
v_cvt_pk_bf16_f32 v210, v224, v225
v_lshlrev_b32 v32, 16, v27
v_and_b32 v33, s25, v27
v_lshlrev_b32 v34, 16, v23
v_and_b32 v35, s25, v23
v_fma_f32 v226, v32, v226, v34
v_fma_f32 v227, v33, v227, v35
v_cvt_pk_bf16_f32 v211, v226, v227
ds_write_b128 v11, v[176:179]
ds_write_b128 v12, v[208:211]
ds_read_b128 v[176:179], v36
ds_read_b128 v[208:211], v36 offset:1024
s_barrier
ds_read_b128 v[240:243], v37
ds_read_b128 v[244:247], v37 offset:1024
ds_read_b128 v[20:23], v44 offset:18432
v_accvgpr_read_b32 v24, a68
v_accvgpr_read_b32 v25, a69
v_accvgpr_read_b32 v26, a70
v_accvgpr_read_b32 v27, a71
v_lshlrev_b32 v28, 16, v24
v_and_b32 v29, s25, v24
s_waitcnt lgkmcnt(7)
v_lshlrev_b32 v30, 16, v16
v_and_b32 v31, s25, v16
v_fma_f32 v180, v28, v180, v30
v_fma_f32 v181, v29, v181, v31
v_cvt_pk_bf16_f32 v180, v180, v181
v_lshlrev_b32 v32, 16, v25
v_and_b32 v33, s25, v25
v_lshlrev_b32 v34, 16, v17
v_and_b32 v35, s25, v17
v_fma_f32 v182, v32, v182, v34
v_fma_f32 v183, v33, v183, v35
v_cvt_pk_bf16_f32 v181, v182, v183
v_lshlrev_b32 v28, 16, v26
v_and_b32 v29, s25, v26
v_lshlrev_b32 v30, 16, v18
v_and_b32 v31, s25, v18
v_fma_f32 v196, v28, v196, v30
v_fma_f32 v197, v29, v197, v31
v_cvt_pk_bf16_f32 v182, v196, v197
v_lshlrev_b32 v32, 16, v27
v_and_b32 v33, s25, v27
v_lshlrev_b32 v34, 16, v19
v_and_b32 v35, s25, v19
v_fma_f32 v198, v32, v198, v34
v_fma_f32 v199, v33, v199, v35
v_cvt_pk_bf16_f32 v183, v198, v199
s_waitcnt lgkmcnt(4)
global_store_dwordx4 v9, v[176:179], s[48:49] offset:256 nt
s_waitcnt lgkmcnt(3)
global_store_dwordx4 v10, v[208:211], s[48:49] offset:256 nt
ds_read_b128 v[16:19], v3 offset:20480
v_accvgpr_read_b32 v24, a84
v_accvgpr_read_b32 v25, a85
v_accvgpr_read_b32 v26, a86
v_accvgpr_read_b32 v27, a87
v_lshlrev_b32 v28, 16, v24
v_and_b32 v29, s25, v24
s_waitcnt lgkmcnt(1)
v_lshlrev_b32 v30, 16, v20
v_and_b32 v31, s25, v20
v_fma_f32 v212, v28, v212, v30
v_fma_f32 v213, v29, v213, v31
v_cvt_pk_bf16_f32 v212, v212, v213
v_lshlrev_b32 v32, 16, v25
v_and_b32 v33, s25, v25
v_lshlrev_b32 v34, 16, v21
v_and_b32 v35, s25, v21
v_fma_f32 v214, v32, v214, v34
v_fma_f32 v215, v33, v215, v35
v_cvt_pk_bf16_f32 v213, v214, v215
v_lshlrev_b32 v28, 16, v26
v_and_b32 v29, s25, v26
v_lshlrev_b32 v30, 16, v22
v_and_b32 v31, s25, v22
v_fma_f32 v228, v28, v228, v30
v_fma_f32 v229, v29, v229, v31
v_cvt_pk_bf16_f32 v214, v228, v229
v_lshlrev_b32 v32, 16, v27
v_and_b32 v33, s25, v27
v_lshlrev_b32 v34, 16, v23
v_and_b32 v35, s25, v23
v_fma_f32 v230, v32, v230, v34
v_fma_f32 v231, v33, v231, v35
v_cvt_pk_bf16_f32 v215, v230, v231
ds_write_b128 v11, v[180:183]
ds_write_b128 v12, v[212:215]
ds_read_b128 v[180:183], v36
ds_read_b128 v[212:215], v36 offset:1024
global_store_dwordx4 v9, v[240:243], s[46:47] nt
global_store_dwordx4 v10, v[244:247], s[46:47] nt
ds_read_b128 v[20:23], v44 offset:20480
v_accvgpr_read_b32 v24, a72
v_accvgpr_read_b32 v25, a73
v_accvgpr_read_b32 v26, a74
v_accvgpr_read_b32 v27, a75
v_lshlrev_b32 v28, 16, v24
v_and_b32 v29, s25, v24
s_waitcnt lgkmcnt(5)
v_lshlrev_b32 v30, 16, v16
v_and_b32 v31, s25, v16
v_fma_f32 v184, v28, v184, v30
v_fma_f32 v185, v29, v185, v31
v_cvt_pk_bf16_f32 v184, v184, v185
v_lshlrev_b32 v32, 16, v25
v_and_b32 v33, s25, v25
v_lshlrev_b32 v34, 16, v17
v_and_b32 v35, s25, v17
v_fma_f32 v186, v32, v186, v34
v_fma_f32 v187, v33, v187, v35
v_cvt_pk_bf16_f32 v185, v186, v187
v_lshlrev_b32 v28, 16, v26
v_and_b32 v29, s25, v26
v_lshlrev_b32 v30, 16, v18
v_and_b32 v31, s25, v18
v_fma_f32 v200, v28, v200, v30
v_fma_f32 v201, v29, v201, v31
v_cvt_pk_bf16_f32 v186, v200, v201
v_lshlrev_b32 v32, 16, v27
v_and_b32 v33, s25, v27
v_lshlrev_b32 v34, 16, v19
v_and_b32 v35, s25, v19
v_fma_f32 v202, v32, v202, v34
v_fma_f32 v203, v33, v203, v35
v_cvt_pk_bf16_f32 v187, v202, v203
s_waitcnt lgkmcnt(2)
global_store_dwordx4 v9, v[180:183], s[50:51] offset:256 nt
s_waitcnt lgkmcnt(1)
global_store_dwordx4 v10, v[212:215], s[50:51] offset:256 nt
ds_read_b128 v[16:19], v3 offset:22528
v_accvgpr_read_b32 v24, a88
v_accvgpr_read_b32 v25, a89
v_accvgpr_read_b32 v26, a90
v_accvgpr_read_b32 v27, a91
v_lshlrev_b32 v28, 16, v24
v_and_b32 v29, s25, v24
s_waitcnt lgkmcnt(1)
v_lshlrev_b32 v30, 16, v20
v_and_b32 v31, s25, v20
v_fma_f32 v216, v28, v216, v30
v_fma_f32 v217, v29, v217, v31
v_cvt_pk_bf16_f32 v216, v216, v217
v_lshlrev_b32 v32, 16, v25
v_and_b32 v33, s25, v25
v_lshlrev_b32 v34, 16, v21
v_and_b32 v35, s25, v21
v_fma_f32 v218, v32, v218, v34
v_fma_f32 v219, v33, v219, v35
v_cvt_pk_bf16_f32 v217, v218, v219
v_lshlrev_b32 v28, 16, v26
v_and_b32 v29, s25, v26
v_lshlrev_b32 v30, 16, v22
v_and_b32 v31, s25, v22
v_fma_f32 v232, v28, v232, v30
v_fma_f32 v233, v29, v233, v31
v_cvt_pk_bf16_f32 v218, v232, v233
v_lshlrev_b32 v32, 16, v27
v_and_b32 v33, s25, v27
v_lshlrev_b32 v34, 16, v23
v_and_b32 v35, s25, v23
v_fma_f32 v234, v32, v234, v34
v_fma_f32 v235, v33, v235, v35
v_cvt_pk_bf16_f32 v219, v234, v235
ds_write_b128 v11, v[184:187]
ds_write_b128 v12, v[216:219]
ds_read_b128 v[184:187], v36
ds_read_b128 v[216:219], v36 offset:1024
ds_read_b128 v[20:23], v44 offset:22528
v_accvgpr_read_b32 v24, a76
v_accvgpr_read_b32 v25, a77
v_accvgpr_read_b32 v26, a78
v_accvgpr_read_b32 v27, a79
v_lshlrev_b32 v28, 16, v24
v_and_b32 v29, s25, v24
s_waitcnt lgkmcnt(5)
v_lshlrev_b32 v30, 16, v16
v_and_b32 v31, s25, v16
v_fma_f32 v188, v28, v188, v30
v_fma_f32 v189, v29, v189, v31
v_cvt_pk_bf16_f32 v188, v188, v189
v_lshlrev_b32 v32, 16, v25
v_and_b32 v33, s25, v25
v_lshlrev_b32 v34, 16, v17
v_and_b32 v35, s25, v17
v_fma_f32 v190, v32, v190, v34
v_fma_f32 v191, v33, v191, v35
v_cvt_pk_bf16_f32 v189, v190, v191
v_lshlrev_b32 v28, 16, v26
v_and_b32 v29, s25, v26
v_lshlrev_b32 v30, 16, v18
v_and_b32 v31, s25, v18
v_fma_f32 v204, v28, v204, v30
v_fma_f32 v205, v29, v205, v31
v_cvt_pk_bf16_f32 v190, v204, v205
v_lshlrev_b32 v32, 16, v27
v_and_b32 v33, s25, v27
v_lshlrev_b32 v34, 16, v19
v_and_b32 v35, s25, v19
v_fma_f32 v206, v32, v206, v34
v_fma_f32 v207, v33, v207, v35
v_cvt_pk_bf16_f32 v191, v206, v207
s_waitcnt lgkmcnt(2)
global_store_dwordx4 v9, v[184:187], s[52:53] offset:256 nt
s_waitcnt lgkmcnt(1)
global_store_dwordx4 v10, v[216:219], s[52:53] offset:256 nt
v_accvgpr_read_b32 v24, a92
v_accvgpr_read_b32 v25, a93
v_accvgpr_read_b32 v26, a94
v_accvgpr_read_b32 v27, a95
v_lshlrev_b32 v28, 16, v24
v_and_b32 v29, s25, v24
s_waitcnt lgkmcnt(0)
v_lshlrev_b32 v30, 16, v20
v_and_b32 v31, s25, v20
v_fma_f32 v220, v28, v220, v30
v_fma_f32 v221, v29, v221, v31
v_cvt_pk_bf16_f32 v220, v220, v221
v_lshlrev_b32 v32, 16, v25
v_and_b32 v33, s25, v25
v_lshlrev_b32 v34, 16, v21
v_and_b32 v35, s25, v21
v_fma_f32 v222, v32, v222, v34
v_fma_f32 v223, v33, v223, v35
v_cvt_pk_bf16_f32 v221, v222, v223
v_lshlrev_b32 v28, 16, v26
v_and_b32 v29, s25, v26
v_lshlrev_b32 v30, 16, v22
v_and_b32 v31, s25, v22
v_fma_f32 v236, v28, v236, v30
v_fma_f32 v237, v29, v237, v31
v_cvt_pk_bf16_f32 v222, v236, v237
v_lshlrev_b32 v32, 16, v27
v_and_b32 v33, s25, v27
v_lshlrev_b32 v34, 16, v23
v_and_b32 v35, s25, v23
v_fma_f32 v238, v32, v238, v34
v_fma_f32 v239, v33, v239, v35
v_cvt_pk_bf16_f32 v223, v238, v239
ds_write_b128 v11, v[188:191]
ds_write_b128 v12, v[220:223]
ds_read_b128 v[188:191], v36
ds_read_b128 v[220:223], v36 offset:1024
s_waitcnt lgkmcnt(1)
global_store_dwordx4 v9, v[188:191], s[54:55] offset:256 nt
s_waitcnt lgkmcnt(0)
global_store_dwordx4 v10, v[220:223], s[54:55] offset:256 nt
Lend:
s_endpgm
Lslow:
s_mov_b32 s68, 0
Lpoll:
global_load_dword v12, v11, s[12:13] sc1
s_add_u32 s68, s68, 1
s_waitcnt vmcnt(0)
v_cmp_gt_u32 vcc, 10, v12
s_nop 4
s_cmp_eq_u64 vcc, 0
s_cbranch_scc1 Lsync_back
s_cmp_lt_u32 s68, 20000
s_cbranch_scc1 Lpoll
s_mov_b32 s67, 0
Lfb_loop:
s_mov_b32 s16, 33038210
s_mul_hi_u32 s17, s67, s16
s_mul_i32 s16, s17, 130
s_sub_u32 s23, s67, s16
s_mov_b32 s16, 858993460
s_mul_hi_u32 s35, s23, s16
s_mul_i32 s16, s35, 5
s_sub_u32 s16, s23, s16
s_mul_i32 s16, s16, 384
s_add_u32 s16, s16, 256
s_min_u32 s16, s16, 1536
s_lshl_b32 s23, s23, 4
s_cmp_ge_u32 s67, 390
s_cselect_b32 s69, 1, 0
s_cbranch_scc0 Ljd_b1
s_sub_u32 s18, s67, 390
s_cmp_ge_u32 s18, 104
s_cselect_b32 s17, 2, 1
s_cselect_b32 s19, 104, 0
s_sub_u32 s18, s18, s19
s_lshr_b32 s35, s18, 2
s_and_b32 s16, s18, 3
s_mul_i32 s16, s16, 384
s_add_u32 s16, s16, 3328
s_lshl_b32 s23, s18, 2
s_add_u32 s23, s23, 2080
Ljd_b1:
s_load_dwordx4 s[60:63], s[70:71], s23
s_mul_i32 s66, s17, 346112
s_mul_i32 s17, s17, 1384448
s_mul_i32 s35, s35, 53248
s_add_u32 s17, s17, s35
s_add_u32 s64, s17, s16
s_waitcnt lgkmcnt(0)
s_add_u32 s64, s6, s64
s_addc_u32 s65, s7, 0
s_cmp_eq_u32 s69, 1
s_cbranch_scc1 Lfb_a
v_lshrrev_b32 v216, 4, v1
v_lshrrev_b32 v217, 3, v216
v_mul_u32_u24 v217, 1664, v217
v_bfe_u32 v218, v216, 4, 1
v_lshlrev_b32 v218, 2, v218
v_and_b32 v212, 7, v216
v_xor_b32 v218, v218, v212
v_lshl_add_u32 v212, v218, 4, v217
v_lshrrev_b32 v217, 4, v216
v_bfe_u32 v218, v216, 2, 2
v_lshl_add_u32 v217, v217, 3, v218
v_lshlrev_b32 v217, 7, v217
v_and_b32 v218, 3, v216
v_lshl_add_u32 v217, v218, 4, v217
v_bfe_u32 v218, v216, 3, 1
v_lshl_add_u32 v208, v218, 6, v217
s_lshl_b32 s16, s3, 12
s_add_u32 s16, s16, 117760
v_add_u32 v208, s16, v208
v_xor_b32 v209, 64, v208
s_lshl_b32 s16, s3, 12
s_add_u32 s16, s16, 117760
s_add_u32 m0, s16, 0
s_nop 0
global_load_lds_dwordx4 v212, s[64:65]
s_add_u32 s64, s64, 13312
s_addc_u32 s65, s65, 0
s_add_u32 m0, s16, 1024
s_nop 0
global_load_lds_dwordx4 v212, s[64:65]
s_add_u32 s64, s64, 13312
s_addc_u32 s65, s65, 0
s_add_u32 m0, s16, 2048
s_nop 0
global_load_lds_dwordx4 v212, s[64:65]
s_add_u32 s64, s64, 13312
s_addc_u32 s65, s65, 0
s_add_u32 m0, s16, 3072
s_nop 0
global_load_lds_dwordx4 v212, s[64:65]
s_waitcnt vmcnt(0)
ds_read_b64_tr_b16 v[192:193], v208 offset:0
ds_read_b64_tr_b16 v[194:195], v208 offset:512
ds_read_b64_tr_b16 v[196:197], v208 offset:8
ds_read_b64_tr_b16 v[198:199], v208 offset:520
ds_read_b64_tr_b16 v[200:201], v209 offset:0
ds_read_b64_tr_b16 v[202:203], v209 offset:512
ds_read_b64_tr_b16 v[204:205], v209 offset:8
ds_read_b64_tr_b16 v[206:207], v209 offset:520
s_add_u32 s16, s60, s66
v_add_u32 v210, s16, v1
s_waitcnt lgkmcnt(6)
global_store_dwordx4 v210, v[192:195], s[14:15] sc0 sc1
s_add_u32 s16, s61, s66
v_add_u32 v211, s16, v1
s_waitcnt lgkmcnt(4)
global_store_dwordx4 v211, v[196:199], s[14:15] sc0 sc1
s_add_u32 s16, s62, s66
v_add_u32 v210, s16, v1
s_waitcnt lgkmcnt(2)
global_store_dwordx4 v210, v[200:203], s[14:15] sc0 sc1
s_add_u32 s16, s63, s66
v_add_u32 v211, s16, v1
s_waitcnt lgkmcnt(0)
global_store_dwordx4 v211, v[204:207], s[14:15] sc0 sc1
s_branch Lfb_next
Lfb_a:
v_lshrrev_b32 v240, 4, v1
v_and_b32 v241, 15, v240
v_lshrrev_b32 v240, 4, v240
v_mul_u32_u24 v240, 13312, v240
v_lshl_add_u32 v241, v241, 4, v240
v_add_u32 v242, 6656, v241
global_load_dwordx4 v[192:195], v241, s[64:65] offset:-3328
global_load_dwordx4 v[196:199], v241, s[64:65] offset:-1664
global_load_dwordx4 v[200:203], v241, s[64:65] offset:0
global_load_dwordx4 v[204:207], v241, s[64:65] offset:1664
global_load_dwordx4 v[208:211], v242, s[64:65] offset:-3328
global_load_dwordx4 v[212:215], v242, s[64:65] offset:-1664
global_load_dwordx4 v[216:219], v242, s[64:65] offset:0
global_load_dwordx4 v[220:223], v242, s[64:65] offset:1664
s_add_u32 s16, s60, s66
s_add_u32 s16, s16, 4096
v_add_u32 v240, s16, v1
s_waitcnt vmcnt(0)
v_perm_b32 v224, v196, v192, s84
v_perm_b32 v225, v204, v200, s84
v_perm_b32 v226, v212, v208, s84
v_perm_b32 v227, v220, v216, s84
v_perm_b32 v228, v196, v192, s85
v_perm_b32 v229, v204, v200, s85
v_perm_b32 v230, v212, v208, s85
v_perm_b32 v231, v220, v216, s85
global_store_dwordx4 v240, v[224:227], s[14:15] offset:-4096 sc0 sc1
global_store_dwordx4 v240, v[228:231], s[14:15] offset:-3072 sc0 sc1
s_nop 1
v_perm_b32 v224, v197, v193, s84
v_perm_b32 v225, v205, v201, s84
v_perm_b32 v226, v213, v209, s84
v_perm_b32 v227, v221, v217, s84
v_perm_b32 v228, v197, v193, s85
v_perm_b32 v229, v205, v201, s85
v_perm_b32 v230, v213, v209, s85
v_perm_b32 v231, v221, v217, s85
global_store_dwordx4 v240, v[224:227], s[14:15] offset:-2048 sc0 sc1
global_store_dwordx4 v240, v[228:231], s[14:15] offset:-1024 sc0 sc1
s_nop 1
v_perm_b32 v224, v198, v194, s84
v_perm_b32 v225, v206, v202, s84
v_perm_b32 v226, v214, v210, s84
v_perm_b32 v227, v222, v218, s84
v_perm_b32 v228, v198, v194, s85
v_perm_b32 v229, v206, v202, s85
v_perm_b32 v230, v214, v210, s85
v_perm_b32 v231, v222, v218, s85
global_store_dwordx4 v240, v[224:227], s[14:15] offset:0 sc0 sc1
global_store_dwordx4 v240, v[228:231], s[14:15] offset:1024 sc0 sc1
s_nop 1
v_perm_b32 v224, v199, v195, s84
v_perm_b32 v225, v207, v203, s84
v_perm_b32 v226, v215, v211, s84
v_perm_b32 v227, v223, v219, s84
v_perm_b32 v228, v199, v195, s85
v_perm_b32 v229, v207, v203, s85
v_perm_b32 v230, v215, v211, s85
v_perm_b32 v231, v223, v219, s85
global_store_dwordx4 v240, v[224:227], s[14:15] offset:2048 sc0 sc1
global_store_dwordx4 v240, v[228:231], s[14:15] offset:3072 sc0 sc1
s_nop 1
Lfb_next:
s_waitcnt vmcnt(0) lgkmcnt(0)
s_add_u32 s67, s67, 1
s_cmp_lt_u32 s67, 598
s_cbranch_scc1 Lfb_loop
s_nop 3
s_branch Lsync_back
Lcode_end:
.p2align 6
.type Ltable,@object
Ltable:
.long 212992, 214016, 215040, 216064, 1266688, 1267712, 1268736, 1269760
.long 2299904, 2300928, 2301952, 2302976, 3333120, 3334144, 3335168, 3336192
.long 217088, 1270784, 2304000, 3337216, 233472, 234496, 235520, 236544
.long 1287168, 1288192, 1289216, 1290240, 2320384, 2321408, 2322432, 2323456
.long 3353600, 3354624, 3355648, 3356672, 237568, 1291264, 2324480, 3357696
.long 253952, 254976, 256000, 257024, 1307648, 1308672, 1309696, 1310720
.long 2340864, 2341888, 2342912, 2343936, 3374080, 3375104, 3376128, 3377152
.long 258048, 1311744, 2344960, 3378176, 274432, 275456, 276480, 277504
.long 1328128, 1329152, 1330176, 1331200, 2361344, 2362368, 2363392, 2364416
.long 3394560, 3395584, 3396608, 3397632, 278528, 1332224, 2365440, 3398656
.long 294912, 295936, 296960, 297984, 1374208, 1375232, 1376256, 1377280
.long 2402304, 2403328, 2404352, 2405376, 3430400, 3431424, 3432448, 3433472
.long 299008, 1378304, 2406400, 3434496, 300032, 301056, 302080, 303104
.long 1379328, 1380352, 1381376, 1382400, 2407424, 2408448, 2409472, 2410496
.long 3435520, 3436544, 3437568, 3438592, 304128, 1383424, 2411520, 3439616
.long 218112, 219136, 220160, 221184, 1251328, 1252352, 1253376, 1254400
.long 2305024, 2306048, 2307072, 2308096, 3338240, 3339264, 3340288, 3341312
.long 222208, 1255424, 2309120, 3342336, 238592, 239616, 240640, 241664
.long 1271808, 1272832, 1273856, 1274880, 2325504, 2326528, 2327552, 2328576
.long 3358720, 3359744, 3360768, 3361792, 242688, 1275904, 2329600, 3362816
.long 259072, 260096, 261120, 262144, 1292288, 1293312, 1294336, 1295360
.long 2345984, 2347008, 2348032, 2349056, 3379200, 3380224, 3381248, 3382272
.long 263168, 1296384, 2350080, 3383296, 279552, 280576, 281600, 282624
.long 1312768, 1313792, 1314816, 1315840, 2366464, 2367488, 2368512, 2369536
.long 3399680, 3400704, 3401728, 3402752, 283648, 1316864, 2370560, 3403776
.long 315392, 316416, 317440, 318464, 1333248, 1334272, 1335296, 1336320
.long 2412544, 2413568, 2414592, 2415616, 3440640, 3441664, 3442688, 3443712
.long 319488, 1337344, 2416640, 3444736, 320512, 321536, 322560, 323584
.long 1338368, 1339392, 1340416, 1341440, 2417664, 2418688, 2419712, 2420736
.long 3445760, 3446784, 3447808, 3448832, 324608, 1342464, 2421760, 3449856
.long 223232, 224256, 225280, 226304, 1256448, 1257472, 1258496, 1259520
.long 2289664, 2290688, 2291712, 2292736, 3343360, 3344384, 3345408, 3346432
.long 227328, 1260544, 2293760, 3347456, 243712, 244736, 245760, 246784
.long 1276928, 1277952, 1278976, 1280000, 2310144, 2311168, 2312192, 2313216
.long 3363840, 3364864, 3365888, 3366912, 247808, 1281024, 2314240, 3367936
.long 264192, 265216, 266240, 267264, 1297408, 1298432, 1299456, 1300480
.long 2330624, 2331648, 2332672, 2333696, 3384320, 3385344, 3386368, 3387392
.long 268288, 1301504, 2334720, 3388416, 284672, 285696, 286720, 287744
.long 1317888, 1318912, 1319936, 1320960, 2351104, 2352128, 2353152, 2354176
.long 3404800, 3405824, 3406848, 3407872, 288768, 1321984, 2355200, 3408896
.long 325632, 326656, 327680, 328704, 1353728, 1354752, 1355776, 1356800
.long 2371584, 2372608, 2373632, 2374656, 3450880, 3451904, 3452928, 3453952
.long 329728, 1357824, 2375680, 3454976, 330752, 331776, 332800, 333824
.long 1358848, 1359872, 1360896, 1361920, 2376704, 2377728, 2378752, 2379776
.long 3456000, 3457024, 3458048, 3459072, 334848, 1362944, 2380800, 3460096
.long 228352, 229376, 230400, 231424, 1261568, 1262592, 1263616, 1264640
.long 2294784, 2295808, 2296832, 2297856, 3328000, 3329024, 3330048, 3331072
.long 232448, 1265664, 2298880, 3332096, 248832, 249856, 250880, 251904
.long 1282048, 1283072, 1284096, 1285120, 2315264, 2316288, 2317312, 2318336
.long 3348480, 3349504, 3350528, 3351552, 252928, 1286144, 2319360, 3352576
.long 269312, 270336, 271360, 272384, 1302528, 1303552, 1304576, 1305600
.long 2335744, 2336768, 2337792, 2338816, 3368960, 3369984, 3371008, 3372032
.long 273408, 1306624, 2339840, 3373056, 289792, 290816, 291840, 292864
.long 1323008, 1324032, 1325056, 1326080, 2356224, 2357248, 2358272, 2359296
.long 3389440, 3390464, 3391488, 3392512, 293888, 1327104, 2360320, 3393536
.long 335872, 336896, 337920, 338944, 1363968, 1364992, 1366016, 1367040
.long 2392064, 2393088, 2394112, 2395136, 3409920, 3410944, 3411968, 3412992
.long 339968, 1368064, 2396160, 3414016, 340992, 342016, 343040, 344064
.long 1369088, 1370112, 1371136, 1372160, 2397184, 2398208, 2399232, 2400256
.long 3415040, 3416064, 3417088, 3418112, 345088, 1373184, 2401280, 3419136
.long 305152, 306176, 307200, 308224, 1343488, 1344512, 1345536, 1346560
.long 2381824, 2382848, 2383872, 2384896, 3420160, 3421184, 3422208, 3423232
.long 309248, 1347584, 2385920, 3424256, 310272, 311296, 312320, 313344
.long 1348608, 1349632, 1350656, 1351680, 2386944, 2387968, 2388992, 2390016
.long 3425280, 3426304, 3427328, 3428352, 314368, 1352704, 2391040, 3429376
.long 0, 1062912, 2093056, 3123200, 32768, 1095680, 2125824, 3155968
.long 65536, 1128448, 2158592, 3188736, 98304, 1161216, 2191360, 3221504
.long 131072, 1234944, 2256896, 3278848, 139264, 1243136, 2265088, 3287040
.long 8192, 1038336, 2101248, 3131392, 40960, 1071104, 2134016, 3164160
.long 73728, 1103872, 2166784, 3196928, 106496, 1136640, 2199552, 3229696
.long 163840, 1169408, 2273280, 3295232, 172032, 1177600, 2281472, 3303424
.long 16384, 1046528, 2076672, 3139584, 49152, 1079296, 2109440, 3172352
.long 81920, 1112064, 2142208, 3205120, 114688, 1144832, 2174976, 3237888
.long 180224, 1202176, 2207744, 3311616, 188416, 1210368, 2215936, 3319808
.long 24576, 1054720, 2084864, 3115008, 57344, 1087488, 2117632, 3147776
.long 90112, 1120256, 2150400, 3180544, 122880, 1153024, 2183168, 3213312
.long 196608, 1218560, 2240512, 3246080, 204800, 1226752, 2248704, 3254272
.long 147456, 1185792, 2224128, 3262464, 155648, 1193984, 2232320, 3270656
.long 0, 0, 0, 0
.size Ltable, .-Ltable
.section .rodata,"a"
.p2align 6
.amdhsa_kernel standalone__dcn_v2_cross__recsys_kernel
  .amdhsa_next_free_vgpr 512
  .amdhsa_next_free_sgpr 102
  .amdhsa_accum_offset 256
  .amdhsa_group_segment_fixed_size 0
  .amdhsa_kernarg_size 48
  .amdhsa_user_sgpr_count 2
  .amdhsa_user_sgpr_kernarg_segment_ptr 1
  .amdhsa_system_sgpr_workgroup_id_x 1
.end_amdhsa_kernel
```
